```python
import torch

def _softmax(x, axis=-1):
    return torch.softmax(x, dim=axis)

def _gelu(x):
    return torch.nn.functional.gelu(x, approximate='tanh')

def _silu(x):
    return torch.nn.functional.silu(x)

def _sigmoid(x):
    return torch.sigmoid(x)

def _layernorm(x, axis=-1, eps=1e-05):
    m = x.mean(dim=axis, keepdim=True)
    v = x.var(dim=axis, keepdim=True, unbiased=False)
    return (x - m) / torch.sqrt(v + eps)

def _scatter_add(tgt, idx, src, axis=0):
    return tgt.clone().index_add_(axis, idx, src)

def _segment_sum(src, seg, n):
    out = torch.zeros((n,) + src.shape[1:], dtype=src.dtype)
    return out.index_add_(0, seg, src)

def _pad(x, pw):
    flat = tuple((v for pair in reversed(pw) for v in pair))
    return torch.nn.functional.pad(x, flat)
kernel_name = 'adaLN_cond__ssm_conv_s4d__glu_gated_geglu__prompt'

def setup_inputs():

    _w = lambda a: (lambda t: t.to(torch.bfloat16) if t.is_floating_point() else t)(torch.as_tensor(a))

    def _A_setup():
        Bsz, L, D, N = (1, 2048, 512, 128)
        return {'u': _w((lambda *s: torch.randn(*s, dtype=torch.bfloat16) * 0.05)(Bsz, L, D)), 'log_A_real': _w((lambda *s: torch.randn(*s, dtype=torch.bfloat16) * 3.2)(D, N) * 0.5), 'A_imag': _w((lambda *s: torch.randn(*s, dtype=torch.bfloat16) * 0.05)(D, N) * 3.14), 'C_real': _w((lambda *s: torch.randn(*s, dtype=torch.bfloat16) * 0.4)(D, N) / N ** 0.5), 'C_imag': _w((lambda *s: torch.randn(*s, dtype=torch.bfloat16) * 0.4)(D, N) / N ** 0.5), 'log_dt': _w((lambda *s: torch.randn(*s, dtype=torch.bfloat16) * 0.05)(D) * 0.5 - 4.0), 'D_skip': _w((lambda *s: torch.randn(*s, dtype=torch.bfloat16) * 0.1)(D))}
    _A_in = _A_setup()

    def _B_setup():
        B, S, Dm, Df = (1, 2048, 512, 1376)
        return {'x': _w((lambda *s: torch.randn(*s, dtype=torch.bfloat16) * 0.05)(B, S, Dm)), 'w_gate': _w((lambda *s: torch.randn(*s, dtype=torch.bfloat16) * 0.8)(Dm, Df) * Dm ** (-0.5)), 'w_up': _w((lambda *s: torch.randn(*s, dtype=torch.bfloat16) * 0.8)(Dm, Df) * Dm ** (-0.5)), 'w_down': _w((lambda *s: torch.randn(*s, dtype=torch.bfloat16) * 0.8)(Df, Dm) * Df ** (-0.5))}
    _B_in = _B_setup()
    return {'A_u': _A_in['u'], 'A_log_A_real': _A_in['log_A_real'], 'A_A_imag': _A_in['A_imag'], 'A_C_real': _A_in['C_real'], 'A_C_imag': _A_in['C_imag'], 'A_log_dt': _A_in['log_dt'], 'A_D_skip': _A_in['D_skip'], 'B_x': _B_in['x'], 'B_w_gate': _B_in['w_gate'], 'B_w_up': _B_in['w_up'], 'B_w_down': _B_in['w_down'], 'c': _w((lambda *s: torch.randn(*s, dtype=torch.bfloat16) * 0.2)(1, 512) * 8.0), 'w_mod': _w((lambda *s: torch.randn(*s, dtype=torch.bfloat16) * 0.2)(512, 6 * 512) * 512 ** (-0.5) * 8.0)}

def reference(A_u, A_log_A_real, A_A_imag, A_C_real, A_C_imag, A_log_dt, A_D_skip, B_x, B_w_gate, B_w_up, B_w_down, c, w_mod):

    def _A_ref(u, log_A_real, A_imag, C_real, C_imag, log_dt, D_skip):
        L = u.shape[1]
        dt = torch.exp(log_dt)
        A = -torch.exp(log_A_real) + 1j * A_imag
        C = (C_real + 1j * C_imag) * dt[:, None]
        pos = (lambda x, dt: x.to(dt))(torch.arange(L), log_dt.dtype)
        P = torch.exp((A * dt[:, None])[:, :, None] * pos[None, None, :])
        K = 2.0 * torch.einsum('dn,dnl->dl', C, P).real
        L2 = 2 * L
        u_t = (lambda x, *d: x.permute(*d))(u, 0, 2, 1)
        Kf = (lambda x, *a, **k: torch.fft.rfft(x.float(), *a, **k))(K, L2)
        Uf = (lambda x, *a, **k: torch.fft.rfft(x.float(), *a, **k))(u_t, L2)
        y = (lambda x, *a, **k: torch.fft.irfft(x, *a, **k).to(torch.bfloat16))(Uf * Kf[None, :, :], L2)[:, :, :L]
        y = (lambda x, *d: x.permute(*d))(y, 0, 2, 1)
        return y + u * D_skip[None, None, :]

    def _B_ref(x, w_gate, w_up, w_down):
        g = torch.einsum('bsd,df->bsf', x, w_gate)
        u = torch.einsum('bsd,df->bsf', x, w_up)
        h = _gelu(g) * u
        return torch.einsum('bsf,fd->bsd', h, w_down)
    x = A_u
    mod = (_silu(c) @ w_mod).reshape(c.shape[0], 6, 1, -1)
    sa, ca, ga, sb, cb, gb = (mod[:, 0].clone(), mod[:, 1].clone(), mod[:, 2].clone(), mod[:, 3].clone(), mod[:, 4].clone(), mod[:, 5].clone())
    h = _layernorm(x, axis=-1) * (1 + ca) + sa
    x = x + ga * _A_ref(h, A_log_A_real, A_A_imag, A_C_real, A_C_imag, A_log_dt, A_D_skip)
    h = _layernorm(x, axis=-1) * (1 + cb) + sb
    x = x + gb * _B_ref(h, B_w_gate, B_w_up, B_w_down)
    return x
```

```asm
; @launch kernel=k1_kernel grid=(256,1,1) block=(256,1,1) lds=146944
.amdgcn_target "amdgcn-amd-amdhsa--gfx950"
.text
.globl k1_kernel
.p2align 8
.type k1_kernel,@function
k1_kernel:
    s_load_dwordx16 s[16:31], s[0:1], 0
    s_load_dwordx16 s[32:47], s[0:1], 64
    v_lshrrev_b32 v1, 6, v0
    v_and_b32 v2, 63, v0
    v_readfirstlane_b32 s3, v1
    s_mov_b32 s6, 0x2000000
    s_mov_b32 s7, 0x20000
    s_mov_b32 s11, 0x20000

    s_cmp_ge_u32 s2, 256
    s_cbranch_scc1 K3_end
    s_cmp_ge_u32 s2, 0
    s_cselect_b32 s8, 1, 0
    s_cmp_lt_u32 s2, 16
    s_cselect_b32 s8, s8, 0
    s_cmp_eq_u32 s8, 0
    s_cbranch_scc1 K1_nt
    s_bfe_u32 s8, s2, 0x10003
    s_lshl_b32 s8, s8, 7+8
    v_lshl_add_u32 v11, v0, 7, s8
    v_cmp_gt_u32 vcc, CODE_END-K1_pc-4, v11
    s_getpc_b64 s[64:65]
K1_pc:
    s_and_b64 exec, exec, vcc
    s_cbranch_execz K1_nt0
    global_load_dword v12, v11, s[64:65]
K1_nt0:
    s_mov_b64 exec, -1
K1_nt:
    s_mov_b32 s60, 0x05040100
    s_mov_b32 s61, 0x07060302
    s_mov_b32 s51, 0
    s_mov_b32 s49, 0
    v_mov_b32 v9, 0
    v_mov_b32 v10, 0
    v_mov_b32 v11, 0

    s_and_b32 s8, s2, 7
    s_lshr_b32 s9, s2, 3
    s_and_b32 s10, s9, 7
    s_lshr_b32 s9, s9, 3
    s_lshl_b32 s12, s8, 2
    s_add_u32 s12, s12, s9
    s_lshl_b32 s12, s12, 4
    s_add_u32 s12, s12, s10
    s_lshr_b32 s9, s3, 1
    s_and_b32 s10, s3, 1
    s_lshl_b32 s13, s9, 3
    s_add_u32 s12, s12, s13
    s_lshl_b32 s8, s12, 8
    s_lshl_b32 s13, s10, 7
    s_add_u32 s8, s8, s13
    v_lshl_add_u32 v99, v2, 1, s8
    s_lshl_b32 s13, s12, 1
    v_mov_b32 v100, s13
    v_mov_b32 v125, 0
    v_mov_b32 v104, 0
    v_mov_b32 v105, 0
    v_mov_b32 v106, 0
    v_mov_b32 v107, 0
    v_mov_b32 v108, 0
    s_mov_b32 s62, s12

    s_cmp_ge_u32 s2, 224
    s_cbranch_scc1 K1_wd
    s_cmp_lt_u32 s2, 128
    s_cbranch_scc1 K1_ln

    s_sub_u32 s8, s2, 128
    s_and_b32 s9, s8, 7
    s_lshr_b32 s8, s8, 3
    s_lshl_b32 s9, s9, 1
    s_and_b32 s10, s8, 1
    s_add_u32 s9, s9, s10
    s_lshr_b32 s8, s8, 1
    s_lshl_b32 s8, s8, 4
    s_add_u32 s8, s8, s9
    v_and_b32 v3, 3, v0
    v_lshrrev_b32 v4, 2, v0
    v_lshlrev_b32 v5, 4, v4
    v_mul_u32_u24 v6, 49152, v4
    v_lshl_add_u32 v6, v3, 4, v6
    s_lshl_b32 s9, s8, 6
    s_lshl_b32 s67, s8, 7
    s_add_u32 s67, s67, 2232320
    s_mov_b32 s68, 15

    s_waitcnt lgkmcnt(0)
    s_mov_b32 s4, s46
    s_mov_b32 s5, s47

    s_mov_b32 s12, s40
    s_mov_b32 s13, s41
    s_mov_b32 s14, 3145728
    s_mov_b32 s15, 0x20000
    global_load_dwordx4 v[8:11], v5, s[38:39]

    buffer_load_dwordx4 v[16:19], v6, s[12:15], s9 offen
    s_add_u32 s9, s9, 6144
    buffer_load_dwordx4 v[20:23], v6, s[12:15], s9 offen
    s_add_u32 s9, s9, 6144
    buffer_load_dwordx4 v[24:27], v6, s[12:15], s9 offen
    s_add_u32 s9, s9, 6144
    buffer_load_dwordx4 v[28:31], v6, s[12:15], s9 offen
    s_add_u32 s9, s9, 6144
    buffer_load_dwordx4 v[32:35], v6, s[12:15], s9 offen
    s_add_u32 s9, s9, 6144
    buffer_load_dwordx4 v[36:39], v6, s[12:15], s9 offen
    s_add_u32 s9, s9, 6144
    buffer_load_dwordx4 v[40:43], v6, s[12:15], s9 offen
    s_add_u32 s9, s9, 6144
    buffer_load_dwordx4 v[44:47], v6, s[12:15], s9 offen
    global_load_short_d16_hi v108, v100, s[26:27]
    global_load_short_d16_hi v104, v99, s[18:19]
    global_load_short_d16_hi v105, v99, s[20:21]
    global_load_short_d16_hi v106, v99, s[22:23]
    global_load_short_d16_hi v107, v99, s[24:25]
    global_load_short_d16_hi v125, v100, s[28:29]
    s_branch K1_mid
K1_wd:
    s_sub_u32 s8, s2, 224
    s_lshl_b32 s8, s8, 2
    s_add_u32 s8, s8, s3
    s_memrealtime s[64:65]
    s_mov_b32 s67, 2260992+128
    s_mov_b32 s68, 1

    s_waitcnt lgkmcnt(0)
    s_mov_b32 s4, s46
    s_mov_b32 s5, s47

    s_cmp_lg_u32 s8, 0
    s_cbranch_scc1 K1_nolead
    s_mul_i32 s65, s65, 0x9e3779b1
    s_xor_b32 s64, s64, s65
    v_mov_b32 v14, s64
    v_mov_b32 v15, 1
    v_mov_b32 v13, 0
    s_mov_b64 exec, 1
    global_store_dwordx2 v13, v[14:15], s[44:45] offset:128 sc1
    s_mov_b64 exec, -1
K1_nolead:

    global_load_short_d16_hi v108, v100, s[26:27]
    global_load_short_d16_hi v104, v99, s[18:19]
    global_load_short_d16_hi v105, v99, s[20:21]
    global_load_short_d16_hi v106, v99, s[22:23]
    global_load_short_d16_hi v107, v99, s[24:25]
    global_load_short_d16_hi v125, v100, s[28:29]
    s_branch K1_mid
K1_ln:
    s_mov_b32 s66, s2
    s_and_b32 s48, s66, 63
    s_lshl_b32 s8, s48, 2
    s_add_u32 s8, s8, s3
    s_lshl_b32 s9, s8, 13
    v_lshl_add_u32 v3, v2, 4, s9
    v_add_u32 v4, 0x1000, v3
    v_mov_b32 v5, 0x3f803f80
    s_lshl_b32 s49, s48, 15
    s_lshl_b32 s50, s3, 13
    s_add_u32 s49, s49, s50
    s_add_u32 s51, s49, 4096
    v_lshlrev_b32 v6, 6, v2
    v_bfe_u32 v9, v2, 1, 2
    v_xor_b32 v9, s3, v9
    v_lshl_add_u32 v9, v9, 4, v6
    v_bfe_u32 v10, v2, 3, 2
    v_xor_b32 v10, v10, v2
    v_lshl_add_u32 v10, v10, 4, s50
    v_lshlrev_b32 v11, 4, v2
    v_add_u32 v9, 98304, v9
    v_add_u32 v10, 98304, v10
    s_lshr_b32 s67, s48, 1
    s_lshl_b32 s67, s67, 5
    s_and_b32 s68, s48, 1
    s_add_u32 s67, s67, s68
    s_lshr_b32 s68, s66, 6
    s_lshl_b32 s68, s68, 1
    s_add_u32 s67, s67, s68
    s_lshl_b32 s67, s67, 2
    s_add_u32 s67, s67, 2228224
    s_mov_b32 s68, 1

    s_waitcnt lgkmcnt(0)
    s_mov_b32 s4, s46
    s_mov_b32 s5, s47

    global_load_dwordx4 v[16:19], v3, s[16:17] offset:0
    global_load_dwordx4 v[20:23], v3, s[16:17] offset:1024
    global_load_dwordx4 v[24:27], v3, s[16:17] offset:2048
    global_load_dwordx4 v[28:31], v3, s[16:17] offset:3072
    global_load_dwordx4 v[32:35], v4, s[16:17] offset:0
    global_load_dwordx4 v[36:39], v4, s[16:17] offset:1024
    global_load_dwordx4 v[40:43], v4, s[16:17] offset:2048
    global_load_dwordx4 v[44:47], v4, s[16:17] offset:3072
    global_load_short_d16_hi v108, v100, s[26:27]
    global_load_short_d16_hi v104, v99, s[18:19]
    global_load_short_d16_hi v105, v99, s[20:21]
    global_load_short_d16_hi v106, v99, s[22:23]
    global_load_short_d16_hi v107, v99, s[24:25]
    global_load_short_d16_hi v125, v100, s[28:29]
K1_mid:
    s_mov_b32 s16, s8
    s_mov_b32 s17, s49
    s_mov_b32 s18, s51
    s_mov_b32 s19, s67
    s_mov_b64 s[20:21], s[60:61]
    s_mov_b32 s26, s68
    s_mov_b32 s27, 0

    s_lshr_b32 s9, s3, 1
    s_and_b32 s10, s3, 1
    s_mul_i32 s14, s9, 34816
    s_lshl_b32 s15, s10, 8
    s_add_u32 s15, s15, s14
    s_mov_b32 m0, s15

    v_and_b32 v101, 15, v2
    v_lshrrev_b32 v102, 4, v2
    v_sub_u32 v103, 15, v101
    v_cvt_f32_u32 v103, v103
    v_lshl_add_u32 v109, v102, 4, s14
    s_cmp_eq_u32 s10, 0

    s_mov_b32 s48, 0x3f800000
    s_cselect_b32 s48, s48, 0x3e000000
    s_cselect_b32 s49, 0, 35
    v_mul_f32 v110, s48, v103
    v_rndne_f32 v110, v110
    v_cvt_u32_f32 v110, v110
    v_add_u32 v110, s49, v110
    v_mul_u32_u24 v110, 544, v110
    v_add_u32 v116, v110, v109

    s_mov_b32 s48, 0x3f000000
    s_cselect_b32 s48, s48, 0x3e000000
    s_cselect_b32 s49, 16, 38
    v_mul_f32 v110, s48, v103
    v_rndne_f32 v110, v110
    v_cvt_u32_f32 v110, v110
    v_add_u32 v110, s49, v110
    v_mul_u32_u24 v110, 544, v110
    v_add_u32 v117, v110, v109

    s_mov_b32 s48, 0x3e800000
    s_cselect_b32 s48, s48, 0x3e000000
    s_cselect_b32 s49, 25, 41
    v_mul_f32 v110, s48, v103
    v_rndne_f32 v110, v110
    v_cvt_u32_f32 v110, v110
    v_add_u32 v110, s49, v110
    v_mul_u32_u24 v110, 544, v110
    v_add_u32 v118, v110, v109

    s_mov_b32 s48, 0x3e800000
    s_cselect_b32 s48, s48, 0x3e000000
    s_cselect_b32 s49, 30, 44
    v_mul_f32 v110, s48, v103
    v_rndne_f32 v110, v110
    v_cvt_u32_f32 v110, v110
    v_add_u32 v110, s49, v110
    v_mul_u32_u24 v110, 544, v110
    v_add_u32 v119, v110, v109

    v_sub_u32 v110, 62, v101
    v_mul_u32_u24 v110, 544, v110
    v_add_u32 v120, v110, v109
    v_lshlrev_b32 v121, 5, v101
    v_lshl_add_u32 v121, v102, 3, v121
    s_mul_i32 s50, s9, 8320
    s_lshl_b32 s52, s10, 11
    s_sub_u32 s50, s50, s52
    s_add_u32 s50, s50, 11264
    v_add_u32 v121, s50, v121
    v_mov_b32 v122, 0x3f80
    ds_write_addtid_b32 v122 offset:0

    s_and_b32 s8, s2, 7
    s_lshr_b32 s9, s2, 3
    s_and_b32 s10, s9, 7
    s_lshr_b32 s9, s9, 3
    s_lshl_b32 s12, s8, 2
    s_add_u32 s12, s12, s9
    s_lshl_b32 s13, s12, 4
    s_add_u32 s13, s13, s10
    s_lshl_b32 s76, s12, 7
    s_lshl_b32 s15, s10, 12
    s_add_u32 s76, s76, s15
    v_lshrrev_b32 v143, 2, v0
    v_lshlrev_b32 v143, 15, v143
    v_and_b32 v144, 3, v0
    v_lshl_add_u32 v143, v144, 4, v143
    v_lshlrev_b32 v144, 4, v0
    v_lshlrev_b32 v145, 4, v2
    s_lshr_b32 s48, s3, 1
    s_and_b32 s49, s3, 1
    s_lshl_b32 s50, s48, 3
    s_add_u32 s50, s50, s13
    s_mul_i32 s52, s3, 4160
    s_add_u32 s52, s52, 9216
    s_mov_b32 s53, 2097152
    s_add_u32 s54, s53, 4096
    s_add_u32 s55, s53, 8192
    s_add_u32 s56, s53, 12288
    s_lshl_b32 s57, s13, 2
    s_add_u32 s57, s57, 2113536
    s_lshr_b32 s58, s2, 3
    s_and_b32 s59, s58, 1
    s_lshl_b32 s60, s8, 1
    s_add_u32 s59, s59, s60
    s_lshr_b32 s61, s58, 1
    v_lshrrev_b32 v146, 5, v2
    v_and_b32 v147, 7, v2
    v_bfe_u32 v155, v2, 3, 2
    v_cmp_eq_u32 s[64:65], 3, v155
    v_mul_u32_u24 v250, 48, v155
    s_nop 0
    v_cndmask_b32 v148, 6, 4, s[64:65]
    v_mul_u32_u24 v148, v148, v147
    v_and_b32 v149, 2, v148
    v_sub_u32 v148, v148, v149
    v_add_u32 v250, v250, v148
    v_mul_u32_u24 v149, 0x010100, v149
    v_lshlrev_b32 v149, 8, v149
    v_add_u32 v150, 0x01000c0c, v149
    v_add_u32 v151, 0x03020c0c, v149
    v_add_u32 v154, 0x05040c0c, v149
    v_and_b32 v149, 31, v2
    v_cmp_eq_u32 vcc, 31, v149
    v_mov_b32 v148, 0x40000000
    v_mul_u32_u24 v252, 3072, v155
    v_lshl_add_u32 v252, v146, 5, v252
    v_lshrrev_b32 v149, 1, v147
    v_lshl_add_u32 v252, v149, 5, v252
    v_cndmask_b32 v250, v250, v148, vcc
    v_lshl_add_u32 v252, v147, 4, v252
    v_cndmask_b32 v254, v252, v148, s[64:65]
    v_lshlrev_b32 v253, 5, v146
    v_mul_u32_u24 v149, 192, v155
    v_add_u32 v253, v253, v149
    v_lshl_add_u32 v253, v147, 2, v253
    s_lshl_b32 s64, s61, 2
    s_add_u32 s64, s64, s3
    s_mul_i32 s77, s64, 22016
    s_mul_i32 s65, s59, 172
    s_add_u32 s77, s77, s65
    v_mov_b32 v251, 0
    s_lshl_b32 s64, s64, 5
    s_add_u32 s64, s64, 2119680
    s_mov_b32 s69, s64
    s_mov_b32 s74, 0x80000000
    s_mov_b32 s75, 0
    s_mov_b32 s14, 1409024
    s_mov_b32 s15, 0x20000

    s_lshl_b32 s64, s59, 4
    s_add_u32 s64, s64, s61
    s_mul_i32 s64, s64, 11264
    s_lshl_b32 s65, s3, 8
    s_add_u32 s64, s64, s65
    s_add_u32 s64, s64, 5898240
    s_lshl_b32 s72, s61, 4
    s_add_u32 s72, s72, s59
    s_mul_i32 s72, s72, 1536
    s_lshl_b32 s73, s3, 6
    s_add_u32 s72, s72, s73
    s_add_u32 s72, s72, 17170432
    s_cmp_eq_u32 s3, 3
    s_cselect_b32 s73, 0x40000000, 0
    v_or_b32 v253, s73, v253

    v_and_b32 v146, 15, v2
    v_lshrrev_b32 v147, 4, v2
    v_lshrrev_b32 v148, 1, v146
    v_lshlrev_b32 v148, 15, v148
    v_and_b32 v149, 1, v146
    v_lshl_add_u32 v148, v149, 5, v148
    v_lshl_add_u32 v148, v147, 3, v148
    s_lshl_b32 s59, s49, 20
    s_add_u32 s59, s59, s76
    s_lshl_b32 s60, s48, 6
    s_add_u32 s59, s59, s60

    v_mov_b32 v255, 0
    s_mul_i32 s60, s48, 4608
    s_lshl_b32 s61, s49, 8
    s_add_u32 s61, s61, s60
    v_lshl_add_u32 v200, v2, 2, s61
    v_lshl_add_u32 v201, v146, 2, s52
    s_lshl_b32 s61, s49, 1
    s_sub_u32 s61, s52, s61
    v_mov_b32 v199, s61
    v_lshlrev_b32 v152, 5, v146
    v_lshl_add_u32 v152, v147, 4, v152
    s_lshl_b32 s61, s49, 8
    s_sub_u32 s61, s60, s61
    s_add_u32 s61, s61, 288
    v_add_u32 v152, s61, v152
    v_lshlrev_b32 v153, 5, v146
    v_lshl_add_u32 v153, v147, 3, v153
    v_lshlrev_b32 v155, 3, v147
    v_sub_u32 v155, v155, v146
    v_add_u32 v155, 2031, v155
    v_and_b32 v149, 1, v155
    v_mul_u32_u24 v149, 4158, v149
    v_lshl_add_u32 v155, v155, 1, v149
    s_mul_i32 s61, s48, 8320
    s_lshl_b32 s73, s49, 8
    s_sub_u32 s61, s61, s73
    s_add_u32 s61, s61, 8512
    v_add_u32 v180, s61, v155
    v_subrev_u32 v181, 1024, v180
    v_subrev_u32 v182, 2048, v180
    v_subrev_u32 v183, 3072, v180
    v_add_u32 v184, 512, v144
    s_mul_i32 s58, s50, 4352
    s_lshl_b32 s73, s49, 11
    s_add_u32 s58, s58, s73
    s_add_u32 s58, s58, 18874368
    s_lshl_b32 s73, s3, 12
    v_add_u32 v185, s73, v145
    v_xor_b32 v186, 4096, v185
    v_mov_b32 v187, 0x3f803f80
    s_lshl_b32 s70, s50, 2
    s_add_u32 s70, s70, 2117632

    s_mov_b32 s12, s32
    s_mov_b32 s13, s33
    v_cmp_gt_u32 vcc, 32, v2
    v_cndmask_b32 v198, 0, v2, vcc
    s_lshr_b32 s51, s62, 5
    s_add_u32 s51, s51, 32
    v_writelane_b32 v198, s51, 32
    s_add_u32 s51, s51, 16
    v_writelane_b32 v198, s51, 33
    s_add_u32 s51, s51, 16
    v_writelane_b32 v198, s51, 34
    s_lshr_b32 s51, s2, 4
    s_add_u32 s51, s51, 80
    v_writelane_b32 v198, s51, 35
    s_add_u32 s51, s51, 16
    v_writelane_b32 v198, s51, 36
    v_lshlrev_b32 v198, 7, v198
    s_mov_b32 s51, 2228224

    v_accvgpr_write_b32 a0, v143
    v_accvgpr_write_b32 a1, v144
    v_accvgpr_write_b32 a2, v148
    v_accvgpr_write_b32 a3, v150
    v_accvgpr_write_b32 a4, v151
    v_accvgpr_write_b32 a5, v152
    v_accvgpr_write_b32 a6, v153
    v_accvgpr_write_b32 a7, v154
    v_accvgpr_write_b32 a8, v180
    v_accvgpr_write_b32 a9, v181
    v_accvgpr_write_b32 a10, v182
    v_accvgpr_write_b32 a11, v183
    v_accvgpr_write_b32 a12, v184
    v_accvgpr_write_b32 a13, v185
    v_accvgpr_write_b32 a14, v186
    v_accvgpr_write_b32 a15, v187
    v_accvgpr_write_b32 a16, v198
    v_accvgpr_write_b32 a17, v199
    v_accvgpr_write_b32 a18, v200
    v_accvgpr_write_b32 a19, v201
    s_cmp_lt_u32 s2, 64
    s_cbranch_scc1 K1_tp
    s_cmp_lt_u32 s2, 128
    s_cbranch_scc1 K1_st
    s_cmp_lt_u32 s2, 224
    s_cbranch_scc1 K1_mp

    s_and_b32 s28, s16, 7
    s_lshr_b32 s29, s16, 3
    v_and_b32 v3, 15, v2
    v_lshrrev_b32 v4, 4, v2
    v_lshlrev_b32 v3, 3, v3
    v_mul_u32_u24 v5, 6144, v4
    v_add_u32 v5, v5, v3
    v_lshl_add_u32 v6, v4, 12, v3
    v_mov_b32 v8, 0x40000000
    v_cmp_eq_u32 vcc, 3, v4
    s_mul_i32 s17, s29, 88064
    s_lshl_b32 s18, s28, 7
    v_cndmask_b32 v7, v6, v8, vcc
    s_add_u32 s17, s17, s18
    s_add_u32 s25, s17, 73728
    s_lshl_b32 s22, s28, 4
    s_add_u32 s22, s22, s29
    s_mul_i32 s22, s22, 11264
    s_add_u32 s22, s22, 4390912
    s_add_u32 s23, s22, 4096
    s_add_u32 s24, s22, 8192
    v_lshlrev_b32 v9, 4, v2
    v_mul_u32_u24 v10, 12, v2
    s_mov_b32 s10, 1409024

    s_mov_b32 s8, s36
    s_mov_b32 s9, s37
    s_add_u32 s18, s17, 0
    buffer_load_dwordx2 v[16:17], v5, s[8:11], s18 offen offset:0
    buffer_load_dwordx2 v[20:21], v5, s[8:11], s18 offen offset:1024
    buffer_load_dwordx2 v[24:25], v5, s[8:11], s18 offen offset:2048
    buffer_load_dwordx2 v[52:53], v6, s[8:11], s25 offen offset:0
    s_add_u32 s18, s17, 3072
    buffer_load_dwordx2 v[18:19], v5, s[8:11], s18 offen offset:0
    buffer_load_dwordx2 v[22:23], v5, s[8:11], s18 offen offset:1024
    buffer_load_dwordx2 v[26:27], v5, s[8:11], s18 offen offset:2048
    buffer_load_dwordx2 v[54:55], v7, s[8:11], s25 offen offset:2048
    s_add_u32 s18, s17, 24576
    buffer_load_dwordx2 v[28:29], v5, s[8:11], s18 offen offset:0
    buffer_load_dwordx2 v[32:33], v5, s[8:11], s18 offen offset:1024
    buffer_load_dwordx2 v[36:37], v5, s[8:11], s18 offen offset:2048
    buffer_load_dwordx2 v[56:57], v6, s[8:11], s25 offen offset:1024
    s_add_u32 s18, s17, 27648
    buffer_load_dwordx2 v[30:31], v5, s[8:11], s18 offen offset:0
    buffer_load_dwordx2 v[34:35], v5, s[8:11], s18 offen offset:1024
    buffer_load_dwordx2 v[38:39], v5, s[8:11], s18 offen offset:2048
    buffer_load_dwordx2 v[58:59], v7, s[8:11], s25 offen offset:3072
    s_add_u32 s18, s17, 49152
    buffer_load_dwordx2 v[40:41], v5, s[8:11], s18 offen offset:0
    buffer_load_dwordx2 v[44:45], v5, s[8:11], s18 offen offset:1024
    buffer_load_dwordx2 v[48:49], v5, s[8:11], s18 offen offset:2048
    s_add_u32 s18, s17, 52224
    buffer_load_dwordx2 v[42:43], v5, s[8:11], s18 offen offset:0
    buffer_load_dwordx2 v[46:47], v5, s[8:11], s18 offen offset:1024
    buffer_load_dwordx2 v[50:51], v5, s[8:11], s18 offen offset:2048
    s_waitcnt vmcnt(22)
    s_branch K1_join
K1_wdp:
    s_waitcnt vmcnt(16)
    v_cmp_ne_u32 vcc, 1, v97
    s_cbranch_vccz K1_nw2_x
    s_mov_b32 s73, 0
K1_nw2:
    global_load_dwordx2 v[96:97], v98, s[44:45] offset:128 sc1
    s_add_u32 s73, s73, 1
    s_waitcnt vmcnt(0)
    v_cmp_ne_u32 vcc, 1, v97
    s_cmp_gt_u32 s73, 0x40000
    s_cbranch_scc1 K1_nw2_x
    s_cbranch_vccnz K1_nw2
K1_nw2_x:

    v_readfirstlane_b32 s30, v96
    v_perm_b32 v80, v18, v16, s20
    v_perm_b32 v81, v22, v20, s20
    v_perm_b32 v82, v26, v24, s20
    v_perm_b32 v83, v54, v52, s20
    buffer_store_dwordx4 v[80:83], v9, s[4:7], s22 offen offset:0 sc1
    v_perm_b32 v84, v18, v16, s21
    v_perm_b32 v85, v22, v20, s21
    v_perm_b32 v86, v26, v24, s21
    v_perm_b32 v87, v54, v52, s21
    buffer_store_dwordx4 v[84:87], v9, s[4:7], s22 offen offset:1024 sc1
    v_perm_b32 v88, v19, v17, s20
    v_perm_b32 v89, v23, v21, s20
    v_perm_b32 v90, v27, v25, s20
    v_perm_b32 v91, v55, v53, s20
    buffer_store_dwordx4 v[88:91], v9, s[4:7], s22 offen offset:2048 sc1
    v_perm_b32 v92, v19, v17, s21
    v_perm_b32 v93, v23, v21, s21
    v_perm_b32 v94, v27, v25, s21
    v_perm_b32 v95, v55, v53, s21
    buffer_store_dwordx4 v[92:95], v9, s[4:7], s22 offen offset:3072 sc1
    v_perm_b32 v80, v30, v28, s20
    v_perm_b32 v81, v34, v32, s20
    v_perm_b32 v82, v38, v36, s20
    v_perm_b32 v83, v58, v56, s20
    buffer_store_dwordx4 v[80:83], v9, s[4:7], s23 offen offset:0 sc1
    v_perm_b32 v84, v30, v28, s21
    v_perm_b32 v85, v34, v32, s21
    v_perm_b32 v86, v38, v36, s21
    v_perm_b32 v87, v58, v56, s21
    buffer_store_dwordx4 v[84:87], v9, s[4:7], s23 offen offset:1024 sc1
    v_perm_b32 v88, v31, v29, s20
    v_perm_b32 v89, v35, v33, s20
    v_perm_b32 v90, v39, v37, s20
    v_perm_b32 v91, v59, v57, s20
    buffer_store_dwordx4 v[88:91], v9, s[4:7], s23 offen offset:2048 sc1
    v_perm_b32 v92, v31, v29, s21
    v_perm_b32 v93, v35, v33, s21
    v_perm_b32 v94, v39, v37, s21
    v_perm_b32 v95, v59, v57, s21
    buffer_store_dwordx4 v[92:95], v9, s[4:7], s23 offen offset:3072 sc1
    v_perm_b32 v80, v42, v40, s20
    v_perm_b32 v81, v46, v44, s20
    v_perm_b32 v82, v50, v48, s20
    buffer_store_dwordx3 v[80:82], v10, s[4:7], s24 offen offset:0 sc1
    v_perm_b32 v84, v42, v40, s21
    v_perm_b32 v85, v46, v44, s21
    v_perm_b32 v86, v50, v48, s21
    buffer_store_dwordx3 v[84:86], v10, s[4:7], s24 offen offset:768 sc1
    v_perm_b32 v88, v43, v41, s20
    v_perm_b32 v89, v47, v45, s20
    v_perm_b32 v90, v51, v49, s20
    buffer_store_dwordx3 v[88:90], v10, s[4:7], s24 offen offset:1536 sc1
    v_perm_b32 v92, v43, v41, s21
    v_perm_b32 v93, v47, v45, s21
    v_perm_b32 v94, v51, v49, s21
    buffer_store_dwordx3 v[92:94], v10, s[4:7], s24 offen offset:2304 sc1
    s_branch K1_wdr
K1_mp:
    s_waitcnt vmcnt(14)
    v_lshlrev_b32 v48, 16, v8
    v_and_b32 v49, 0xffff0000, v8
    v_lshlrev_b32 v50, 16, v9
    v_and_b32 v51, 0xffff0000, v9
    v_lshlrev_b32 v52, 16, v10
    v_and_b32 v53, 0xffff0000, v10
    v_lshlrev_b32 v54, 16, v11
    v_and_b32 v55, 0xffff0000, v11
    v_mul_f32 v56, 0xbfb8aa3b, v48
    v_mul_f32 v57, 0xbfb8aa3b, v49
    v_mul_f32 v58, 0xbfb8aa3b, v50
    v_mul_f32 v59, 0xbfb8aa3b, v51
    v_mul_f32 v60, 0xbfb8aa3b, v52
    v_mul_f32 v61, 0xbfb8aa3b, v53
    v_mul_f32 v62, 0xbfb8aa3b, v54
    v_mul_f32 v63, 0xbfb8aa3b, v55
    v_exp_f32 v56, v56
    v_exp_f32 v57, v57
    v_exp_f32 v58, v58
    v_exp_f32 v59, v59
    v_exp_f32 v60, v60
    v_exp_f32 v61, v61
    v_exp_f32 v62, v62
    v_exp_f32 v63, v63
    v_add_f32 v56, 1.0, v56
    v_add_f32 v57, 1.0, v57
    v_add_f32 v58, 1.0, v58
    v_add_f32 v59, 1.0, v59
    v_add_f32 v60, 1.0, v60
    v_add_f32 v61, 1.0, v61
    v_add_f32 v62, 1.0, v62
    v_add_f32 v63, 1.0, v63
    v_rcp_f32 v56, v56
    v_rcp_f32 v57, v57
    v_rcp_f32 v58, v58
    v_rcp_f32 v59, v59
    v_rcp_f32 v60, v60
    v_rcp_f32 v61, v61
    v_rcp_f32 v62, v62
    v_rcp_f32 v63, v63
    v_mul_f32 v48, v48, v56
    v_mul_f32 v49, v49, v57
    v_mul_f32 v50, v50, v58
    v_mul_f32 v51, v51, v59
    v_mul_f32 v52, v52, v60
    v_mul_f32 v53, v53, v61
    v_mul_f32 v54, v54, v62
    v_mul_f32 v55, v55, v63
    v_cvt_pk_bf16_f32 v8, v48, v49
    v_cvt_pk_bf16_f32 v9, v50, v51
    v_cvt_pk_bf16_f32 v10, v52, v53
    v_cvt_pk_bf16_f32 v11, v54, v55
    s_waitcnt vmcnt(12)
    v_perm_b32 v64, v20, v16, s20
    v_perm_b32 v65, v20, v16, s21
    v_perm_b32 v66, v21, v17, s20
    v_perm_b32 v67, v21, v17, s21
    v_perm_b32 v68, v22, v18, s20
    v_perm_b32 v69, v22, v18, s21
    v_perm_b32 v70, v23, v19, s20
    v_perm_b32 v71, v23, v19, s21
    v_dot2_f32_bf16 v48, v64, v8, 0
    v_dot2_f32_bf16 v49, v65, v8, 0
    v_dot2_f32_bf16 v50, v66, v8, 0
    v_dot2_f32_bf16 v51, v67, v8, 0
    v_dot2_f32_bf16 v52, v68, v8, 0
    v_dot2_f32_bf16 v53, v69, v8, 0
    v_dot2_f32_bf16 v54, v70, v8, 0
    v_dot2_f32_bf16 v55, v71, v8, 0
    s_waitcnt vmcnt(10)
    v_perm_b32 v64, v28, v24, s20
    v_perm_b32 v65, v28, v24, s21
    v_perm_b32 v66, v29, v25, s20
    v_perm_b32 v67, v29, v25, s21
    v_perm_b32 v68, v30, v26, s20
    v_perm_b32 v69, v30, v26, s21
    v_perm_b32 v70, v31, v27, s20
    v_perm_b32 v71, v31, v27, s21
    v_dot2_f32_bf16 v48, v64, v9, v48
    v_dot2_f32_bf16 v49, v65, v9, v49
    v_dot2_f32_bf16 v50, v66, v9, v50
    v_dot2_f32_bf16 v51, v67, v9, v51
    v_dot2_f32_bf16 v52, v68, v9, v52
    v_dot2_f32_bf16 v53, v69, v9, v53
    v_dot2_f32_bf16 v54, v70, v9, v54
    v_dot2_f32_bf16 v55, v71, v9, v55
    s_waitcnt vmcnt(8)
    v_perm_b32 v64, v36, v32, s20
    v_perm_b32 v65, v36, v32, s21
    v_perm_b32 v66, v37, v33, s20
    v_perm_b32 v67, v37, v33, s21
    v_perm_b32 v68, v38, v34, s20
    v_perm_b32 v69, v38, v34, s21
    v_perm_b32 v70, v39, v35, s20
    v_perm_b32 v71, v39, v35, s21
    v_dot2_f32_bf16 v48, v64, v10, v48
    v_dot2_f32_bf16 v49, v65, v10, v49
    v_dot2_f32_bf16 v50, v66, v10, v50
    v_dot2_f32_bf16 v51, v67, v10, v51
    v_dot2_f32_bf16 v52, v68, v10, v52
    v_dot2_f32_bf16 v53, v69, v10, v53
    v_dot2_f32_bf16 v54, v70, v10, v54
    v_dot2_f32_bf16 v55, v71, v10, v55
    s_waitcnt vmcnt(6)
    v_perm_b32 v64, v44, v40, s20
    v_perm_b32 v65, v44, v40, s21
    v_perm_b32 v66, v45, v41, s20
    v_perm_b32 v67, v45, v41, s21
    v_perm_b32 v68, v46, v42, s20
    v_perm_b32 v69, v46, v42, s21
    v_perm_b32 v70, v47, v43, s20
    v_perm_b32 v71, v47, v43, s21
    v_dot2_f32_bf16 v48, v64, v11, v48
    v_dot2_f32_bf16 v49, v65, v11, v49
    v_dot2_f32_bf16 v50, v66, v11, v50
    v_dot2_f32_bf16 v51, v67, v11, v51
    v_dot2_f32_bf16 v52, v68, v11, v52
    v_dot2_f32_bf16 v53, v69, v11, v53
    v_dot2_f32_bf16 v54, v70, v11, v54
    v_dot2_f32_bf16 v55, v71, v11, v55
    s_nop 2
    v_permlane32_swap_b32 v48, v52
    v_permlane32_swap_b32 v49, v53
    v_permlane32_swap_b32 v50, v54
    v_permlane32_swap_b32 v51, v55
    v_add_f32 v48, v48, v52
    v_add_f32 v49, v49, v53
    v_add_f32 v50, v50, v54
    v_add_f32 v51, v51, v55
    s_nop 0
    v_permlane16_swap_b32 v48, v50
    v_permlane16_swap_b32 v49, v51
    v_add_f32 v48, v48, v50
    v_add_f32 v49, v49, v51
    s_nop 0
    v_add_f32_dpp v48, v48, v48 row_ror:8 row_mask:0xf bank_mask:0xf
    v_add_f32_dpp v49, v49, v49 row_ror:8 row_mask:0xf bank_mask:0xf
    s_nop 0
    v_add_f32_dpp v48, v48, v48 row_ror:4 row_mask:0xf bank_mask:0xf
    v_add_f32_dpp v49, v49, v49 row_ror:4 row_mask:0xf bank_mask:0xf
    s_nop 0
    v_lshrrev_b32 v4, 4, v2
    v_lshlrev_b32 v4, 3, v4
    v_lshl_add_u32 v4, v3, 5, v4
    s_lshl_b32 s9, s3, 7
    s_add_u32 s9, s9, 98304
    v_add_u32 v4, s9, v4
    ds_write_b64 v4, v[48:49]
    s_waitcnt vmcnt(0) lgkmcnt(0)
    s_barrier
    s_cmp_lg_u32 s3, 0
    s_cbranch_scc1 K1_join
    v_and_b32 v4, 31, v2
    v_lshlrev_b32 v4, 2, v4
    v_add_u32 v5, 98304, v4
    ds_read2_b32 v[8:9], v5 offset0:0 offset1:32
    ds_read2_b32 v[10:11], v5 offset0:64 offset1:96
    s_lshr_b32 s9, s16, 4
    s_cmp_eq_u32 s9, 1
    s_cselect_b32 s10, 1.0, 0
    s_cmp_eq_u32 s9, 4
    s_cselect_b32 s10, 1.0, s10
    s_lshl_b32 s9, s16, 7
    s_add_u32 s9, s9, 2113536
    s_waitcnt lgkmcnt(0)
    v_add_f32 v8, v8, v9
    v_add_f32 v10, v10, v11
    v_add_f32 v8, v8, v10
    v_cvt_pk_bf16_f32 v8, v8, v8
    v_and_b32 v8, 0xffff0000, v8
    v_add_f32 v8, s10, v8
    v_cvt_pk_bf16_f32 v8, v8, v8
    v_and_b32 v8, 0xffff0000, v8
    buffer_store_dword v8, v4, s[4:7], s9 offen sc1
    s_branch K1_join

K1_tp:
    s_waitcnt vmcnt(12)
    v_perm_b32 v64, v20, v16, s20
    v_perm_b32 v68, v20, v16, s21
    v_perm_b32 v72, v21, v17, s20
    v_perm_b32 v76, v21, v17, s21
    v_perm_b32 v80, v22, v18, s20
    v_perm_b32 v84, v22, v18, s21
    v_perm_b32 v88, v23, v19, s20
    v_perm_b32 v92, v23, v19, s21
    s_waitcnt vmcnt(10)
    v_perm_b32 v65, v28, v24, s20
    v_perm_b32 v69, v28, v24, s21
    v_perm_b32 v73, v29, v25, s20
    v_perm_b32 v77, v29, v25, s21
    v_perm_b32 v81, v30, v26, s20
    v_perm_b32 v85, v30, v26, s21
    v_perm_b32 v89, v31, v27, s20
    v_perm_b32 v93, v31, v27, s21
    s_waitcnt vmcnt(8)
    v_perm_b32 v66, v36, v32, s20
    v_perm_b32 v70, v36, v32, s21
    v_perm_b32 v74, v37, v33, s20
    v_perm_b32 v78, v37, v33, s21
    v_perm_b32 v82, v38, v34, s20
    v_perm_b32 v86, v38, v34, s21
    v_perm_b32 v90, v39, v35, s20
    v_perm_b32 v94, v39, v35, s21
    s_waitcnt vmcnt(6)
    v_perm_b32 v67, v44, v40, s20
    ds_write_b128 v9, v[64:67] offset:0
    v_perm_b32 v71, v44, v40, s21
    ds_write_b128 v9, v[68:71] offset:4096
    v_perm_b32 v75, v45, v41, s20
    ds_write_b128 v9, v[72:75] offset:8192
    v_perm_b32 v79, v45, v41, s21
    ds_write_b128 v9, v[76:79] offset:12288
    v_perm_b32 v83, v46, v42, s20
    ds_write_b128 v9, v[80:83] offset:16384
    v_perm_b32 v87, v46, v42, s21
    ds_write_b128 v9, v[84:87] offset:20480
    v_perm_b32 v91, v47, v43, s20
    ds_write_b128 v9, v[88:91] offset:24576
    v_perm_b32 v95, v47, v43, s21
    ds_write_b128 v9, v[92:95] offset:28672
    s_waitcnt lgkmcnt(0)
    s_barrier
    ds_read_b128 v[64:67], v10 offset:0
    ds_read_b128 v[68:71], v10 offset:1024
    ds_read_b128 v[72:75], v10 offset:2048
    ds_read_b128 v[76:79], v10 offset:3072
    ds_read_b128 v[80:83], v10 offset:4096
    ds_read_b128 v[84:87], v10 offset:5120
    ds_read_b128 v[88:91], v10 offset:6144
    ds_read_b128 v[92:95], v10 offset:7168
    s_waitcnt lgkmcnt(7)
    buffer_store_dwordx4 v[64:67], v11, s[4:7], s17 offen offset:0 sc1
    s_waitcnt lgkmcnt(6)
    buffer_store_dwordx4 v[68:71], v11, s[4:7], s17 offen offset:1024 sc1
    s_waitcnt lgkmcnt(5)
    buffer_store_dwordx4 v[72:75], v11, s[4:7], s17 offen offset:2048 sc1
    s_waitcnt lgkmcnt(4)
    buffer_store_dwordx4 v[76:79], v11, s[4:7], s17 offen offset:3072 sc1
    s_waitcnt lgkmcnt(3)
    buffer_store_dwordx4 v[80:83], v11, s[4:7], s18 offen offset:0 sc1
    s_waitcnt lgkmcnt(2)
    buffer_store_dwordx4 v[84:87], v11, s[4:7], s18 offen offset:1024 sc1
    s_waitcnt lgkmcnt(1)
    buffer_store_dwordx4 v[88:91], v11, s[4:7], s18 offen offset:2048 sc1
    s_waitcnt lgkmcnt(0)
    buffer_store_dwordx4 v[92:95], v11, s[4:7], s18 offen offset:3072 sc1
    s_waitcnt vmcnt(8)
    s_branch K1_join
K1_st:
    s_waitcnt vmcnt(13)
    v_dot2_f32_bf16 v48, v16, v5, 0
    v_dot2_f32_bf16 v56, v16, v16, 0
    v_dot2_f32_bf16 v48, v17, v5, v48
    v_dot2_f32_bf16 v56, v17, v17, v56
    v_dot2_f32_bf16 v48, v18, v5, v48
    v_dot2_f32_bf16 v56, v18, v18, v56
    v_dot2_f32_bf16 v48, v19, v5, v48
    v_dot2_f32_bf16 v56, v19, v19, v56
    s_waitcnt vmcnt(12)
    v_dot2_f32_bf16 v49, v20, v5, 0
    v_dot2_f32_bf16 v57, v20, v20, 0
    v_dot2_f32_bf16 v49, v21, v5, v49
    v_dot2_f32_bf16 v57, v21, v21, v57
    v_dot2_f32_bf16 v49, v22, v5, v49
    v_dot2_f32_bf16 v57, v22, v22, v57
    v_dot2_f32_bf16 v49, v23, v5, v49
    v_dot2_f32_bf16 v57, v23, v23, v57
    s_waitcnt vmcnt(11)
    v_dot2_f32_bf16 v50, v24, v5, 0
    v_dot2_f32_bf16 v58, v24, v24, 0
    v_dot2_f32_bf16 v50, v25, v5, v50
    v_dot2_f32_bf16 v58, v25, v25, v58
    v_dot2_f32_bf16 v50, v26, v5, v50
    v_dot2_f32_bf16 v58, v26, v26, v58
    v_dot2_f32_bf16 v50, v27, v5, v50
    v_dot2_f32_bf16 v58, v27, v27, v58
    s_waitcnt vmcnt(10)
    v_dot2_f32_bf16 v51, v28, v5, 0
    v_dot2_f32_bf16 v59, v28, v28, 0
    v_dot2_f32_bf16 v51, v29, v5, v51
    v_dot2_f32_bf16 v59, v29, v29, v59
    v_dot2_f32_bf16 v51, v30, v5, v51
    v_dot2_f32_bf16 v59, v30, v30, v59
    v_dot2_f32_bf16 v51, v31, v5, v51
    v_dot2_f32_bf16 v59, v31, v31, v59
    s_waitcnt vmcnt(9)
    v_dot2_f32_bf16 v52, v32, v5, 0
    v_dot2_f32_bf16 v60, v32, v32, 0
    v_dot2_f32_bf16 v52, v33, v5, v52
    v_dot2_f32_bf16 v60, v33, v33, v60
    v_dot2_f32_bf16 v52, v34, v5, v52
    v_dot2_f32_bf16 v60, v34, v34, v60
    v_dot2_f32_bf16 v52, v35, v5, v52
    v_dot2_f32_bf16 v60, v35, v35, v60
    s_waitcnt vmcnt(8)
    v_dot2_f32_bf16 v53, v36, v5, 0
    v_dot2_f32_bf16 v61, v36, v36, 0
    v_dot2_f32_bf16 v53, v37, v5, v53
    v_dot2_f32_bf16 v61, v37, v37, v61
    v_dot2_f32_bf16 v53, v38, v5, v53
    v_dot2_f32_bf16 v61, v38, v38, v61
    v_dot2_f32_bf16 v53, v39, v5, v53
    v_dot2_f32_bf16 v61, v39, v39, v61
    s_waitcnt vmcnt(7)
    v_dot2_f32_bf16 v54, v40, v5, 0
    v_dot2_f32_bf16 v62, v40, v40, 0
    v_dot2_f32_bf16 v54, v41, v5, v54
    v_dot2_f32_bf16 v62, v41, v41, v62
    v_dot2_f32_bf16 v54, v42, v5, v54
    v_dot2_f32_bf16 v62, v42, v42, v62
    v_dot2_f32_bf16 v54, v43, v5, v54
    v_dot2_f32_bf16 v62, v43, v43, v62
    s_waitcnt vmcnt(6)
    v_dot2_f32_bf16 v55, v44, v5, 0
    v_dot2_f32_bf16 v63, v44, v44, 0
    v_dot2_f32_bf16 v55, v45, v5, v55
    v_dot2_f32_bf16 v63, v45, v45, v63
    v_dot2_f32_bf16 v55, v46, v5, v55
    v_dot2_f32_bf16 v63, v46, v46, v63
    v_dot2_f32_bf16 v55, v47, v5, v55
    v_dot2_f32_bf16 v63, v47, v47, v63
    s_nop 1
    v_permlane32_swap_b32 v48, v56
    v_permlane32_swap_b32 v49, v57
    v_permlane32_swap_b32 v50, v58
    v_permlane32_swap_b32 v51, v59
    v_permlane32_swap_b32 v52, v60
    v_permlane32_swap_b32 v53, v61
    v_permlane32_swap_b32 v54, v62
    v_permlane32_swap_b32 v55, v63
    v_add_f32 v48, v48, v56
    v_add_f32 v49, v49, v57
    v_add_f32 v50, v50, v58
    v_add_f32 v51, v51, v59
    v_add_f32 v52, v52, v60
    v_add_f32 v53, v53, v61
    v_add_f32 v54, v54, v62
    v_add_f32 v55, v55, v63
    v_permlane16_swap_b32 v48, v52
    v_permlane16_swap_b32 v49, v53
    v_permlane16_swap_b32 v50, v54
    v_permlane16_swap_b32 v51, v55
    v_add_f32 v48, v48, v52
    v_add_f32 v49, v49, v53
    v_add_f32 v50, v50, v54
    v_add_f32 v51, v51, v55
    v_add_f32_dpp v48, v48, v48 row_ror:8 row_mask:0xf bank_mask:0xf
    v_add_f32_dpp v49, v49, v49 row_ror:8 row_mask:0xf bank_mask:0xf
    v_add_f32_dpp v50, v50, v50 row_ror:8 row_mask:0xf bank_mask:0xf
    v_add_f32_dpp v51, v51, v51 row_ror:8 row_mask:0xf bank_mask:0xf
    v_add_f32_dpp v48, v48, v48 row_ror:4 row_mask:0xf bank_mask:0xf
    v_add_f32_dpp v49, v49, v49 row_ror:4 row_mask:0xf bank_mask:0xf
    v_add_f32_dpp v50, v50, v50 row_ror:4 row_mask:0xf bank_mask:0xf
    v_add_f32_dpp v51, v51, v51 row_ror:4 row_mask:0xf bank_mask:0xf
    v_add_f32_dpp v48, v48, v48 row_ror:2 row_mask:0xf bank_mask:0xf
    v_add_f32_dpp v49, v49, v49 row_ror:2 row_mask:0xf bank_mask:0xf
    v_add_f32_dpp v50, v50, v50 row_ror:2 row_mask:0xf bank_mask:0xf
    v_add_f32_dpp v51, v51, v51 row_ror:2 row_mask:0xf bank_mask:0xf
    v_add_f32_dpp v48, v48, v48 row_ror:1 row_mask:0xf bank_mask:0xf
    v_add_f32_dpp v49, v49, v49 row_ror:1 row_mask:0xf bank_mask:0xf
    v_add_f32_dpp v50, v50, v50 row_ror:1 row_mask:0xf bank_mask:0xf
    v_add_f32_dpp v51, v51, v51 row_ror:1 row_mask:0xf bank_mask:0xf
    v_mov_b32 v56, v48
    v_mov_b32 v57, v49
    v_mov_b32 v58, v50
    v_mov_b32 v59, v51
    s_nop 0
    v_permlane32_swap_b32 v48, v56
    v_permlane32_swap_b32 v49, v57
    v_permlane32_swap_b32 v50, v58
    v_permlane32_swap_b32 v51, v59
    v_mov_b32 v6, 0x3727c5ac
    v_mul_f32 v48, 0x3b000000, v48
    v_mul_f32 v49, 0x3b000000, v49
    v_mul_f32 v50, 0x3b000000, v50
    v_mul_f32 v51, 0x3b000000, v51
    v_fmamk_f32 v56, v56, 0x3b000000, v6
    v_fmamk_f32 v57, v57, 0x3b000000, v6
    v_fmamk_f32 v58, v58, 0x3b000000, v6
    v_fmamk_f32 v59, v59, 0x3b000000, v6
    v_fma_f32 v56, -v48, v48, v56
    v_fma_f32 v57, -v49, v49, v57
    v_fma_f32 v58, -v50, v50, v58
    v_fma_f32 v59, -v51, v51, v59
    v_rsq_f32 v8, v56
    v_rsq_f32 v9, v57
    v_rsq_f32 v12, v58
    v_rsq_f32 v13, v59
    s_nop 0
    v_mul_f32 v10, -v48, v8
    v_mul_f32 v11, -v49, v9
    v_mul_f32 v14, -v50, v12
    v_mul_f32 v15, -v51, v13
    v_lshlrev_b32 v7, 9, v2
    s_lshl_b32 s9, s16, 4
    s_add_u32 s9, s9, 2097152
    s_add_u32 s10, s9, 4096
    s_mov_b64 exec, 0x10001
    buffer_store_dwordx4 v[8:11], v7, s[4:7], s9 offen sc1
    buffer_store_dwordx4 v[12:15], v7, s[4:7], s10 offen sc1
    s_mov_b64 exec, -1

    s_waitcnt vmcnt(2)
K1_join:
    v_mov_b32 v98, 0

    v_mul_f32 v108, 0x3fb8aa3b, v108
    v_mul_f32 v104, 0x3fb8aa3b, v104
    v_exp_f32 v108, v108
    v_exp_f32 v104, v104
    s_nop 0
    v_cvt_pk_bf16_f32 v110, v108, v104
    v_lshlrev_b32 v108, 16, v110
    v_and_b32 v104, 0xffff0000, v110
    v_mul_f32 v104, v104, v108
    v_mul_f32 v104, 0xbfb8aa3b, v104
    v_mul_f32 v105, v105, v108
    v_mul_f32 v105, 0x3e22f983, v105
    v_add_f32 v108, v108, v108

    v_mul_f32 v184, 0x3f800000, v104
    v_mul_f32 v185, 0x3f800000, v105
    v_exp_f32 v184, v184
    v_fract_f32 v185, v185
    v_cos_f32 v130, v185
    v_sin_f32 v131, v185

    v_mul_f32 v186, 0x41800000, v104
    v_mul_f32 v187, 0x41800000, v105
    v_exp_f32 v186, v186
    v_fract_f32 v187, v187
    v_cos_f32 v160, v187
    v_sin_f32 v161, v187

    v_mul_f32 v188, 0x43800000, v104
    v_mul_f32 v189, 0x43800000, v105
    v_exp_f32 v188, v188
    v_fract_f32 v189, v189
    v_cos_f32 v166, v189
    v_sin_f32 v167, v189

    v_pk_mul_f32 v[130:131], v[130:131], v[184:185] op_sel_hi:[1,0]
    v_pk_mul_f32 v[160:161], v[160:161], v[186:187] op_sel_hi:[1,0]
    v_pk_mul_f32 v[166:167], v[166:167], v[188:189] op_sel_hi:[1,0]
    v_pk_mul_f32 v[180:181], v[106:107], v[108:109] op_sel_hi:[1,0]
    v_and_b32 v126, 127, v0
    v_cmp_eq_u32 vcc, 63, v126
    s_nop 1
    v_cndmask_b32 v125, 0, v125, vcc
    v_cvt_pk_bf16_f32 v192, v130, v131
    ds_write_addtid_b32 v192 offset:544
    v_cvt_pk_bf16_f32 v193, v180, -v181
    ds_write_addtid_b32 v193 offset:25568
    v_cvt_pk_bf16_f32 v194, v166, v167
    ds_write_addtid_b32 v194 offset:8704
    v_pk_mul_f32 v[184:185], v[130:131], v[130:131] op_sel:[0,0] op_sel_hi:[1,0]
    v_pk_fma_f32 v[132:133], v[130:131], v[130:131], v[184:185] op_sel:[1,1,0] op_sel_hi:[0,1,1] neg_lo:[1,0,0]
    v_cvt_pk_bf16_f32 v195, v132, v133
    ds_write_addtid_b32 v195 offset:1088
    v_pk_mul_f32 v[186:187], v[180:181], v[160:161] op_sel:[0,0] op_sel_hi:[1,0]
    v_pk_fma_f32 v[182:183], v[180:181], v[160:161], v[186:187] op_sel:[1,1,0] op_sel_hi:[0,1,1] neg_lo:[1,0,0]
    v_cvt_pk_bf16_f32 v196, v182, -v183
    ds_write_addtid_b32 v196 offset:26112
    v_pk_mul_f32 v[184:185], v[166:167], v[166:167] op_sel:[0,0] op_sel_hi:[1,0]
    v_pk_fma_f32 v[168:169], v[166:167], v[166:167], v[184:185] op_sel:[1,1,0] op_sel_hi:[0,1,1] neg_lo:[1,0,0]
    v_cvt_pk_bf16_f32 v197, v168, v169
    ds_write_addtid_b32 v197 offset:13600
    v_pk_mul_f32 v[186:187], v[130:131], v[132:133] op_sel:[0,0] op_sel_hi:[1,0]
    v_pk_fma_f32 v[134:135], v[130:131], v[132:133], v[186:187] op_sel:[1,1,0] op_sel_hi:[0,1,1] neg_lo:[1,0,0]
    v_cvt_pk_bf16_f32 v198, v134, v135
    ds_write_addtid_b32 v198 offset:1632
    v_pk_mul_f32 v[184:185], v[182:183], v[160:161] op_sel:[0,0] op_sel_hi:[1,0]
    v_pk_fma_f32 v[180:181], v[182:183], v[160:161], v[184:185] op_sel:[1,1,0] op_sel_hi:[0,1,1] neg_lo:[1,0,0]
    v_cvt_pk_bf16_f32 v199, v180, -v181
    ds_write_addtid_b32 v199 offset:26656
    v_pk_mul_f32 v[186:187], v[166:167], v[168:169] op_sel:[0,0] op_sel_hi:[1,0]
    v_pk_fma_f32 v[170:171], v[166:167], v[168:169], v[186:187] op_sel:[1,1,0] op_sel_hi:[0,1,1] neg_lo:[1,0,0]
    v_cvt_pk_bf16_f32 v192, v170, v171
    ds_write_addtid_b32 v192 offset:16320
    global_load_dwordx2 v[96:97], v98, s[44:45] offset:128 sc1
    v_pk_mul_f32 v[184:185], v[132:133], v[132:133] op_sel:[0,0] op_sel_hi:[1,0]
    v_pk_fma_f32 v[136:137], v[132:133], v[132:133], v[184:185] op_sel:[1,1,0] op_sel_hi:[0,1,1] neg_lo:[1,0,0]
    v_cvt_pk_bf16_f32 v193, v136, v137
    ds_write_addtid_b32 v193 offset:2176
    v_pk_mul_f32 v[186:187], v[180:181], v[160:161] op_sel:[0,0] op_sel_hi:[1,0]
    v_pk_fma_f32 v[182:183], v[180:181], v[160:161], v[186:187] op_sel:[1,1,0] op_sel_hi:[0,1,1] neg_lo:[1,0,0]
    v_cvt_pk_bf16_f32 v194, v182, -v183
    ds_write_addtid_b32 v194 offset:27200
    v_pk_mul_f32 v[184:185], v[168:169], v[168:169] op_sel:[0,0] op_sel_hi:[1,0]
    v_pk_fma_f32 v[172:173], v[168:169], v[168:169], v[184:185] op_sel:[1,1,0] op_sel_hi:[0,1,1] neg_lo:[1,0,0]
    v_cvt_pk_bf16_f32 v195, v172, v173
    ds_write_addtid_b32 v195 offset:19040
    v_pk_mul_f32 v[186:187], v[132:133], v[134:135] op_sel:[0,0] op_sel_hi:[1,0]
    v_pk_fma_f32 v[138:139], v[132:133], v[134:135], v[186:187] op_sel:[1,1,0] op_sel_hi:[0,1,1] neg_lo:[1,0,0]
    v_cvt_pk_bf16_f32 v196, v138, v139
    ds_write_addtid_b32 v196 offset:2720
    v_pk_mul_f32 v[184:185], v[182:183], v[160:161] op_sel:[0,0] op_sel_hi:[1,0]
    v_pk_fma_f32 v[180:181], v[182:183], v[160:161], v[184:185] op_sel:[1,1,0] op_sel_hi:[0,1,1] neg_lo:[1,0,0]
    v_cvt_pk_bf16_f32 v197, v180, -v181
    ds_write_addtid_b32 v197 offset:27744
    v_pk_mul_f32 v[186:187], v[168:169], v[170:171] op_sel:[0,0] op_sel_hi:[1,0]
    v_pk_fma_f32 v[174:175], v[168:169], v[170:171], v[186:187] op_sel:[1,1,0] op_sel_hi:[0,1,1] neg_lo:[1,0,0]
    v_cvt_pk_bf16_f32 v198, v174, v175
    ds_write_addtid_b32 v198 offset:20672
    v_pk_mul_f32 v[184:185], v[134:135], v[134:135] op_sel:[0,0] op_sel_hi:[1,0]
    v_pk_fma_f32 v[140:141], v[134:135], v[134:135], v[184:185] op_sel:[1,1,0] op_sel_hi:[0,1,1] neg_lo:[1,0,0]
    v_cvt_pk_bf16_f32 v199, v140, v141
    ds_write_addtid_b32 v199 offset:3264
    v_pk_mul_f32 v[186:187], v[180:181], v[160:161] op_sel:[0,0] op_sel_hi:[1,0]
    v_pk_fma_f32 v[182:183], v[180:181], v[160:161], v[186:187] op_sel:[1,1,0] op_sel_hi:[0,1,1] neg_lo:[1,0,0]
    v_cvt_pk_bf16_f32 v192, v182, -v183
    ds_write_addtid_b32 v192 offset:28288
    v_pk_mul_f32 v[184:185], v[170:171], v[170:171] op_sel:[0,0] op_sel_hi:[1,0]
    v_pk_fma_f32 v[176:177], v[170:171], v[170:171], v[184:185] op_sel:[1,1,0] op_sel_hi:[0,1,1] neg_lo:[1,0,0]
    v_cvt_pk_bf16_f32 v193, v176, v177
    ds_write_addtid_b32 v193 offset:22304
    v_pk_mul_f32 v[186:187], v[134:135], v[136:137] op_sel:[0,0] op_sel_hi:[1,0]
    v_pk_fma_f32 v[142:143], v[134:135], v[136:137], v[186:187] op_sel:[1,1,0] op_sel_hi:[0,1,1] neg_lo:[1,0,0]
    v_cvt_pk_bf16_f32 v194, v142, v143
    ds_write_addtid_b32 v194 offset:3808
    v_pk_mul_f32 v[184:185], v[182:183], v[160:161] op_sel:[0,0] op_sel_hi:[1,0]
    v_pk_fma_f32 v[180:181], v[182:183], v[160:161], v[184:185] op_sel:[1,1,0] op_sel_hi:[0,1,1] neg_lo:[1,0,0]
    v_cvt_pk_bf16_f32 v195, v180, -v181
    ds_write_addtid_b32 v195 offset:28832
    v_pk_mul_f32 v[186:187], v[170:171], v[172:173] op_sel:[0,0] op_sel_hi:[1,0]
    v_pk_fma_f32 v[178:179], v[170:171], v[172:173], v[186:187] op_sel:[1,1,0] op_sel_hi:[0,1,1] neg_lo:[1,0,0]
    v_cvt_pk_bf16_f32 v196, v178, v179
    ds_write_addtid_b32 v196 offset:23936
    v_pk_mul_f32 v[184:185], v[136:137], v[136:137] op_sel:[0,0] op_sel_hi:[1,0]
    v_pk_fma_f32 v[144:145], v[136:137], v[136:137], v[184:185] op_sel:[1,1,0] op_sel_hi:[0,1,1] neg_lo:[1,0,0]
    v_cvt_pk_bf16_f32 v197, v144, v145
    ds_write_addtid_b32 v197 offset:4352
    v_pk_mul_f32 v[186:187], v[180:181], v[160:161] op_sel:[0,0] op_sel_hi:[1,0]
    v_pk_fma_f32 v[182:183], v[180:181], v[160:161], v[186:187] op_sel:[1,1,0] op_sel_hi:[0,1,1] neg_lo:[1,0,0]
    v_cvt_pk_bf16_f32 v198, v182, -v183
    ds_write_addtid_b32 v198 offset:29376
    v_pk_mul_f32 v[184:185], v[136:137], v[138:139] op_sel:[0,0] op_sel_hi:[1,0]
    v_pk_fma_f32 v[146:147], v[136:137], v[138:139], v[184:185] op_sel:[1,1,0] op_sel_hi:[0,1,1] neg_lo:[1,0,0]
    v_cvt_pk_bf16_f32 v199, v146, v147
    ds_write_addtid_b32 v199 offset:4896
    v_pk_mul_f32 v[186:187], v[182:183], v[160:161] op_sel:[0,0] op_sel_hi:[1,0]
    v_pk_fma_f32 v[180:181], v[182:183], v[160:161], v[186:187] op_sel:[1,1,0] op_sel_hi:[0,1,1] neg_lo:[1,0,0]
    v_cvt_pk_bf16_f32 v192, v180, -v181
    ds_write_addtid_b32 v192 offset:29920
    s_cmp_ge_u32 s2, 224
    s_cbranch_scc1 K1_npub
    s_waitcnt vmcnt(0)
    v_cmp_ne_u32 vcc, 1, v97
    s_cbranch_vccz K1_nw_x
    s_mov_b32 s73, 0
K1_nw:
    global_load_dwordx2 v[96:97], v98, s[44:45] offset:128 sc1
    s_add_u32 s73, s73, 1
    s_waitcnt vmcnt(0)
    v_cmp_ne_u32 vcc, 1, v97
    s_cmp_gt_u32 s73, 0x40000
    s_cbranch_scc1 K1_nw_x
    s_cbranch_vccnz K1_nw
K1_nw_x:

    s_barrier
    v_readfirstlane_b32 s30, v96
    v_lshlrev_b32 v97, 2, v2
    s_cmp_eq_u32 s3, 1
    s_cbranch_scc0 K1_npub
    s_mov_b64 exec, s[26:27]
    buffer_store_dword v96, v97, s[4:7], s19 offen sc1
    s_mov_b64 exec, -1
K1_npub:

    v_pk_mul_f32 v[184:185], v[138:139], v[138:139] op_sel:[0,0] op_sel_hi:[1,0]
    v_pk_fma_f32 v[148:149], v[138:139], v[138:139], v[184:185] op_sel:[1,1,0] op_sel_hi:[0,1,1] neg_lo:[1,0,0]
    v_cvt_pk_bf16_f32 v193, v148, v149
    ds_write_addtid_b32 v193 offset:5440
    v_pk_mul_f32 v[186:187], v[180:181], v[160:161] op_sel:[0,0] op_sel_hi:[1,0]
    v_pk_fma_f32 v[182:183], v[180:181], v[160:161], v[186:187] op_sel:[1,1,0] op_sel_hi:[0,1,1] neg_lo:[1,0,0]
    v_cvt_pk_bf16_f32 v194, v182, -v183
    ds_write_addtid_b32 v194 offset:30464
    s_mov_b32 s8, s34
    s_mov_b32 s9, s35
    s_mov_b32 s10, s14
    s_mov_b32 s28, s77
    s_mov_b32 exec_hi, 0
    buffer_load_dwordx2 v[64:65], v250, s[12:15], s77 offen
    s_add_u32 s77, s77, 2752
    buffer_load_dwordx2 v[66:67], v250, s[12:15], s77 offen
    s_add_u32 s77, s77, 2752
    s_mov_b64 exec, -1
    v_pk_mul_f32 v[184:185], v[138:139], v[140:141] op_sel:[0,0] op_sel_hi:[1,0]
    v_pk_fma_f32 v[150:151], v[138:139], v[140:141], v[184:185] op_sel:[1,1,0] op_sel_hi:[0,1,1] neg_lo:[1,0,0]
    v_cvt_pk_bf16_f32 v195, v150, v151
    ds_write_addtid_b32 v195 offset:5984
    v_pk_mul_f32 v[186:187], v[182:183], v[160:161] op_sel:[0,0] op_sel_hi:[1,0]
    v_pk_fma_f32 v[180:181], v[182:183], v[160:161], v[186:187] op_sel:[1,1,0] op_sel_hi:[0,1,1] neg_lo:[1,0,0]
    v_cvt_pk_bf16_f32 v196, v180, -v181
    ds_write_addtid_b32 v196 offset:31008
    v_pk_mul_f32 v[184:185], v[140:141], v[140:141] op_sel:[0,0] op_sel_hi:[1,0]
    v_pk_fma_f32 v[152:153], v[140:141], v[140:141], v[184:185] op_sel:[1,1,0] op_sel_hi:[0,1,1] neg_lo:[1,0,0]
    v_cvt_pk_bf16_f32 v197, v152, v153
    ds_write_addtid_b32 v197 offset:6528
    v_pk_mul_f32 v[186:187], v[180:181], v[160:161] op_sel:[0,0] op_sel_hi:[1,0]
    v_pk_fma_f32 v[182:183], v[180:181], v[160:161], v[186:187] op_sel:[1,1,0] op_sel_hi:[0,1,1] neg_lo:[1,0,0]
    v_cvt_pk_bf16_f32 v198, v182, -v183
    ds_write_addtid_b32 v198 offset:31552
    s_mov_b32 exec_hi, 0
    buffer_load_dwordx2 v[68:69], v250, s[12:15], s77 offen
    s_add_u32 s77, s77, 2752
    buffer_load_dwordx2 v[70:71], v250, s[12:15], s77 offen
    s_add_u32 s77, s77, 2752
    s_mov_b64 exec, -1
    v_pk_mul_f32 v[184:185], v[140:141], v[142:143] op_sel:[0,0] op_sel_hi:[1,0]
    v_pk_fma_f32 v[154:155], v[140:141], v[142:143], v[184:185] op_sel:[1,1,0] op_sel_hi:[0,1,1] neg_lo:[1,0,0]
    v_cvt_pk_bf16_f32 v199, v154, v155
    ds_write_addtid_b32 v199 offset:7072
    v_pk_mul_f32 v[186:187], v[182:183], v[160:161] op_sel:[0,0] op_sel_hi:[1,0]
    v_pk_fma_f32 v[180:181], v[182:183], v[160:161], v[186:187] op_sel:[1,1,0] op_sel_hi:[0,1,1] neg_lo:[1,0,0]
    v_cvt_pk_bf16_f32 v192, v180, -v181
    ds_write_addtid_b32 v192 offset:32096
    v_pk_mul_f32 v[184:185], v[142:143], v[142:143] op_sel:[0,0] op_sel_hi:[1,0]
    v_pk_fma_f32 v[156:157], v[142:143], v[142:143], v[184:185] op_sel:[1,1,0] op_sel_hi:[0,1,1] neg_lo:[1,0,0]
    v_cvt_pk_bf16_f32 v193, v156, v157
    ds_write_addtid_b32 v193 offset:7616
    v_pk_mul_f32 v[186:187], v[180:181], v[160:161] op_sel:[0,0] op_sel_hi:[1,0]
    v_pk_fma_f32 v[182:183], v[180:181], v[160:161], v[186:187] op_sel:[1,1,0] op_sel_hi:[0,1,1] neg_lo:[1,0,0]
    v_cvt_pk_bf16_f32 v194, v182, -v183
    ds_write_addtid_b32 v194 offset:32640
    s_mov_b32 exec_hi, 0
    buffer_load_dwordx2 v[72:73], v250, s[12:15], s77 offen
    s_add_u32 s77, s77, 2752
    buffer_load_dwordx2 v[74:75], v250, s[12:15], s77 offen
    s_add_u32 s77, s77, 2752
    s_mov_b64 exec, -1
    v_pk_mul_f32 v[184:185], v[142:143], v[144:145] op_sel:[0,0] op_sel_hi:[1,0]
    v_pk_fma_f32 v[158:159], v[142:143], v[144:145], v[184:185] op_sel:[1,1,0] op_sel_hi:[0,1,1] neg_lo:[1,0,0]
    v_cvt_pk_bf16_f32 v195, v158, v159
    ds_write_addtid_b32 v195 offset:8160
    v_pk_mul_f32 v[186:187], v[182:183], v[160:161] op_sel:[0,0] op_sel_hi:[1,0]
    v_pk_fma_f32 v[180:181], v[182:183], v[160:161], v[186:187] op_sel:[1,1,0] op_sel_hi:[0,1,1] neg_lo:[1,0,0]
    v_cvt_pk_bf16_f32 v196, v180, -v181
    ds_write_addtid_b32 v196 offset:33184
    v_pk_mul_f32 v[184:185], v[180:181], v[160:161] op_sel:[0,0] op_sel_hi:[1,0]
    v_pk_fma_f32 v[182:183], v[180:181], v[160:161], v[184:185] op_sel:[1,1,0] op_sel_hi:[0,1,1] neg_lo:[1,0,0]
    v_cvt_pk_bf16_f32 v197, v182, -v183
    ds_write_addtid_b32 v197 offset:33728
    v_pk_mul_f32 v[186:187], v[166:167], v[132:133] op_sel:[0,0] op_sel_hi:[1,0]
    v_pk_fma_f32 v[190:191], v[166:167], v[132:133], v[186:187] op_sel:[1,1,0] op_sel_hi:[0,1,1] neg_lo:[1,0,0]
    v_cvt_pk_bf16_f32 v198, v190, v191
    ds_write_addtid_b32 v198 offset:9248
    s_mov_b32 exec_hi, 0
    buffer_load_dwordx2 v[76:77], v250, s[12:15], s77 offen
    s_add_u32 s77, s77, 2752
    buffer_load_dwordx2 v[78:79], v250, s[12:15], s77 offen
    s_add_u32 s77, s77, 2752
    s_mov_b64 exec, -1
    v_pk_mul_f32 v[184:185], v[166:167], v[136:137] op_sel:[0,0] op_sel_hi:[1,0]
    v_pk_fma_f32 v[188:189], v[166:167], v[136:137], v[184:185] op_sel:[1,1,0] op_sel_hi:[0,1,1] neg_lo:[1,0,0]
    v_cvt_pk_bf16_f32 v199, v188, v189
    ds_write_addtid_b32 v199 offset:9792
    v_pk_mul_f32 v[186:187], v[166:167], v[140:141] op_sel:[0,0] op_sel_hi:[1,0]
    v_pk_fma_f32 v[190:191], v[166:167], v[140:141], v[186:187] op_sel:[1,1,0] op_sel_hi:[0,1,1] neg_lo:[1,0,0]
    v_cvt_pk_bf16_f32 v192, v190, v191
    ds_write_addtid_b32 v192 offset:10336
    v_pk_mul_f32 v[184:185], v[166:167], v[144:145] op_sel:[0,0] op_sel_hi:[1,0]
    v_pk_fma_f32 v[188:189], v[166:167], v[144:145], v[184:185] op_sel:[1,1,0] op_sel_hi:[0,1,1] neg_lo:[1,0,0]
    v_cvt_pk_bf16_f32 v193, v188, v189
    ds_write_addtid_b32 v193 offset:10880
    v_pk_mul_f32 v[186:187], v[166:167], v[148:149] op_sel:[0,0] op_sel_hi:[1,0]
    v_pk_fma_f32 v[190:191], v[166:167], v[148:149], v[186:187] op_sel:[1,1,0] op_sel_hi:[0,1,1] neg_lo:[1,0,0]
    v_cvt_pk_bf16_f32 v194, v190, v191
    ds_write_addtid_b32 v194 offset:11424
    s_mov_b32 exec_lo, 0
    buffer_load_dwordx2 v[64:65], v250, s[8:11], s28 offen
    s_add_u32 s28, s28, 2752
    buffer_load_dwordx2 v[66:67], v250, s[8:11], s28 offen
    s_add_u32 s28, s28, 2752
    s_mov_b64 exec, -1
    v_pk_mul_f32 v[184:185], v[166:167], v[152:153] op_sel:[0,0] op_sel_hi:[1,0]
    v_pk_fma_f32 v[188:189], v[166:167], v[152:153], v[184:185] op_sel:[1,1,0] op_sel_hi:[0,1,1] neg_lo:[1,0,0]
    v_cvt_pk_bf16_f32 v195, v188, v189
    ds_write_addtid_b32 v195 offset:11968
    v_pk_mul_f32 v[186:187], v[166:167], v[156:157] op_sel:[0,0] op_sel_hi:[1,0]
    v_pk_fma_f32 v[190:191], v[166:167], v[156:157], v[186:187] op_sel:[1,1,0] op_sel_hi:[0,1,1] neg_lo:[1,0,0]
    v_cvt_pk_bf16_f32 v196, v190, v191
    ds_write_addtid_b32 v196 offset:12512
    v_pk_mul_f32 v[184:185], v[166:167], v[160:161] op_sel:[0,0] op_sel_hi:[1,0]
    v_pk_fma_f32 v[188:189], v[166:167], v[160:161], v[184:185] op_sel:[1,1,0] op_sel_hi:[0,1,1] neg_lo:[1,0,0]
    v_cvt_pk_bf16_f32 v197, v188, v189
    ds_write_addtid_b32 v197 offset:13056
    v_pk_mul_f32 v[186:187], v[168:169], v[136:137] op_sel:[0,0] op_sel_hi:[1,0]
    v_pk_fma_f32 v[190:191], v[168:169], v[136:137], v[186:187] op_sel:[1,1,0] op_sel_hi:[0,1,1] neg_lo:[1,0,0]
    v_cvt_pk_bf16_f32 v198, v190, v191
    ds_write_addtid_b32 v198 offset:14144
    s_mov_b32 exec_lo, 0
    buffer_load_dwordx2 v[68:69], v250, s[8:11], s28 offen
    s_add_u32 s28, s28, 2752
    buffer_load_dwordx2 v[70:71], v250, s[8:11], s28 offen
    s_add_u32 s28, s28, 2752
    s_mov_b64 exec, -1
    v_pk_mul_f32 v[184:185], v[168:169], v[144:145] op_sel:[0,0] op_sel_hi:[1,0]
    v_pk_fma_f32 v[188:189], v[168:169], v[144:145], v[184:185] op_sel:[1,1,0] op_sel_hi:[0,1,1] neg_lo:[1,0,0]
    v_cvt_pk_bf16_f32 v199, v188, v189
    ds_write_addtid_b32 v199 offset:14688
    v_pk_mul_f32 v[186:187], v[168:169], v[152:153] op_sel:[0,0] op_sel_hi:[1,0]
    v_pk_fma_f32 v[190:191], v[168:169], v[152:153], v[186:187] op_sel:[1,1,0] op_sel_hi:[0,1,1] neg_lo:[1,0,0]
    v_cvt_pk_bf16_f32 v192, v190, v191
    ds_write_addtid_b32 v192 offset:15232
    v_pk_mul_f32 v[184:185], v[168:169], v[160:161] op_sel:[0,0] op_sel_hi:[1,0]
    v_pk_fma_f32 v[188:189], v[168:169], v[160:161], v[184:185] op_sel:[1,1,0] op_sel_hi:[0,1,1] neg_lo:[1,0,0]
    v_cvt_pk_bf16_f32 v193, v188, v189
    ds_write_addtid_b32 v193 offset:15776
    v_pk_mul_f32 v[186:187], v[170:171], v[136:137] op_sel:[0,0] op_sel_hi:[1,0]
    v_pk_fma_f32 v[190:191], v[170:171], v[136:137], v[186:187] op_sel:[1,1,0] op_sel_hi:[0,1,1] neg_lo:[1,0,0]
    v_cvt_pk_bf16_f32 v194, v190, v191
    ds_write_addtid_b32 v194 offset:16864
    s_mov_b32 exec_lo, 0
    buffer_load_dwordx2 v[72:73], v250, s[8:11], s28 offen
    s_add_u32 s28, s28, 2752
    buffer_load_dwordx2 v[74:75], v250, s[8:11], s28 offen
    s_add_u32 s28, s28, 2752
    s_mov_b64 exec, -1
    v_pk_mul_f32 v[184:185], v[170:171], v[144:145] op_sel:[0,0] op_sel_hi:[1,0]
    v_pk_fma_f32 v[188:189], v[170:171], v[144:145], v[184:185] op_sel:[1,1,0] op_sel_hi:[0,1,1] neg_lo:[1,0,0]
    v_cvt_pk_bf16_f32 v195, v188, v189
    ds_write_addtid_b32 v195 offset:17408
    v_pk_mul_f32 v[186:187], v[170:171], v[152:153] op_sel:[0,0] op_sel_hi:[1,0]
    v_pk_fma_f32 v[190:191], v[170:171], v[152:153], v[186:187] op_sel:[1,1,0] op_sel_hi:[0,1,1] neg_lo:[1,0,0]
    v_cvt_pk_bf16_f32 v196, v190, v191
    ds_write_addtid_b32 v196 offset:17952
    v_pk_mul_f32 v[184:185], v[170:171], v[160:161] op_sel:[0,0] op_sel_hi:[1,0]
    v_pk_fma_f32 v[188:189], v[170:171], v[160:161], v[184:185] op_sel:[1,1,0] op_sel_hi:[0,1,1] neg_lo:[1,0,0]
    v_cvt_pk_bf16_f32 v197, v188, v189
    ds_write_addtid_b32 v197 offset:18496
    v_pk_mul_f32 v[186:187], v[172:173], v[144:145] op_sel:[0,0] op_sel_hi:[1,0]
    v_pk_fma_f32 v[190:191], v[172:173], v[144:145], v[186:187] op_sel:[1,1,0] op_sel_hi:[0,1,1] neg_lo:[1,0,0]
    v_cvt_pk_bf16_f32 v198, v190, v191
    ds_write_addtid_b32 v198 offset:19584
    s_mov_b32 exec_lo, 0
    buffer_load_dwordx2 v[76:77], v250, s[8:11], s28 offen
    s_add_u32 s28, s28, 2752
    buffer_load_dwordx2 v[78:79], v250, s[8:11], s28 offen
    s_add_u32 s28, s28, 2752
    s_mov_b64 exec, -1
    v_pk_mul_f32 v[184:185], v[172:173], v[160:161] op_sel:[0,0] op_sel_hi:[1,0]
    v_pk_fma_f32 v[188:189], v[172:173], v[160:161], v[184:185] op_sel:[1,1,0] op_sel_hi:[0,1,1] neg_lo:[1,0,0]
    v_cvt_pk_bf16_f32 v199, v188, v189
    ds_write_addtid_b32 v199 offset:20128
    v_pk_mul_f32 v[186:187], v[174:175], v[144:145] op_sel:[0,0] op_sel_hi:[1,0]
    v_pk_fma_f32 v[190:191], v[174:175], v[144:145], v[186:187] op_sel:[1,1,0] op_sel_hi:[0,1,1] neg_lo:[1,0,0]
    v_cvt_pk_bf16_f32 v192, v190, v191
    ds_write_addtid_b32 v192 offset:21216
    v_pk_mul_f32 v[184:185], v[174:175], v[160:161] op_sel:[0,0] op_sel_hi:[1,0]
    v_pk_fma_f32 v[188:189], v[174:175], v[160:161], v[184:185] op_sel:[1,1,0] op_sel_hi:[0,1,1] neg_lo:[1,0,0]
    v_cvt_pk_bf16_f32 v193, v188, v189
    ds_write_addtid_b32 v193 offset:21760
    v_pk_mul_f32 v[186:187], v[176:177], v[144:145] op_sel:[0,0] op_sel_hi:[1,0]
    v_pk_fma_f32 v[190:191], v[176:177], v[144:145], v[186:187] op_sel:[1,1,0] op_sel_hi:[0,1,1] neg_lo:[1,0,0]
    v_cvt_pk_bf16_f32 v194, v190, v191
    ds_write_addtid_b32 v194 offset:22848
    v_pk_mul_f32 v[184:185], v[176:177], v[160:161] op_sel:[0,0] op_sel_hi:[1,0]
    v_pk_fma_f32 v[188:189], v[176:177], v[160:161], v[184:185] op_sel:[1,1,0] op_sel_hi:[0,1,1] neg_lo:[1,0,0]
    v_cvt_pk_bf16_f32 v195, v188, v189
    ds_write_addtid_b32 v195 offset:23392
    v_pk_mul_f32 v[186:187], v[178:179], v[144:145] op_sel:[0,0] op_sel_hi:[1,0]
    v_pk_fma_f32 v[190:191], v[178:179], v[144:145], v[186:187] op_sel:[1,1,0] op_sel_hi:[0,1,1] neg_lo:[1,0,0]
    v_cvt_pk_bf16_f32 v196, v190, v191
    ds_write_addtid_b32 v196 offset:24480
    v_pk_mul_f32 v[184:185], v[178:179], v[160:161] op_sel:[0,0] op_sel_hi:[1,0]
    v_pk_fma_f32 v[188:189], v[178:179], v[160:161], v[184:185] op_sel:[1,1,0] op_sel_hi:[0,1,1] neg_lo:[1,0,0]
    v_cvt_pk_bf16_f32 v197, v188, v189
    ds_write_addtid_b32 v197 offset:25024
    s_cmp_ge_u32 s2, 224
    s_cbranch_scc1 K1_wdp
K1_wdr:
    s_cmp_eq_u32 s3, 1
    v_accvgpr_read_b32 v3, a0
    v_accvgpr_read_b32 v4, a1
    v_accvgpr_read_b32 v8, a2
    v_accvgpr_read_b32 v10, a3
    v_accvgpr_read_b32 v11, a4
    v_accvgpr_read_b32 v12, a5
    v_accvgpr_read_b32 v13, a6
    v_accvgpr_read_b32 v14, a7
    v_accvgpr_read_b32 v40, a8
    v_accvgpr_read_b32 v41, a9
    v_accvgpr_read_b32 v42, a10
    v_accvgpr_read_b32 v43, a11
    v_accvgpr_read_b32 v44, a12
    v_accvgpr_read_b32 v45, a13
    v_accvgpr_read_b32 v46, a14
    v_accvgpr_read_b32 v47, a15
    v_accvgpr_read_b32 v58, a16
    v_accvgpr_read_b32 v59, a17
    v_accvgpr_read_b32 v60, a18
    v_accvgpr_read_b32 v61, a19
    s_waitcnt lgkmcnt(0)
    s_barrier
    ds_read_b128 v[128:131], v120 offset:0
    ds_read_b128 v[160:163], v116 offset:0
    ds_read_b128 v[132:135], v120 offset:64
    ds_read_b128 v[164:167], v116 offset:64
    ds_read_b128 v[136:139], v120 offset:128
    ds_read_b128 v[168:171], v116 offset:128
    ds_read_b128 v[140:143], v120 offset:192
    ds_read_b128 v[172:175], v116 offset:192
    ds_read_b128 v[144:147], v120 offset:256
    ds_read_b128 v[176:179], v116 offset:256
    ds_read_b128 v[148:151], v120 offset:320
    ds_read_b128 v[180:183], v116 offset:320
    ds_read_b128 v[152:155], v120 offset:384
    ds_read_b128 v[184:187], v116 offset:384
    ds_read_b128 v[156:159], v120 offset:448
    ds_read_b128 v[188:191], v116 offset:448
    s_waitcnt lgkmcnt(14)
    v_mfma_f32_16x16x32_bf16 v[224:227], v[160:163], v[128:131], 0
    ds_read_b128 v[192:195], v117 offset:0
    s_waitcnt lgkmcnt(13)
    v_mfma_f32_16x16x32_bf16 v[224:227], v[164:167], v[132:135], v[224:227]
    ds_read_b128 v[196:199], v117 offset:64
    s_waitcnt lgkmcnt(12)
    v_mfma_f32_16x16x32_bf16 v[224:227], v[168:171], v[136:139], v[224:227]
    ds_read_b128 v[200:203], v117 offset:128
    s_waitcnt lgkmcnt(11)
    v_mfma_f32_16x16x32_bf16 v[224:227], v[172:175], v[140:143], v[224:227]
    ds_read_b128 v[204:207], v117 offset:192
    s_waitcnt lgkmcnt(10)
    v_mfma_f32_16x16x32_bf16 v[224:227], v[176:179], v[144:147], v[224:227]
    ds_read_b128 v[208:211], v117 offset:256
    s_waitcnt lgkmcnt(9)
    v_mfma_f32_16x16x32_bf16 v[224:227], v[180:183], v[148:151], v[224:227]
    ds_read_b128 v[212:215], v117 offset:320
    s_waitcnt lgkmcnt(8)
    v_mfma_f32_16x16x32_bf16 v[224:227], v[184:187], v[152:155], v[224:227]
    ds_read_b128 v[216:219], v117 offset:384
    s_waitcnt lgkmcnt(7)
    v_mfma_f32_16x16x32_bf16 v[224:227], v[188:191], v[156:159], v[224:227]
    ds_read_b128 v[220:223], v117 offset:448
    s_waitcnt lgkmcnt(7)
    v_mfma_f32_16x16x32_bf16 v[228:231], v[192:195], v[128:131], 0
    ds_read_b128 v[160:163], v118 offset:0
    s_waitcnt lgkmcnt(7)
    v_mfma_f32_16x16x32_bf16 v[228:231], v[196:199], v[132:135], v[228:231]
    ds_read_b128 v[164:167], v118 offset:64
    s_waitcnt lgkmcnt(7)
    v_mfma_f32_16x16x32_bf16 v[228:231], v[200:203], v[136:139], v[228:231]
    ds_read_b128 v[168:171], v118 offset:128
    v_add_f32 v227, v227, v125
    v_cvt_pk_bf16_f32 v240, v224, v225
    v_cvt_pk_bf16_f32 v241, v226, v227
    v_cvt_pk_bf16_f32 v112, v225, v226

    s_waitcnt lgkmcnt(7)
    v_mfma_f32_16x16x32_bf16 v[228:231], v[204:207], v[140:143], v[228:231]
    ds_read_b128 v[172:175], v118 offset:192
    s_waitcnt lgkmcnt(7)
    v_mfma_f32_16x16x32_bf16 v[228:231], v[208:211], v[144:147], v[228:231]
    ds_read_b128 v[176:179], v118 offset:256
    s_waitcnt lgkmcnt(7)
    v_mfma_f32_16x16x32_bf16 v[228:231], v[212:215], v[148:151], v[228:231]
    ds_read_b128 v[180:183], v118 offset:320
    s_waitcnt lgkmcnt(7)
    v_mfma_f32_16x16x32_bf16 v[228:231], v[216:219], v[152:155], v[228:231]
    ds_read_b128 v[184:187], v118 offset:384
    s_waitcnt lgkmcnt(7)
    v_mfma_f32_16x16x32_bf16 v[228:231], v[220:223], v[156:159], v[228:231]
    ds_read_b128 v[188:191], v118 offset:448
    s_waitcnt lgkmcnt(7)
    v_mfma_f32_16x16x32_bf16 v[232:235], v[160:163], v[128:131], 0
    ds_read_b128 v[192:195], v119 offset:0
    s_waitcnt lgkmcnt(7)
    v_mfma_f32_16x16x32_bf16 v[232:235], v[164:167], v[132:135], v[232:235]
    ds_read_b128 v[196:199], v119 offset:64
    s_waitcnt lgkmcnt(7)
    v_mfma_f32_16x16x32_bf16 v[232:235], v[168:171], v[136:139], v[232:235]
    ds_read_b128 v[200:203], v119 offset:128
    v_cvt_pk_bf16_f32 v242, v228, v229
    v_cvt_pk_bf16_f32 v243, v230, v231
    v_cvt_pk_bf16_f32 v113, v229, v230

    s_waitcnt lgkmcnt(7)
    v_mfma_f32_16x16x32_bf16 v[232:235], v[172:175], v[140:143], v[232:235]
    ds_read_b128 v[204:207], v119 offset:192
    s_waitcnt lgkmcnt(7)
    v_mfma_f32_16x16x32_bf16 v[232:235], v[176:179], v[144:147], v[232:235]
    ds_read_b128 v[208:211], v119 offset:256
    s_waitcnt lgkmcnt(7)
    v_mfma_f32_16x16x32_bf16 v[232:235], v[180:183], v[148:151], v[232:235]
    ds_read_b128 v[212:215], v119 offset:320
    s_waitcnt lgkmcnt(7)
    v_mfma_f32_16x16x32_bf16 v[232:235], v[184:187], v[152:155], v[232:235]
    ds_read_b128 v[216:219], v119 offset:384
    s_waitcnt lgkmcnt(7)
    v_mfma_f32_16x16x32_bf16 v[232:235], v[188:191], v[156:159], v[232:235]
    ds_read_b128 v[220:223], v119 offset:448
    s_waitcnt lgkmcnt(7)
    v_mfma_f32_16x16x32_bf16 v[236:239], v[192:195], v[128:131], 0
    s_waitcnt lgkmcnt(6)
    v_mfma_f32_16x16x32_bf16 v[236:239], v[196:199], v[132:135], v[236:239]
    s_waitcnt lgkmcnt(5)
    v_mfma_f32_16x16x32_bf16 v[236:239], v[200:203], v[136:139], v[236:239]
    v_cvt_pk_bf16_f32 v244, v232, v233
    v_cvt_pk_bf16_f32 v245, v234, v235
    v_cvt_pk_bf16_f32 v114, v233, v234

    s_cbranch_scc0 K1_np2
    buffer_load_dwordx4 v[16:19], v58, s[4:7], s51 offen sc1
K1_np2:
    s_cbranch_scc0 K1_poll_x
    s_waitcnt vmcnt(0)
    s_mov_b32 s73, 0
    s_branch K1_poll_c
K1_poll:
    buffer_load_dwordx4 v[16:19], v58, s[4:7], s51 offen sc1
    s_add_u32 s73, s73, 1
    s_waitcnt vmcnt(0)
K1_poll_c:
    v_xor_b32 v16, s30, v16
    v_xor_b32 v17, s30, v17
    v_xor_b32 v18, s30, v18
    v_xor_b32 v19, s30, v19
    v_or3_b32 v16, v16, v17, v18
    v_or_b32 v16, v16, v19
    v_cmpx_ne_u32 vcc, 0, v16
    s_cmp_gt_u32 s73, 0x40000
    s_cbranch_scc1 K1_poll_y
    s_cbranch_execnz K1_poll
K1_poll_y:
    s_mov_b64 exec, -1

K1_poll_x:
    s_waitcnt lgkmcnt(0)
    s_barrier
    buffer_load_dwordx4 v[16:19], v3, s[4:7], s76 offen sc1
    buffer_load_dwordx4 v[20:23], v3, s[4:7], s76 offen offset:64 sc1
    buffer_load_dword v49, off, s[4:7], s57 sc1
    buffer_load_dword v51, off, s[4:7], s57 offset:32 sc1
    buffer_load_dword v48, off, s[4:7], s57 offset:2048 sc1
    buffer_load_dword v50, off, s[4:7], s57 offset:2080 sc1
    buffer_load_dwordx4 v[24:27], v4, s[4:7], s53 offen sc1
    buffer_load_dwordx4 v[28:31], v4, s[4:7], s54 offen sc1
    buffer_load_dwordx4 v[32:35], v4, s[4:7], s55 offen sc1
    buffer_load_dwordx4 v[36:39], v4, s[4:7], s56 offen sc1
    s_mov_b32 s57, s69
    v_mfma_f32_16x16x32_bf16 v[236:239], v[204:207], v[140:143], v[236:239]
    ds_write_b64 v121, v[240:241] offset:1536
    ds_write_b32 v121, v112 offset:5696
    ds_write_b16 v121, v240 offset:5694
    ds_write_b16_d16_hi v121, v241 offset:5700

    v_mfma_f32_16x16x32_bf16 v[236:239], v[208:211], v[144:147], v[236:239]
    ds_write_b64 v121, v[242:243] offset:1024
    ds_write_b32 v121, v113 offset:5184
    ds_write_b16 v121, v242 offset:5182
    ds_write_b16_d16_hi v121, v243 offset:5188

    v_mfma_f32_16x16x32_bf16 v[236:239], v[212:215], v[148:151], v[236:239]
    ds_write_b64 v121, v[244:245] offset:512
    ds_write_b32 v121, v114 offset:4672
    ds_write_b16 v121, v244 offset:4670
    ds_write_b16_d16_hi v121, v245 offset:4676

    v_mfma_f32_16x16x32_bf16 v[236:239], v[216:219], v[152:155], v[236:239]
    ds_write_b32 v60, v255 offset:0
    ds_write_b32 v61, v255 offset:4096
    ds_write_b16 v59, v255 offset:4096
    v_mfma_f32_16x16x32_bf16 v[236:239], v[220:223], v[156:159], v[236:239]
    s_nop 7
    v_cvt_pk_bf16_f32 v246, v236, v237
    v_cvt_pk_bf16_f32 v247, v238, v239
    v_cvt_pk_bf16_f32 v115, v237, v238

    ds_write_b64 v121, v[246:247] offset:0
    ds_write_b32 v121, v115 offset:4160
    ds_write_b16 v121, v246 offset:4158
    ds_write_b16_d16_hi v121, v247 offset:4164

    buffer_load_dwordx4 v[224:227], v251, s[4:7], s57 offen sc1
    buffer_load_dwordx4 v[216:219], v251, s[4:7], s57 offen offset:2048 sc1
    buffer_load_dwordx4 v[228:231], v251, s[4:7], s57 offen offset:16 sc1
    buffer_load_dwordx4 v[220:223], v251, s[4:7], s57 offen offset:2064 sc1
    s_waitcnt vmcnt(14)
    v_mov_b64 v[200:201], v[64:65]
    v_mov_b64 v[202:203], v[66:67]
    v_mov_b64 v[204:205], v[68:69]
    v_mov_b64 v[206:207], v[70:71]
    v_mov_b64 v[208:209], v[72:73]
    v_mov_b64 v[210:211], v[74:75]
    v_mov_b64 v[212:213], v[76:77]
    v_mov_b64 v[214:215], v[78:79]
    s_waitcnt vmcnt(7)
    v_lshlrev_b32 v52, 16, v16
    v_and_b32 v53, 0xffff0000, v16
    v_pk_fma_f32 v[52:53], v[52:53], v[24:25], v[26:27]
    v_pk_fma_f32 v[52:53], v[52:53], v[48:49], v[48:49] op_sel:[0,0,1] op_sel_hi:[1,0,1]
    v_cvt_pk_bf16_f32 v56, v52, v53

    v_lshlrev_b32 v54, 16, v20
    v_and_b32 v55, 0xffff0000, v20
    v_pk_fma_f32 v[54:55], v[54:55], v[24:25], v[26:27]
    v_pk_fma_f32 v[54:55], v[54:55], v[50:51], v[50:51] op_sel:[0,0,1] op_sel_hi:[1,0,1]
    v_cvt_pk_bf16_f32 v60, v54, v55

    s_waitcnt vmcnt(6)
    v_lshlrev_b32 v52, 16, v17
    v_and_b32 v53, 0xffff0000, v17
    v_pk_fma_f32 v[52:53], v[52:53], v[28:29], v[30:31]
    v_pk_fma_f32 v[52:53], v[52:53], v[48:49], v[48:49] op_sel:[0,0,1] op_sel_hi:[1,0,1]
    v_cvt_pk_bf16_f32 v57, v52, v53

    v_lshlrev_b32 v54, 16, v21
    v_and_b32 v55, 0xffff0000, v21
    v_pk_fma_f32 v[54:55], v[54:55], v[28:29], v[30:31]
    v_pk_fma_f32 v[54:55], v[54:55], v[50:51], v[50:51] op_sel:[0,0,1] op_sel_hi:[1,0,1]
    v_cvt_pk_bf16_f32 v61, v54, v55

    s_waitcnt vmcnt(5)
    v_lshlrev_b32 v52, 16, v18
    v_and_b32 v53, 0xffff0000, v18
    v_pk_fma_f32 v[52:53], v[52:53], v[32:33], v[34:35]
    v_pk_fma_f32 v[52:53], v[52:53], v[48:49], v[48:49] op_sel:[0,0,1] op_sel_hi:[1,0,1]
    v_cvt_pk_bf16_f32 v58, v52, v53

    v_lshlrev_b32 v54, 16, v22
    v_and_b32 v55, 0xffff0000, v22
    v_pk_fma_f32 v[54:55], v[54:55], v[32:33], v[34:35]
    v_pk_fma_f32 v[54:55], v[54:55], v[50:51], v[50:51] op_sel:[0,0,1] op_sel_hi:[1,0,1]
    v_cvt_pk_bf16_f32 v62, v54, v55

    s_waitcnt vmcnt(4)
    v_lshlrev_b32 v52, 16, v19
    v_and_b32 v53, 0xffff0000, v19
    v_pk_fma_f32 v[52:53], v[52:53], v[36:37], v[38:39]
    v_pk_fma_f32 v[52:53], v[52:53], v[48:49], v[48:49] op_sel:[0,0,1] op_sel_hi:[1,0,1]
    v_cvt_pk_bf16_f32 v59, v52, v53

    v_lshlrev_b32 v54, 16, v23
    v_and_b32 v55, 0xffff0000, v23
    v_pk_fma_f32 v[54:55], v[54:55], v[36:37], v[38:39]
    v_pk_fma_f32 v[54:55], v[54:55], v[50:51], v[50:51] op_sel:[0,0,1] op_sel_hi:[1,0,1]
    v_cvt_pk_bf16_f32 v63, v54, v55

    ds_write_b128 v44, v[56:59]
    ds_write_b128 v44, v[60:63] offset:4608
    s_waitcnt lgkmcnt(0)
    s_barrier
    ds_read2_b32 v[96:97], v40 offset0:176 offset1:177
    ds_read2_b32 v[98:99], v40 offset0:178 offset1:179
    ds_read_b128 v[128:131], v12 offset:192
    ds_read_b128 v[132:135], v12 offset:704
    ds_read_b128 v[136:139], v12 offset:1216
    ds_read_b128 v[140:143], v12 offset:1728
    ds_read_b128 v[144:147], v12 offset:2240
    ds_read_b128 v[148:151], v12 offset:2752
    ds_read_b128 v[152:155], v12 offset:3264
    ds_read_b128 v[156:159], v12 offset:3776
    ds_read2_b32 v[100:101], v40 offset0:48 offset1:49
    ds_read2_b32 v[102:103], v40 offset0:50 offset1:51
    s_waitcnt lgkmcnt(9)
    v_mfma_f32_16x16x32_bf16 v[64:67], v[96:99], v[128:131], 0
    ds_read2_b32 v[104:105], v41 offset0:176 offset1:177
    ds_read2_b32 v[106:107], v41 offset0:178 offset1:179
    buffer_load_dword v63, off, s[4:7], s70 sc1
    s_waitcnt lgkmcnt(10)
    v_mfma_f32_16x16x32_bf16 v[68:71], v[96:99], v[132:135], 0
    ds_read2_b32 v[108:109], v41 offset0:48 offset1:49
    ds_read2_b32 v[110:111], v41 offset0:50 offset1:51
    s_waitcnt lgkmcnt(11)
    v_mfma_f32_16x16x32_bf16 v[72:75], v[96:99], v[136:139], 0
    ds_read2_b32 v[112:113], v42 offset0:176 offset1:177
    ds_read2_b32 v[114:115], v42 offset0:178 offset1:179
    s_waitcnt lgkmcnt(12)
    v_mfma_f32_16x16x32_bf16 v[76:79], v[96:99], v[140:143], 0
    ds_read2_b32 v[116:117], v42 offset0:48 offset1:49
    ds_read2_b32 v[118:119], v42 offset0:50 offset1:51
    s_waitcnt lgkmcnt(13)
    v_mfma_f32_16x16x32_bf16 v[80:83], v[96:99], v[144:147], 0
    ds_read2_b32 v[120:121], v43 offset0:176 offset1:177
    ds_read2_b32 v[122:123], v43 offset0:178 offset1:179
    buffer_load_dwordx2 v[192:193], v8, s[4:7], s59 offen sc1
    s_add_u32 s59, s59, 0x40000
    s_waitcnt lgkmcnt(14)
    v_mfma_f32_16x16x32_bf16 v[84:87], v[96:99], v[148:151], 0
    ds_read2_b32 v[124:125], v43 offset0:48 offset1:49
    ds_read2_b32 v[126:127], v43 offset0:50 offset1:51
    s_waitcnt lgkmcnt(15)
    v_mfma_f32_16x16x32_bf16 v[88:91], v[96:99], v[152:155], 0
    ds_read_b128 v[160:163], v12 offset:128
    s_waitcnt vmcnt(4)
    v_perm_b32 v52, v201, v200, v10
    v_perm_b32 v53, v201, v200, v11
    s_waitcnt lgkmcnt(15)
    v_mfma_f32_16x16x32_bf16 v[92:95], v[96:99], v[156:159], 0
    ds_read2_b32 v[96:97], v40 offset0:160 offset1:161
    v_perm_b32 v54, v201, v200, v14
    v_mul_f32 v56, v52, v216
    s_waitcnt lgkmcnt(14)
    v_mfma_f32_16x16x32_bf16 v[68:71], v[100:103], v[128:131], v[68:71]
    ds_read2_b32 v[98:99], v40 offset0:162 offset1:163
    v_mul_f32 v57, v53, v216
    v_mul_f32 v58, v54, v216
    buffer_load_dwordx2 v[194:195], v8, s[4:7], s59 offen sc1
    s_add_u32 s59, s59, 0x40000
    v_mfma_f32_16x16x32_bf16 v[72:75], v[100:103], v[132:135], v[72:75]
    ds_read_b128 v[164:167], v12 offset:640
    v_mul_f32 v247, v52, v224
    v_mul_f32 v248, v53, v224
    v_mfma_f32_16x16x32_bf16 v[76:79], v[100:103], v[136:139], v[76:79]
    ds_read_b128 v[168:171], v12 offset:1152
    v_mul_f32 v249, v54, v224
    v_perm_b32 v52, v203, v202, v10
    v_mfma_f32_16x16x32_bf16 v[80:83], v[100:103], v[140:143], v[80:83]
    ds_read_b128 v[172:175], v12 offset:1664
    v_perm_b32 v53, v203, v202, v11
    v_perm_b32 v54, v203, v202, v14
    v_mfma_f32_16x16x32_bf16 v[84:87], v[100:103], v[144:147], v[84:87]
    ds_read_b128 v[176:179], v12 offset:2176
    v_mul_f32 v59, v52, v217
    v_mul_f32 v60, v53, v217
    buffer_load_dwordx2 v[196:197], v8, s[4:7], s59 offen sc1
    s_add_u32 s59, s59, 0x40000
    v_mfma_f32_16x16x32_bf16 v[88:91], v[100:103], v[148:151], v[88:91]
    ds_read_b128 v[180:183], v12 offset:2688
    v_mul_f32 v61, v54, v217
    v_fmac_f32 v247, v52, v225
    v_mfma_f32_16x16x32_bf16 v[92:95], v[100:103], v[152:155], v[92:95]
    ds_read_b128 v[184:187], v12 offset:3200
    v_fmac_f32 v248, v53, v225
    v_fmac_f32 v249, v54, v225
    s_waitcnt lgkmcnt(15)
    v_mfma_f32_16x16x32_bf16 v[72:75], v[104:107], v[128:131], v[72:75]
    ds_read_b128 v[188:191], v12 offset:3712
    v_add_f32 v244, v56, v59
    v_add_f32 v245, v57, v60
    v_mfma_f32_16x16x32_bf16 v[76:79], v[104:107], v[132:135], v[76:79]
    ds_read2_b32 v[100:101], v40 offset0:32 offset1:33
    v_add_f32 v246, v58, v61
    v_cvt_pk_bf16_f32 v232, v56, v59
    buffer_load_dwordx2 v[198:199], v8, s[4:7], s59 offen sc1
    s_add_u32 s59, s59, 0x40000
    v_mfma_f32_16x16x32_bf16 v[80:83], v[104:107], v[136:139], v[80:83]
    ds_read2_b32 v[102:103], v40 offset0:34 offset1:35
    v_cvt_pk_bf16_f32 v236, v57, v60
    v_cvt_pk_bf16_f32 v240, v58, v61
    v_mfma_f32_16x16x32_bf16 v[84:87], v[104:107], v[140:143], v[84:87]
    v_cndmask_b32 v232, v232, v47, s[74:75]
    v_perm_b32 v52, v205, v204, v10
    v_perm_b32 v53, v205, v204, v11
    v_mfma_f32_16x16x32_bf16 v[88:91], v[104:107], v[144:147], v[88:91]
    v_perm_b32 v54, v205, v204, v14
    v_mul_f32 v56, v52, v218
    v_mul_f32 v57, v53, v218
    v_mfma_f32_16x16x32_bf16 v[92:95], v[104:107], v[148:151], v[92:95]
    ds_read2_b32 v[104:105], v41 offset0:160 offset1:161
    v_mul_f32 v58, v54, v218
    v_fmac_f32 v247, v52, v226
    v_mfma_f32_16x16x32_bf16 v[76:79], v[108:111], v[128:131], v[76:79]
    ds_read2_b32 v[106:107], v41 offset0:162 offset1:163
    v_fmac_f32 v248, v53, v226
    v_fmac_f32 v249, v54, v226
    v_mfma_f32_16x16x32_bf16 v[80:83], v[108:111], v[132:135], v[80:83]
    v_add_f32 v244, v244, v56
    v_add_f32 v245, v245, v57
    v_add_f32 v246, v246, v58
    v_mfma_f32_16x16x32_bf16 v[84:87], v[108:111], v[136:139], v[84:87]
    v_perm_b32 v52, v207, v206, v10
    v_perm_b32 v53, v207, v206, v11
    v_perm_b32 v54, v207, v206, v14
    v_mfma_f32_16x16x32_bf16 v[88:91], v[108:111], v[140:143], v[88:91]
    v_mul_f32 v59, v52, v219
    v_mul_f32 v60, v53, v219
    v_mul_f32 v61, v54, v219
    v_mfma_f32_16x16x32_bf16 v[92:95], v[108:111], v[144:147], v[92:95]
    ds_read2_b32 v[108:109], v41 offset0:32 offset1:33
    v_fmac_f32 v247, v52, v227
    v_fmac_f32 v248, v53, v227
    v_mfma_f32_16x16x32_bf16 v[80:83], v[112:115], v[128:131], v[80:83]
    ds_read2_b32 v[110:111], v41 offset0:34 offset1:35
    v_fmac_f32 v249, v54, v227
    v_add_f32 v244, v244, v59
    v_mfma_f32_16x16x32_bf16 v[84:87], v[112:115], v[132:135], v[84:87]
    v_add_f32 v245, v245, v60
    v_add_f32 v246, v246, v61
    v_cvt_pk_bf16_f32 v233, v56, v59
    v_mfma_f32_16x16x32_bf16 v[88:91], v[112:115], v[136:139], v[88:91]
    v_cvt_pk_bf16_f32 v237, v57, v60
    v_cvt_pk_bf16_f32 v241, v58, v61
    v_cndmask_b32 v233, v233, v47, s[74:75]
    v_mfma_f32_16x16x32_bf16 v[92:95], v[112:115], v[140:143], v[92:95]
    ds_read2_b32 v[112:113], v42 offset0:160 offset1:161
    s_waitcnt vmcnt(5)
    v_perm_b32 v52, v209, v208, v10
    v_perm_b32 v53, v209, v208, v11
    s_waitcnt lgkmcnt(15)
    v_mfma_f32_16x16x32_bf16 v[84:87], v[116:119], v[128:131], v[84:87]
    ds_read2_b32 v[114:115], v42 offset0:162 offset1:163
    v_perm_b32 v54, v209, v208, v14
    v_mul_f32 v56, v52, v220
    v_mfma_f32_16x16x32_bf16 v[88:91], v[116:119], v[132:135], v[88:91]
    v_mul_f32 v57, v53, v220
    v_mul_f32 v58, v54, v220
    v_fmac_f32 v247, v52, v228
    v_mfma_f32_16x16x32_bf16 v[92:95], v[116:119], v[136:139], v[92:95]
    ds_read2_b32 v[116:117], v42 offset0:32 offset1:33
    ds_read2_b32 v[118:119], v42 offset0:34 offset1:35
    v_fmac_f32 v248, v53, v228
    v_mfma_f32_16x16x32_bf16 v[88:91], v[120:123], v[128:131], v[88:91]
    v_fmac_f32 v249, v54, v228
    v_add_f32 v244, v244, v56
    v_add_f32 v245, v245, v57
    v_mfma_f32_16x16x32_bf16 v[92:95], v[120:123], v[132:135], v[92:95]
    ds_read2_b32 v[120:121], v43 offset0:160 offset1:161
    ds_read2_b32 v[122:123], v43 offset0:162 offset1:163
    v_add_f32 v246, v246, v58
    v_mfma_f32_16x16x32_bf16 v[92:95], v[124:127], v[128:131], v[92:95]
    ds_read2_b32 v[124:125], v43 offset0:32 offset1:33
    ds_read2_b32 v[126:127], v43 offset0:34 offset1:35
    v_perm_b32 v52, v211, v210, v10
    s_waitcnt lgkmcnt(15)
    v_mfma_f32_16x16x32_bf16 v[64:67], v[96:99], v[160:163], v[64:67]
    ds_read_b128 v[128:131], v12 offset:64
    v_perm_b32 v53, v211, v210, v11
    v_perm_b32 v54, v211, v210, v14
    v_mfma_f32_16x16x32_bf16 v[68:71], v[96:99], v[164:167], v[68:71]
    ds_read_b128 v[132:135], v12 offset:576
    v_mul_f32 v59, v52, v221
    v_mul_f32 v60, v53, v221
    v_mfma_f32_16x16x32_bf16 v[72:75], v[96:99], v[168:171], v[72:75]
    ds_read_b128 v[136:139], v12 offset:1088
    v_mul_f32 v61, v54, v221
    v_fmac_f32 v247, v52, v229
    v_mfma_f32_16x16x32_bf16 v[76:79], v[96:99], v[172:175], v[76:79]
    ds_read_b128 v[140:143], v12 offset:1600
    v_fmac_f32 v248, v53, v229
    v_fmac_f32 v249, v54, v229
    v_mfma_f32_16x16x32_bf16 v[80:83], v[96:99], v[176:179], v[80:83]
    ds_read_b128 v[144:147], v12 offset:2112
    v_add_f32 v244, v244, v59
    v_add_f32 v245, v245, v60
    v_mfma_f32_16x16x32_bf16 v[84:87], v[96:99], v[180:183], v[84:87]
    ds_read_b128 v[148:151], v12 offset:2624
    v_add_f32 v246, v246, v61
    v_cvt_pk_bf16_f32 v234, v56, v59
    v_mfma_f32_16x16x32_bf16 v[88:91], v[96:99], v[184:187], v[88:91]
    ds_read_b128 v[152:155], v12 offset:3136
    v_cvt_pk_bf16_f32 v238, v57, v60
    v_cvt_pk_bf16_f32 v242, v58, v61
    s_waitcnt lgkmcnt(15)
    v_mfma_f32_16x16x32_bf16 v[92:95], v[96:99], v[188:191], v[92:95]
    ds_read2_b32 v[96:97], v40 offset0:144 offset1:145
    v_cndmask_b32 v234, v234, v47, s[74:75]
    v_perm_b32 v52, v213, v212, v10
    v_mfma_f32_16x16x32_bf16 v[68:71], v[100:103], v[160:163], v[68:71]
    ds_read2_b32 v[98:99], v40 offset0:146 offset1:147
    v_perm_b32 v53, v213, v212, v11
    v_perm_b32 v54, v213, v212, v14
    v_mfma_f32_16x16x32_bf16 v[72:75], v[100:103], v[164:167], v[72:75]
    ds_read_b128 v[156:159], v12 offset:3648
    v_mul_f32 v56, v52, v222
    v_mul_f32 v57, v53, v222
    v_mfma_f32_16x16x32_bf16 v[76:79], v[100:103], v[168:171], v[76:79]
    v_mul_f32 v58, v54, v222
    v_fmac_f32 v247, v52, v230
    v_fmac_f32 v248, v53, v230
    v_mfma_f32_16x16x32_bf16 v[80:83], v[100:103], v[172:175], v[80:83]
    v_fmac_f32 v249, v54, v230
    v_add_f32 v244, v244, v56
    v_add_f32 v245, v245, v57
    v_mfma_f32_16x16x32_bf16 v[84:87], v[100:103], v[176:179], v[84:87]
    v_add_f32 v246, v246, v58
    v_perm_b32 v52, v215, v214, v10
    v_perm_b32 v53, v215, v214, v11
    v_mfma_f32_16x16x32_bf16 v[88:91], v[100:103], v[180:183], v[88:91]
    v_perm_b32 v54, v215, v214, v14
    v_mul_f32 v59, v52, v223
    v_mul_f32 v60, v53, v223
    v_mfma_f32_16x16x32_bf16 v[92:95], v[100:103], v[184:187], v[92:95]
    ds_read2_b32 v[100:101], v40 offset0:16 offset1:17
    v_mul_f32 v61, v54, v223
    v_fmac_f32 v247, v52, v231
    v_mfma_f32_16x16x32_bf16 v[72:75], v[104:107], v[160:163], v[72:75]
    ds_read2_b32 v[102:103], v40 offset0:18 offset1:19
    v_fmac_f32 v248, v53, v231
    v_fmac_f32 v249, v54, v231
    v_mfma_f32_16x16x32_bf16 v[76:79], v[104:107], v[164:167], v[76:79]
    v_add_f32 v244, v244, v59
    v_add_f32 v245, v245, v60
    v_add_f32 v246, v246, v61
    v_mfma_f32_16x16x32_bf16 v[80:83], v[104:107], v[168:171], v[80:83]
    v_cvt_pk_bf16_f32 v235, v56, v59
    v_cvt_pk_bf16_f32 v239, v57, v60
    v_cvt_pk_bf16_f32 v243, v58, v61
    v_mfma_f32_16x16x32_bf16 v[84:87], v[104:107], v[172:175], v[84:87]
    v_cndmask_b32 v235, v235, v47, s[74:75]
    buffer_store_dwordx4 v[236:239], v252, s[4:7], s64 offen offset:1024 sc1
    buffer_store_dwordx4 v[240:243], v254, s[4:7], s64 offen offset:2048 sc1
    v_mfma_f32_16x16x32_bf16 v[88:91], v[104:107], v[176:179], v[88:91]
    buffer_store_dwordx4 v[232:235], v252, s[4:7], s64 offen offset:0 sc1
    s_waitcnt vmcnt(3)
    v_lshlrev_b32 v16, 16, v192
    v_and_b32 v17, 0xffff0000, v192
    v_mfma_f32_16x16x32_bf16 v[92:95], v[104:107], v[180:183], v[92:95]
    ds_read2_b32 v[104:105], v41 offset0:144 offset1:145
    v_lshlrev_b32 v18, 16, v193
    v_and_b32 v19, 0xffff0000, v193
    v_mfma_f32_16x16x32_bf16 v[76:79], v[108:111], v[160:163], v[76:79]
    ds_read2_b32 v[106:107], v41 offset0:146 offset1:147
    v_lshlrev_b32 v20, 16, v194
    v_and_b32 v21, 0xffff0000, v194
    v_mfma_f32_16x16x32_bf16 v[80:83], v[108:111], v[164:167], v[80:83]
    v_lshlrev_b32 v22, 16, v195
    v_and_b32 v23, 0xffff0000, v195
    v_lshlrev_b32 v24, 16, v196
    v_mfma_f32_16x16x32_bf16 v[84:87], v[108:111], v[168:171], v[84:87]
    v_and_b32 v25, 0xffff0000, v196
    v_lshlrev_b32 v26, 16, v197
    v_and_b32 v27, 0xffff0000, v197
    v_mfma_f32_16x16x32_bf16 v[88:91], v[108:111], v[172:175], v[88:91]
    v_lshlrev_b32 v28, 16, v198
    v_and_b32 v29, 0xffff0000, v198
    v_lshlrev_b32 v30, 16, v199
    v_mfma_f32_16x16x32_bf16 v[92:95], v[108:111], v[176:179], v[92:95]
    ds_read2_b32 v[108:109], v41 offset0:16 offset1:17
    v_and_b32 v31, 0xffff0000, v199
    s_waitcnt lgkmcnt(15)
    v_mfma_f32_16x16x32_bf16 v[80:83], v[112:115], v[160:163], v[80:83]
    ds_read2_b32 v[110:111], v41 offset0:18 offset1:19
    v_mfma_f32_16x16x32_bf16 v[84:87], v[112:115], v[164:167], v[84:87]
    v_mfma_f32_16x16x32_bf16 v[88:91], v[112:115], v[168:171], v[88:91]
    v_mfma_f32_16x16x32_bf16 v[92:95], v[112:115], v[172:175], v[92:95]
    ds_read2_b32 v[112:113], v42 offset0:144 offset1:145
    v_mfma_f32_16x16x32_bf16 v[84:87], v[116:119], v[160:163], v[84:87]
    ds_read2_b32 v[114:115], v42 offset0:146 offset1:147
    v_mfma_f32_16x16x32_bf16 v[88:91], v[116:119], v[164:167], v[88:91]
    v_mfma_f32_16x16x32_bf16 v[92:95], v[116:119], v[168:171], v[92:95]
    ds_read2_b32 v[116:117], v42 offset0:16 offset1:17
    ds_read2_b32 v[118:119], v42 offset0:18 offset1:19
    v_mfma_f32_16x16x32_bf16 v[88:91], v[120:123], v[160:163], v[88:91]
    v_mfma_f32_16x16x32_bf16 v[92:95], v[120:123], v[164:167], v[92:95]
    ds_read2_b32 v[120:121], v43 offset0:144 offset1:145
    ds_read2_b32 v[122:123], v43 offset0:146 offset1:147
    v_mfma_f32_16x16x32_bf16 v[92:95], v[124:127], v[160:163], v[92:95]
    ds_read2_b32 v[124:125], v43 offset0:16 offset1:17
    ds_read2_b32 v[126:127], v43 offset0:18 offset1:19
    s_waitcnt lgkmcnt(15)
    v_mfma_f32_16x16x32_bf16 v[64:67], v[96:99], v[128:131], v[64:67]
    ds_read_b128 v[160:163], v12 offset:0
    v_mfma_f32_16x16x32_bf16 v[68:71], v[96:99], v[132:135], v[68:71]
    ds_read_b128 v[164:167], v12 offset:512
    v_mfma_f32_16x16x32_bf16 v[72:75], v[96:99], v[136:139], v[72:75]
    ds_read_b128 v[168:171], v12 offset:1024
    v_mfma_f32_16x16x32_bf16 v[76:79], v[96:99], v[140:143], v[76:79]
    ds_read_b128 v[172:175], v12 offset:1536
    v_mfma_f32_16x16x32_bf16 v[80:83], v[96:99], v[144:147], v[80:83]
    ds_read_b128 v[176:179], v12 offset:2048
    v_mfma_f32_16x16x32_bf16 v[84:87], v[96:99], v[148:151], v[84:87]
    ds_read_b128 v[180:183], v12 offset:2560
    v_mfma_f32_16x16x32_bf16 v[88:91], v[96:99], v[152:155], v[88:91]
    ds_read_b128 v[184:187], v12 offset:3072
    s_waitcnt lgkmcnt(15)
    v_mfma_f32_16x16x32_bf16 v[92:95], v[96:99], v[156:159], v[92:95]
    ds_read2_b32 v[96:97], v40 offset0:128 offset1:129
    v_mfma_f32_16x16x32_bf16 v[68:71], v[100:103], v[128:131], v[68:71]
    ds_read2_b32 v[98:99], v40 offset0:130 offset1:131
    v_mfma_f32_16x16x32_bf16 v[72:75], v[100:103], v[132:135], v[72:75]
    ds_read_b128 v[188:191], v12 offset:3584
    v_mfma_f32_16x16x32_bf16 v[76:79], v[100:103], v[136:139], v[76:79]
    v_mfma_f32_16x16x32_bf16 v[80:83], v[100:103], v[140:143], v[80:83]
    v_mfma_f32_16x16x32_bf16 v[84:87], v[100:103], v[144:147], v[84:87]
    v_mfma_f32_16x16x32_bf16 v[88:91], v[100:103], v[148:151], v[88:91]
    v_mfma_f32_16x16x32_bf16 v[92:95], v[100:103], v[152:155], v[92:95]
    ds_read2_b32 v[100:101], v40 offset0:0 offset1:1
    v_mfma_f32_16x16x32_bf16 v[72:75], v[104:107], v[128:131], v[72:75]
    ds_read2_b32 v[102:103], v40 offset0:2 offset1:3
    v_mfma_f32_16x16x32_bf16 v[76:79], v[104:107], v[132:135], v[76:79]
    v_mfma_f32_16x16x32_bf16 v[80:83], v[104:107], v[136:139], v[80:83]
    v_mfma_f32_16x16x32_bf16 v[84:87], v[104:107], v[140:143], v[84:87]
    v_mfma_f32_16x16x32_bf16 v[88:91], v[104:107], v[144:147], v[88:91]
    v_mfma_f32_16x16x32_bf16 v[92:95], v[104:107], v[148:151], v[92:95]
    ds_read2_b32 v[104:105], v41 offset0:128 offset1:129
    v_mfma_f32_16x16x32_bf16 v[76:79], v[108:111], v[128:131], v[76:79]
    ds_read2_b32 v[106:107], v41 offset0:130 offset1:131
    v_mfma_f32_16x16x32_bf16 v[80:83], v[108:111], v[132:135], v[80:83]
    v_mfma_f32_16x16x32_bf16 v[84:87], v[108:111], v[136:139], v[84:87]
    v_mfma_f32_16x16x32_bf16 v[88:91], v[108:111], v[140:143], v[88:91]
    v_mfma_f32_16x16x32_bf16 v[92:95], v[108:111], v[144:147], v[92:95]
    ds_read2_b32 v[108:109], v41 offset0:0 offset1:1
    s_waitcnt lgkmcnt(15)
    v_mfma_f32_16x16x32_bf16 v[80:83], v[112:115], v[128:131], v[80:83]
    ds_read2_b32 v[110:111], v41 offset0:2 offset1:3
    v_mfma_f32_16x16x32_bf16 v[84:87], v[112:115], v[132:135], v[84:87]
    v_mfma_f32_16x16x32_bf16 v[88:91], v[112:115], v[136:139], v[88:91]
    v_mfma_f32_16x16x32_bf16 v[92:95], v[112:115], v[140:143], v[92:95]
    ds_read2_b32 v[112:113], v42 offset0:128 offset1:129
    v_mfma_f32_16x16x32_bf16 v[84:87], v[116:119], v[128:131], v[84:87]
    ds_read2_b32 v[114:115], v42 offset0:130 offset1:131
    v_mfma_f32_16x16x32_bf16 v[88:91], v[116:119], v[132:135], v[88:91]
    v_mfma_f32_16x16x32_bf16 v[92:95], v[116:119], v[136:139], v[92:95]
    ds_read2_b32 v[116:117], v42 offset0:0 offset1:1
    ds_read2_b32 v[118:119], v42 offset0:2 offset1:3
    v_mfma_f32_16x16x32_bf16 v[88:91], v[120:123], v[128:131], v[88:91]
    s_waitcnt vmcnt(0)
    s_lshl_b32 s71, s2, 7
    s_add_u32 s71, s71, 2301952
    s_cmp_eq_u32 s3, 3
    v_mov_b32 v62, s30
    s_barrier
    s_cbranch_scc0 K2_nf
    s_mov_b64 exec, 1
    buffer_store_dword v62, off, s[4:7], s71 sc1
    s_mov_b64 exec, -1
K2_nf:

    v_mfma_f32_16x16x32_bf16 v[92:95], v[120:123], v[132:135], v[92:95]
    ds_read2_b32 v[120:121], v43 offset0:128 offset1:129
    ds_read2_b32 v[122:123], v43 offset0:130 offset1:131
    v_mfma_f32_16x16x32_bf16 v[92:95], v[124:127], v[128:131], v[92:95]
    ds_read2_b32 v[124:125], v43 offset0:0 offset1:1
    ds_read2_b32 v[126:127], v43 offset0:2 offset1:3
    s_waitcnt lgkmcnt(15)
    v_mfma_f32_16x16x32_bf16 v[64:67], v[96:99], v[160:163], v[64:67]
    v_mfma_f32_16x16x32_bf16 v[68:71], v[96:99], v[164:167], v[68:71]
    v_mfma_f32_16x16x32_bf16 v[72:75], v[96:99], v[168:171], v[72:75]
    v_mfma_f32_16x16x32_bf16 v[76:79], v[96:99], v[172:175], v[76:79]
    v_mfma_f32_16x16x32_bf16 v[80:83], v[96:99], v[176:179], v[80:83]
    v_mfma_f32_16x16x32_bf16 v[84:87], v[96:99], v[180:183], v[84:87]
    v_mfma_f32_16x16x32_bf16 v[88:91], v[96:99], v[184:187], v[88:91]
    s_waitcnt lgkmcnt(14)
    v_mfma_f32_16x16x32_bf16 v[92:95], v[96:99], v[188:191], v[92:95]
    s_waitcnt lgkmcnt(12)
    v_mfma_f32_16x16x32_bf16 v[68:71], v[100:103], v[160:163], v[68:71]
    v_mfma_f32_16x16x32_bf16 v[72:75], v[100:103], v[164:167], v[72:75]
    v_mfma_f32_16x16x32_bf16 v[76:79], v[100:103], v[168:171], v[76:79]
    v_mfma_f32_16x16x32_bf16 v[80:83], v[100:103], v[172:175], v[80:83]
    v_mfma_f32_16x16x32_bf16 v[84:87], v[100:103], v[176:179], v[84:87]
    v_mfma_f32_16x16x32_bf16 v[88:91], v[100:103], v[180:183], v[88:91]
    v_mfma_f32_16x16x32_bf16 v[92:95], v[100:103], v[184:187], v[92:95]
    s_waitcnt lgkmcnt(10)
    v_mfma_f32_16x16x32_bf16 v[72:75], v[104:107], v[160:163], v[72:75]
    v_mfma_f32_16x16x32_bf16 v[76:79], v[104:107], v[164:167], v[76:79]
    v_mfma_f32_16x16x32_bf16 v[80:83], v[104:107], v[168:171], v[80:83]
    v_mfma_f32_16x16x32_bf16 v[84:87], v[104:107], v[172:175], v[84:87]
    v_mfma_f32_16x16x32_bf16 v[88:91], v[104:107], v[176:179], v[88:91]
    v_mfma_f32_16x16x32_bf16 v[92:95], v[104:107], v[180:183], v[92:95]
    s_waitcnt lgkmcnt(8)
    v_mfma_f32_16x16x32_bf16 v[76:79], v[108:111], v[160:163], v[76:79]
    v_mfma_f32_16x16x32_bf16 v[80:83], v[108:111], v[164:167], v[80:83]
    v_mfma_f32_16x16x32_bf16 v[84:87], v[108:111], v[168:171], v[84:87]
    v_mfma_f32_16x16x32_bf16 v[88:91], v[108:111], v[172:175], v[88:91]
    v_mfma_f32_16x16x32_bf16 v[92:95], v[108:111], v[176:179], v[92:95]
    s_waitcnt lgkmcnt(6)
    v_mfma_f32_16x16x32_bf16 v[80:83], v[112:115], v[160:163], v[80:83]
    v_mfma_f32_16x16x32_bf16 v[84:87], v[112:115], v[164:167], v[84:87]
    v_mfma_f32_16x16x32_bf16 v[88:91], v[112:115], v[168:171], v[88:91]
    v_mfma_f32_16x16x32_bf16 v[92:95], v[112:115], v[172:175], v[92:95]
    s_waitcnt lgkmcnt(4)
    v_mfma_f32_16x16x32_bf16 v[84:87], v[116:119], v[160:163], v[84:87]
    v_mfma_f32_16x16x32_bf16 v[88:91], v[116:119], v[164:167], v[88:91]
    v_mfma_f32_16x16x32_bf16 v[92:95], v[116:119], v[168:171], v[92:95]
    s_waitcnt lgkmcnt(2)
    v_mfma_f32_16x16x32_bf16 v[88:91], v[120:123], v[160:163], v[88:91]
    v_mfma_f32_16x16x32_bf16 v[92:95], v[120:123], v[164:167], v[92:95]
    s_waitcnt lgkmcnt(0)
    v_mfma_f32_16x16x32_bf16 v[92:95], v[124:127], v[160:163], v[92:95]
    s_cmp_eq_u32 s49, 0
    s_cbranch_scc0 K2_hi
    s_nop 6

    ds_write_b128 v45, v[80:83] offset:25856
    ds_write_b128 v45, v[84:87] offset:26880
    ds_write_b128 v45, v[88:91] offset:27904
    ds_write_b128 v45, v[92:95] offset:28928
    v_fmac_f32 v16, v63, v64
    v_fmac_f32 v17, v63, v65
    v_fmac_f32 v18, v63, v66
    v_fmac_f32 v19, v63, v67
    v_fmac_f32 v20, v63, v68
    v_fmac_f32 v21, v63, v69
    v_fmac_f32 v22, v63, v70
    v_fmac_f32 v23, v63, v71
    v_fmac_f32 v24, v63, v72
    v_fmac_f32 v25, v63, v73
    v_fmac_f32 v26, v63, v74
    v_fmac_f32 v27, v63, v75
    v_fmac_f32 v28, v63, v76
    v_fmac_f32 v29, v63, v77
    v_fmac_f32 v30, v63, v78
    v_fmac_f32 v31, v63, v79
    s_branch K2_join
K2_hi:
    ds_write_b128 v45, v[64:67] offset:25856
    ds_write_b128 v45, v[68:71] offset:26880
    ds_write_b128 v45, v[72:75] offset:27904
    ds_write_b128 v45, v[76:79] offset:28928
    v_fmac_f32 v16, v63, v80
    v_fmac_f32 v17, v63, v81
    v_fmac_f32 v18, v63, v82
    v_fmac_f32 v19, v63, v83
    v_fmac_f32 v20, v63, v84
    v_fmac_f32 v21, v63, v85
    v_fmac_f32 v22, v63, v86
    v_fmac_f32 v23, v63, v87
    v_fmac_f32 v24, v63, v88
    v_fmac_f32 v25, v63, v89
    v_fmac_f32 v26, v63, v90
    v_fmac_f32 v27, v63, v91
    v_fmac_f32 v28, v63, v92
    v_fmac_f32 v29, v63, v93
    v_fmac_f32 v30, v63, v94
    v_fmac_f32 v31, v63, v95
K2_join:
    v_lshrrev_b32 v9, 2, v45
    v_lshlrev_b32 v62, 2, v0
    ds_write2st64_b32 v9, v244, v247 offset0:165 offset1:181
    ds_write2st64_b32 v9, v245, v248 offset0:166 offset1:182
    ds_write2st64_b32 v9, v246, v249 offset0:167 offset1:183
    s_bfe_u32 s71, s2, 0x20004
    s_and_b32 s28, s2, 1
    s_lshl_b32 s28, s28, 2
    s_add_u32 s71, s71, s28
    s_and_b32 s28, s2, 8
    s_add_u32 s71, s71, s28
    s_lshl_b32 s71, s71, 7
    s_add_u32 s31, s71, 2301952
    v_and_b32 v48, 15, v2
    v_lshlrev_b32 v48, 11, v48
    s_waitcnt lgkmcnt(0)
    s_barrier
    buffer_load_dword v61, v48, s[4:7], s31 offen sc1

    ds_read_b128 v[96:99], v46 offset:25856
    ds_read_b128 v[100:103], v46 offset:26880
    ds_read_b128 v[104:107], v46 offset:27904
    ds_read_b128 v[108:111], v46 offset:28928
    ds_read2st64_b32 v[56:57], v62 offset0:165 offset1:169
    ds_read2st64_b32 v[58:59], v62 offset0:173 offset1:177
    ds_read2st64_b32 v[52:53], v62 offset0:181 offset1:185
    ds_read2st64_b32 v[54:55], v62 offset0:189 offset1:193
    s_waitcnt lgkmcnt(7)
    v_fmac_f32 v16, v63, v96
    v_fmac_f32 v17, v63, v97
    v_fmac_f32 v18, v63, v98
    v_fmac_f32 v19, v63, v99
    v_cvt_pk_bf16_f32 v32, v16, v17
    v_cvt_pk_bf16_f32 v33, v18, v19
    buffer_store_dwordx2 v[32:33], v13, s[4:7], s58 offen offset:0 sc1

    s_waitcnt lgkmcnt(6)
    v_fmac_f32 v20, v63, v100
    v_fmac_f32 v21, v63, v101
    v_fmac_f32 v22, v63, v102
    v_fmac_f32 v23, v63, v103
    v_cvt_pk_bf16_f32 v34, v20, v21
    v_cvt_pk_bf16_f32 v35, v22, v23
    buffer_store_dwordx2 v[34:35], v13, s[4:7], s58 offen offset:512 sc1

    s_waitcnt lgkmcnt(5)
    v_fmac_f32 v24, v63, v104
    v_fmac_f32 v25, v63, v105
    v_fmac_f32 v26, v63, v106
    v_fmac_f32 v27, v63, v107
    v_cvt_pk_bf16_f32 v36, v24, v25
    v_cvt_pk_bf16_f32 v37, v26, v27
    buffer_store_dwordx2 v[36:37], v13, s[4:7], s58 offen offset:1024 sc1

    s_waitcnt lgkmcnt(4)
    v_fmac_f32 v28, v63, v108
    v_fmac_f32 v29, v63, v109
    v_fmac_f32 v30, v63, v110
    v_fmac_f32 v31, v63, v111
    v_cvt_pk_bf16_f32 v38, v28, v29
    v_cvt_pk_bf16_f32 v39, v30, v31
    buffer_store_dwordx2 v[38:39], v13, s[4:7], s58 offen offset:1536 sc1

    s_waitcnt lgkmcnt(0)
    v_add_f32 v56, v56, v57
    v_add_f32 v58, v58, v59
    v_add_f32 v52, v52, v53
    v_add_f32 v54, v54, v55
    v_add_f32 v56, v56, v58
    v_add_f32 v52, v52, v54
    buffer_store_dword v56, v253, s[4:7], s72 offen sc1
    buffer_store_dword v52, v253, s[4:7], s72 offen offset:768 sc1
    s_and_b32 s8, s2, 7
    s_lshr_b32 s9, s2, 3
    s_and_b32 s62, s9, 7
    s_and_b32 s61, s8, 1
    s_lshl_b32 s12, s61, 3
    s_add_u32 s10, s62, s12
    s_lshr_b32 s9, s9, 3
    s_lshr_b32 s8, s8, 1
    s_lshl_b32 s8, s8, 2
    s_add_u32 s8, s8, s9
    s_lshl_b32 s12, s8, 1
    s_add_u32 s61, s61, s12
    v_lshrrev_b32 v4, 4, v2
    v_bfe_u32 v5, v2, 1, 2
    s_and_b32 s12, s3, 1
    s_lshl_b32 s12, s12, 1
    v_and_b32 v6, 1, v4
    v_or_b32 v6, s12, v6
    v_xor_b32 v5, v5, v6
    v_lshlrev_b32 v5, 5, v5
    v_and_b32 v6, 1, v2
    v_lshl_add_u32 v5, v6, 4, v5
    v_lshrrev_b32 v3, 3, v2
    v_mul_u32_u24 v3, 4352, v3
    v_add_u32 v3, v3, v5
    s_mul_i32 s48, s3, 8*4352
    s_lshl_b32 s49, s8, 8
    s_add_u32 s48, s48, s49
    s_add_u32 s48, s48, 18874368
    s_lshl_b32 s49, s3, 10
    v_bfe_u32 v5, v2, 2, 2
    v_lshlrev_b32 v7, 4, v2
    s_mul_i32 s50, s10, 180224
    s_mul_i32 s51, s3, 3072
    s_add_u32 s50, s50, s51
    s_add_u32 s50, s50, 5898240
    s_mov_b32 m0, s49
    v_and_b32 v6, 1, v4
    v_lshrrev_b32 v17, 1, v5
    v_lshl_or_b32 v6, v6, 1, v17
    v_lshl_add_u32 v16, v4, 3, v5
    v_lshlrev_b32 v16, 7, v16
    v_and_b32 v17, 3, v2
    v_lshl_add_u32 v16, v17, 3, v16

    v_xor_b32 v17, 0, v6
    v_lshl_add_u32 v8, v17, 5, v16
    v_add_u32 v12, 0x10000, v8
    v_xor_b32 v17, 1, v6
    v_lshl_add_u32 v9, v17, 5, v16
    v_add_u32 v13, 0x10000, v9
    v_xor_b32 v17, 2, v6
    v_lshl_add_u32 v10, v17, 5, v16
    v_add_u32 v14, 0x10000, v10
    v_xor_b32 v17, 3, v6
    v_lshl_add_u32 v11, v17, 5, v16
    v_add_u32 v15, 0x10000, v11
    s_mul_i32 s29, s10, 180224
    s_lshr_b32 s28, s2, 6
    s_mul_i32 s28, s28, 2816
    s_add_u32 s29, s29, s28
    s_add_u32 s29, s29, 5898240
    s_add_u32 s28, s29, 90112
    v_lshrrev_b32 v24, 5, v0
    v_mul_u32_u24 v24, 11264, v24
    v_and_b32 v20, 31, v0
    v_min_u32 v20, 21, v20
    v_lshl_add_u32 v24, v20, 7, v24
    v_lshrrev_b32 v22, 1, v2
    v_mul_u32_u24 v22, 32*4352, v22
    v_and_b32 v23, 1, v2
    v_lshl_add_u32 v22, v23, 7, v22
    s_lshl_b32 s27, s62, 2
    s_add_u32 s27, s27, s3
    s_mul_i32 s27, s27, 4352
    s_lshl_b32 s26, s8, 8
    s_add_u32 s27, s27, s26
    s_add_u32 s27, s27, 18874368
    s_waitcnt vmcnt(6)
    v_mov_b32 v62, v61

    s_mov_b32 s75, 0
    s_branch K3_pw_c
K3_pw:
    buffer_load_dword v62, v48, s[4:7], s31 offen offset:0 sc1
    s_add_u32 s75, s75, 1
    s_waitcnt vmcnt(0)
K3_pw_c:
    v_cmpx_ne_u32 vcc, s30, v62
    s_cmp_gt_u32 s75, 0x40000
    s_cbranch_scc1 K3_pw_x
    s_cbranch_execnz K3_pw
K3_pw_x:
    s_mov_b64 exec, -1

    s_cmp_eq_u32 s3, 3
    s_cbranch_scc1 K3_w3
    buffer_load_dwordx4 a[0:3], v7, s[4:7], s50 offen offset:0 sc1
    buffer_load_dwordx4 a[4:7], v7, s[4:7], s50 offen offset:1024 sc1
    buffer_load_dwordx4 a[8:11], v7, s[4:7], s50 offen offset:2048 sc1
    s_add_u32 s50, s50, 11264
    buffer_load_dwordx4 a[12:15], v7, s[4:7], s50 offen offset:0 sc1
    buffer_load_dwordx4 a[16:19], v7, s[4:7], s50 offen offset:1024 sc1
    buffer_load_dwordx4 a[20:23], v7, s[4:7], s50 offen offset:2048 sc1
    s_add_u32 s50, s50, 11264
    buffer_load_dwordx4 a[24:27], v7, s[4:7], s50 offen offset:0 sc1
    buffer_load_dwordx4 a[28:31], v7, s[4:7], s50 offen offset:1024 sc1
    buffer_load_dwordx4 a[32:35], v7, s[4:7], s50 offen offset:2048 sc1
    s_add_u32 s50, s50, 11264
    buffer_load_dwordx4 a[36:39], v7, s[4:7], s50 offen offset:0 sc1
    buffer_load_dwordx4 a[40:43], v7, s[4:7], s50 offen offset:1024 sc1
    buffer_load_dwordx4 a[44:47], v7, s[4:7], s50 offen offset:2048 sc1
    s_add_u32 s50, s50, 11264
    v_lshlrev_b32 v224, 3, v0
    s_mul_i32 s52, s10, 1536
    s_add_u32 s52, s52, 17170432
    s_lshl_b32 s54, s8, 7
    s_add_u32 s54, s54, s10
    s_mul_i32 s54, s54, 3072
    s_add_u32 s54, s54, 10878976
    s_mov_b32 s56, 0xbdd2d3e8
    s_mov_b32 s57, 0xc0135761
    v_and_b32 v225, 15, v2
    v_lshl_add_u32 v226, v5, 4, v225
    v_lshlrev_b32 v226, 4, v226
    v_and_b32 v227, 3, v2
    v_lshl_add_u32 v226, v227, 2, v226
    v_add_u32 v226, 131072, v226
    v_lshlrev_b32 v227, 2, v225
    v_add_u32 v227, 139456, v227
    v_lshrrev_b32 v228, 3, v0
    v_lshlrev_b32 v228, 6, v228
    v_and_b32 v229, 3, v0
    v_lshl_add_u32 v228, v229, 4, v228
    v_bfe_u32 v229, v0, 2, 1
    v_lshl_add_u32 v228, v229, 3, v228
    v_add_u32 v228, 141312, v228
    s_mul_i32 s53, s3, 192
    s_add_u32 s53, s53, 141312
    v_lshl_add_u32 v232, v4, 4, s53
    v_mov_b32 v230, 0x3b000000
    v_mov_b32 v231, 0x3727c5ac
    s_mov_b32 s59, 0

    v_lshlrev_b32 v52, 4, v2
    v_mul_u32_u24 v53, 12, v2
    s_lshl_b32 s60, s62, 4
    s_lshl_b32 s63, s3, 2
    s_add_u32 s60, s60, s63
    s_mul_i32 s60, s60, 11264
    s_add_u32 s60, s60, 4390912

    s_lshr_b32 s63, s61, 1
    s_lshl_b32 s63, s63, 3
    s_and_b32 s64, s61, 1
    s_add_u32 s63, s63, s64
    s_lshl_b32 s64, s63, 4
    s_lshl_b32 s65, s3, 2
    s_add_u32 s64, s64, s65
    s_mul_i32 s64, s64, 3072
    s_add_u32 s64, s64, 10878976
    s_lshl_b32 s65, s3, 1
    s_add_u32 s63, s63, s65
    v_and_b32 v57, 15, v2
    v_lshrrev_b32 v58, 4, v2
    v_mul_u32_u24 v59, 4*4352, v57
    v_lshl_add_u32 v59, v58, 3, v59
    s_mul_i32 s70, s62, 64*4352
    s_lshl_b32 s71, s63, 5
    s_add_u32 s70, s70, s71
    s_add_u32 s70, s70, 18874368
    v_lshlrev_b32 v60, 4, v57
    s_lshl_b32 s71, s62, 8
    s_add_u32 s71, s71, 2123776
    v_lshlrev_b32 v61, 12, v58
    v_lshl_add_u32 v61, v57, 3, v61
    s_lshl_b32 s72, s63, 14
    s_lshl_b32 s73, s62, 7
    s_add_u32 s72, s72, s73
    s_lshl_b32 s73, s3, 12
    v_add_u32 v54, s73, v52
    s_lshl_b32 s73, s3, 14
    v_add_u32 v55, s73, v52
    s_mov_b32 s14, 0x200000
    s_mov_b32 s15, 0x20000

    s_lshl_b32 s74, s8, 13
    s_add_u32 s74, s74, 2359296
    s_lshl_b32 s66, s10, 9
    s_add_u32 s66, s66, s74
    s_lshl_b32 s75, s3, 11
    s_add_u32 s74, s74, s75
    v_and_b32 v63, 3, v2
    v_lshlrev_b32 v63, 9, v63
    s_mov_b32 s76, 1
    s_mov_b32 s77, 0
    s_lshl_b32 s28, s2, 7
    s_add_u32 s28, s28, 2269184
    s_mov_b32 s29, 2269184
    v_mov_b32 v56, s30
    v_lshlrev_b32 v49, 7, v0
    s_cmp_eq_u32 s3, 1
    s_waitcnt vmcnt(12)
    s_barrier
    s_cbranch_scc0 K3_nf0
    s_mov_b64 exec, 1
    buffer_store_dword v56, off, s[4:7], s28 sc1
    s_mov_b64 exec, -1
K3_nf0:

    buffer_load_dwordx4 a[48:51], v7, s[4:7], s50 offen offset:0 sc1
    buffer_load_dwordx4 a[52:55], v7, s[4:7], s50 offen offset:1024 sc1
    buffer_load_dwordx4 a[56:59], v7, s[4:7], s50 offen offset:2048 sc1
    s_add_u32 s50, s50, 11264
    buffer_load_dwordx4 a[60:63], v7, s[4:7], s50 offen offset:0 sc1
    buffer_load_dwordx4 a[64:67], v7, s[4:7], s50 offen offset:1024 sc1
    buffer_load_dwordx4 a[68:71], v7, s[4:7], s50 offen offset:2048 sc1
    s_add_u32 s50, s50, 11264
    buffer_load_dwordx4 a[72:75], v7, s[4:7], s50 offen offset:0 sc1
    buffer_load_dwordx4 a[76:79], v7, s[4:7], s50 offen offset:1024 sc1
    buffer_load_dwordx4 a[80:83], v7, s[4:7], s50 offen offset:2048 sc1
    s_add_u32 s50, s50, 11264
    buffer_load_dwordx4 a[84:87], v7, s[4:7], s50 offen offset:0 sc1
    buffer_load_dwordx4 a[88:91], v7, s[4:7], s50 offen offset:1024 sc1
    buffer_load_dwordx4 a[92:95], v7, s[4:7], s50 offen offset:2048 sc1
    s_add_u32 s50, s50, 11264
    buffer_load_dwordx4 a[96:99], v7, s[4:7], s50 offen offset:0 sc1
    buffer_load_dwordx4 a[100:103], v7, s[4:7], s50 offen offset:1024 sc1
    buffer_load_dwordx4 a[104:107], v7, s[4:7], s50 offen offset:2048 sc1
    s_add_u32 s50, s50, 11264
    buffer_load_dwordx4 a[108:111], v7, s[4:7], s50 offen offset:0 sc1
    buffer_load_dwordx4 a[112:115], v7, s[4:7], s50 offen offset:1024 sc1
    buffer_load_dwordx4 a[116:119], v7, s[4:7], s50 offen offset:2048 sc1
    s_add_u32 s50, s50, 11264
    buffer_load_dwordx4 a[120:123], v7, s[4:7], s50 offen offset:0 sc1
    buffer_load_dwordx4 a[124:127], v7, s[4:7], s50 offen offset:1024 sc1
    buffer_load_dwordx4 a[128:131], v7, s[4:7], s50 offen offset:2048 sc1
    s_add_u32 s50, s50, 11264
    buffer_load_dwordx4 a[132:135], v7, s[4:7], s50 offen offset:0 sc1
    buffer_load_dwordx4 a[136:139], v7, s[4:7], s50 offen offset:1024 sc1
    buffer_load_dwordx4 a[140:143], v7, s[4:7], s50 offen offset:2048 sc1
    s_add_u32 s50, s50, 11264
    buffer_load_dwordx4 a[144:147], v7, s[4:7], s50 offen offset:0 sc1
    buffer_load_dwordx4 a[148:151], v7, s[4:7], s50 offen offset:1024 sc1
    buffer_load_dwordx4 a[152:155], v7, s[4:7], s50 offen offset:2048 sc1
    s_add_u32 s50, s50, 11264
    buffer_load_dwordx4 a[156:159], v7, s[4:7], s50 offen offset:0 sc1
    buffer_load_dwordx4 a[160:163], v7, s[4:7], s50 offen offset:1024 sc1
    buffer_load_dwordx4 a[164:167], v7, s[4:7], s50 offen offset:2048 sc1
    s_add_u32 s50, s50, 11264
    buffer_load_dword v62, v49, s[4:7], s29 offen sc1
    buffer_load_dwordx4 a[168:171], v7, s[4:7], s50 offen offset:0 sc1
    buffer_load_dwordx4 a[172:175], v7, s[4:7], s50 offen offset:1024 sc1
    buffer_load_dwordx4 a[176:179], v7, s[4:7], s50 offen offset:2048 sc1
    s_add_u32 s50, s50, 11264
    buffer_load_dwordx4 a[180:183], v7, s[4:7], s50 offen offset:0 sc1
    buffer_load_dwordx4 a[184:187], v7, s[4:7], s50 offen offset:1024 sc1
    buffer_load_dwordx4 a[188:191], v7, s[4:7], s50 offen offset:2048 sc1
    s_add_u32 s50, s50, 11264
    v_lshlrev_b32 v229, 4, v2
    s_lshl_b32 s58, s3, 10
    s_add_u32 s54, s54, s58
    s_and_b32 s58, s3, 1
    s_lshl_b32 s58, s58, 11
    s_add_u32 s58, s58, 142848
    v_lshl_add_u32 v234, v2, 2, s58
    v_mov_b32 v50, 0x40000000

    s_waitcnt vmcnt(6)
    s_mov_b32 s75, 0
    s_branch K3_px0_c
K3_px0:
    buffer_load_dword v62, v49, s[4:7], s29 offen offset:0 sc1
    s_add_u32 s75, s75, 1
    s_waitcnt vmcnt(0)
K3_px0_c:
    v_cmpx_ne_u32 vcc, s30, v62
    s_cmp_gt_u32 s75, 0x40000
    s_cbranch_scc1 K3_px0_x
    s_cbranch_execnz K3_px0
K3_px0_x:
    s_mov_b64 exec, -1

    s_barrier
    buffer_load_dwordx4 v3, s[4:7], s48 offen sc1 lds
    s_add_u32 s49, s49, 0x1000
    s_add_u32 s48, s48, 32*4352
    s_mov_b32 m0, s49
    s_nop 0
    buffer_load_dwordx4 v3, s[4:7], s48 offen sc1 lds
    s_add_u32 s49, s49, 0x1000
    s_add_u32 s48, s48, 32*4352
    s_mov_b32 m0, s49
    s_nop 0
    buffer_load_dwordx4 v3, s[4:7], s48 offen sc1 lds
    s_add_u32 s49, s49, 0x1000
    s_add_u32 s48, s48, 32*4352
    s_mov_b32 m0, s49
    s_nop 0
    buffer_load_dwordx4 v3, s[4:7], s48 offen sc1 lds
    s_add_u32 s49, s49, 0x1000
    s_add_u32 s48, s48, 32*4352
    s_mov_b32 m0, s49
    s_nop 0
    buffer_load_dwordx4 v3, s[4:7], s48 offen sc1 lds
    s_add_u32 s49, s49, 0x1000
    s_add_u32 s48, s48, 32*4352
    s_mov_b32 m0, s49
    s_nop 0
    buffer_load_dwordx4 v3, s[4:7], s48 offen sc1 lds
    s_add_u32 s49, s49, 0x1000
    s_add_u32 s48, s48, 32*4352
    s_mov_b32 m0, s49
    s_nop 0
    buffer_load_dwordx4 v3, s[4:7], s48 offen sc1 lds
    s_add_u32 s49, s49, 0x1000
    s_add_u32 s48, s48, 32*4352
    s_mov_b32 m0, s49
    s_nop 0
    buffer_load_dwordx4 v3, s[4:7], s48 offen sc1 lds
    s_add_u32 s49, s49, 0x1000
    s_add_u32 s48, s48, 32*4352
    s_mov_b32 m0, s49
    s_nop 0
    s_waitcnt vmcnt(7)
    s_barrier
    ds_read_b64_tr_b16 v[64:65], v8 offset:0
    ds_read_b64_tr_b16 v[66:67], v8 offset:512
    ds_read_b64_tr_b16 v[68:69], v9 offset:0
    ds_read_b64_tr_b16 v[70:71], v9 offset:512
    ds_read_b64_tr_b16 v[72:73], v10 offset:0
    ds_read_b64_tr_b16 v[74:75], v10 offset:512
    ds_read_b64_tr_b16 v[76:77], v11 offset:0
    ds_read_b64_tr_b16 v[78:79], v11 offset:512
    v_mov_b32 v51, s57
    s_waitcnt lgkmcnt(6)
    v_mfma_f32_16x16x32_bf16 v[128:131], a[0:3], v[64:67], 0
    v_mfma_f32_16x16x32_bf16 v[160:163], a[4:7], v[64:67], 0
    buffer_load_dwordx4 v3, s[4:7], s48 offen sc1 lds
    s_add_u32 s49, s49, 0x1000
    s_add_u32 s48, s48, 32*4352
    s_mov_b32 m0, s49
    s_waitcnt vmcnt(6)
    s_barrier
    v_mfma_f32_16x16x32_bf16 v[192:195], a[8:11], v[64:67], 0
    ds_read_b64_tr_b16 v[80:81], v8 offset:4096
    s_waitcnt lgkmcnt(5)
    v_mfma_f32_16x16x32_bf16 v[132:135], a[0:3], v[68:71], 0
    ds_read_b64_tr_b16 v[82:83], v8 offset:4608
    v_mfma_f32_16x16x32_bf16 v[164:167], a[4:7], v[68:71], 0
    ds_read_b64_tr_b16 v[84:85], v9 offset:4096
    v_mfma_f32_16x16x32_bf16 v[196:199], a[8:11], v[68:71], 0
    ds_read_b64_tr_b16 v[86:87], v9 offset:4608
    s_waitcnt lgkmcnt(6)
    v_mfma_f32_16x16x32_bf16 v[136:139], a[0:3], v[72:75], 0
    ds_read_b64_tr_b16 v[88:89], v10 offset:4096
    v_mfma_f32_16x16x32_bf16 v[168:171], a[4:7], v[72:75], 0
    ds_read_b64_tr_b16 v[90:91], v10 offset:4608
    buffer_load_dwordx4 v3, s[4:7], s48 offen sc1 lds
    s_add_u32 s49, s49, 0x1000
    s_add_u32 s48, s48, 32*4352
    s_mov_b32 m0, s49
    v_mfma_f32_16x16x32_bf16 v[200:203], a[8:11], v[72:75], 0
    ds_read_b64_tr_b16 v[92:93], v11 offset:4096
    s_waitcnt lgkmcnt(7)
    v_mfma_f32_16x16x32_bf16 v[140:143], a[0:3], v[76:79], 0
    ds_read_b64_tr_b16 v[94:95], v11 offset:4608
    v_mfma_f32_16x16x32_bf16 v[172:175], a[4:7], v[76:79], 0
    v_mfma_f32_16x16x32_bf16 v[204:207], a[8:11], v[76:79], 0
    s_waitcnt lgkmcnt(6)
    v_mfma_f32_16x16x32_bf16 v[128:131], a[12:15], v[80:83], v[128:131]
    v_mfma_f32_16x16x32_bf16 v[160:163], a[16:19], v[80:83], v[160:163]
    buffer_load_dwordx4 v3, s[4:7], s48 offen sc1 lds
    s_add_u32 s49, s49, 0x1000
    s_add_u32 s48, s48, 32*4352
    s_mov_b32 m0, s49
    v_mfma_f32_16x16x32_bf16 v[192:195], a[20:23], v[80:83], v[192:195]
    ds_read_b64_tr_b16 v[64:65], v8 offset:8192
    s_waitcnt lgkmcnt(5)
    v_mfma_f32_16x16x32_bf16 v[132:135], a[12:15], v[84:87], v[132:135]
    ds_read_b64_tr_b16 v[66:67], v8 offset:8704
    v_mfma_f32_16x16x32_bf16 v[164:167], a[16:19], v[84:87], v[164:167]
    ds_read_b64_tr_b16 v[68:69], v9 offset:8192
    v_mfma_f32_16x16x32_bf16 v[196:199], a[20:23], v[84:87], v[196:199]
    ds_read_b64_tr_b16 v[70:71], v9 offset:8704
    s_waitcnt lgkmcnt(6)
    v_mfma_f32_16x16x32_bf16 v[136:139], a[12:15], v[88:91], v[136:139]
    ds_read_b64_tr_b16 v[72:73], v10 offset:8192
    v_mfma_f32_16x16x32_bf16 v[168:171], a[16:19], v[88:91], v[168:171]
    ds_read_b64_tr_b16 v[74:75], v10 offset:8704
    buffer_load_dwordx4 v3, s[4:7], s48 offen sc1 lds
    s_add_u32 s49, s49, 0x1000
    s_add_u32 s48, s48, 32*4352
    s_mov_b32 m0, s49
    v_mfma_f32_16x16x32_bf16 v[200:203], a[20:23], v[88:91], v[200:203]
    ds_read_b64_tr_b16 v[76:77], v11 offset:8192
    s_waitcnt lgkmcnt(7)
    v_mfma_f32_16x16x32_bf16 v[140:143], a[12:15], v[92:95], v[140:143]
    ds_read_b64_tr_b16 v[78:79], v11 offset:8704
    v_mfma_f32_16x16x32_bf16 v[172:175], a[16:19], v[92:95], v[172:175]
    v_mfma_f32_16x16x32_bf16 v[204:207], a[20:23], v[92:95], v[204:207]
    s_waitcnt lgkmcnt(6)
    v_mfma_f32_16x16x32_bf16 v[128:131], a[24:27], v[64:67], v[128:131]
    v_mfma_f32_16x16x32_bf16 v[160:163], a[28:31], v[64:67], v[160:163]
    buffer_load_dwordx4 v3, s[4:7], s48 offen sc1 lds
    s_add_u32 s49, s49, 0x1000
    s_add_u32 s48, s48, 32*4352
    s_mov_b32 m0, s49
    s_waitcnt vmcnt(8)
    s_barrier
    v_mfma_f32_16x16x32_bf16 v[192:195], a[32:35], v[64:67], v[192:195]
    ds_read_b64_tr_b16 v[80:81], v8 offset:12288
    s_waitcnt lgkmcnt(5)
    v_mfma_f32_16x16x32_bf16 v[132:135], a[24:27], v[68:71], v[132:135]
    ds_read_b64_tr_b16 v[82:83], v8 offset:12800
    v_mfma_f32_16x16x32_bf16 v[164:167], a[28:31], v[68:71], v[164:167]
    ds_read_b64_tr_b16 v[84:85], v9 offset:12288
    v_mfma_f32_16x16x32_bf16 v[196:199], a[32:35], v[68:71], v[196:199]
    ds_read_b64_tr_b16 v[86:87], v9 offset:12800
    s_waitcnt lgkmcnt(6)
    v_mfma_f32_16x16x32_bf16 v[136:139], a[24:27], v[72:75], v[136:139]
    ds_read_b64_tr_b16 v[88:89], v10 offset:12288
    v_mfma_f32_16x16x32_bf16 v[168:171], a[28:31], v[72:75], v[168:171]
    ds_read_b64_tr_b16 v[90:91], v10 offset:12800
    buffer_load_dwordx4 v3, s[4:7], s48 offen sc1 lds
    s_add_u32 s49, s49, 0x1000
    s_add_u32 s48, s48, 32*4352
    s_mov_b32 m0, s49
    v_mfma_f32_16x16x32_bf16 v[200:203], a[32:35], v[72:75], v[200:203]
    ds_read_b64_tr_b16 v[92:93], v11 offset:12288
    s_waitcnt lgkmcnt(7)
    v_mfma_f32_16x16x32_bf16 v[140:143], a[24:27], v[76:79], v[140:143]
    ds_read_b64_tr_b16 v[94:95], v11 offset:12800
    v_mfma_f32_16x16x32_bf16 v[172:175], a[28:31], v[76:79], v[172:175]
    v_mfma_f32_16x16x32_bf16 v[204:207], a[32:35], v[76:79], v[204:207]
    s_waitcnt lgkmcnt(6)
    v_mfma_f32_16x16x32_bf16 v[128:131], a[36:39], v[80:83], v[128:131]
    v_mfma_f32_16x16x32_bf16 v[160:163], a[40:43], v[80:83], v[160:163]
    buffer_load_dwordx4 v3, s[4:7], s48 offen sc1 lds
    s_add_u32 s49, s49, 0x1000
    s_add_u32 s48, s48, 32*4352
    s_mov_b32 m0, s49
    v_mfma_f32_16x16x32_bf16 v[192:195], a[44:47], v[80:83], v[192:195]
    ds_read_b64_tr_b16 v[64:65], v8 offset:16384
    s_waitcnt lgkmcnt(5)
    v_mfma_f32_16x16x32_bf16 v[132:135], a[36:39], v[84:87], v[132:135]
    ds_read_b64_tr_b16 v[66:67], v8 offset:16896
    v_mfma_f32_16x16x32_bf16 v[164:167], a[40:43], v[84:87], v[164:167]
    ds_read_b64_tr_b16 v[68:69], v9 offset:16384
    buffer_load_dwordx4 v3, s[4:7], s48 offen sc1 lds
    s_add_u32 s49, s49, 0x1000
    s_sub_u32 s48, s48, 480*4352-128
    s_mov_b32 m0, s49
    v_mfma_f32_16x16x32_bf16 v[196:199], a[44:47], v[84:87], v[196:199]
    ds_read_b64_tr_b16 v[70:71], v9 offset:16896
    s_waitcnt lgkmcnt(6)
    v_mfma_f32_16x16x32_bf16 v[136:139], a[36:39], v[88:91], v[136:139]
    ds_read_b64_tr_b16 v[72:73], v10 offset:16384
    v_mfma_f32_16x16x32_bf16 v[168:171], a[40:43], v[88:91], v[168:171]
    ds_read_b64_tr_b16 v[74:75], v10 offset:16896
    buffer_load_dwordx2 v[16:17], v224, s[4:7], s52 offen sc1
    s_add_u32 s52, s52, 24576
    v_mfma_f32_16x16x32_bf16 v[200:203], a[44:47], v[88:91], v[200:203]
    ds_read_b64_tr_b16 v[76:77], v11 offset:16384
    s_waitcnt lgkmcnt(7)
    v_mfma_f32_16x16x32_bf16 v[140:143], a[36:39], v[92:95], v[140:143]
    ds_read_b64_tr_b16 v[78:79], v11 offset:16896
    v_mfma_f32_16x16x32_bf16 v[172:175], a[40:43], v[92:95], v[172:175]
    buffer_load_dwordx2 v[18:19], v224, s[4:7], s52 offen sc1
    s_add_u32 s52, s52, 24576
    v_mfma_f32_16x16x32_bf16 v[204:207], a[44:47], v[92:95], v[204:207]
    s_waitcnt lgkmcnt(6)
    v_mfma_f32_16x16x32_bf16 v[128:131], a[48:51], v[64:67], v[128:131]
    v_mfma_f32_16x16x32_bf16 v[160:163], a[52:55], v[64:67], v[160:163]
    buffer_load_dwordx2 v[20:21], v224, s[4:7], s52 offen sc1
    s_add_u32 s52, s52, 24576
    s_waitcnt vmcnt(12)
    s_barrier
    v_mfma_f32_16x16x32_bf16 v[192:195], a[56:59], v[64:67], v[192:195]
    ds_read_b64_tr_b16 v[80:81], v8 offset:20480
    s_waitcnt lgkmcnt(5)
    v_mfma_f32_16x16x32_bf16 v[132:135], a[48:51], v[68:71], v[132:135]
    ds_read_b64_tr_b16 v[82:83], v8 offset:20992
    v_mfma_f32_16x16x32_bf16 v[164:167], a[52:55], v[68:71], v[164:167]
    ds_read_b64_tr_b16 v[84:85], v9 offset:20480
    buffer_load_dwordx2 v[22:23], v224, s[4:7], s52 offen sc1
    s_add_u32 s52, s52, 24576
    v_mfma_f32_16x16x32_bf16 v[196:199], a[56:59], v[68:71], v[196:199]
    ds_read_b64_tr_b16 v[86:87], v9 offset:20992
    s_waitcnt lgkmcnt(6)
    v_mfma_f32_16x16x32_bf16 v[136:139], a[48:51], v[72:75], v[136:139]
    ds_read_b64_tr_b16 v[88:89], v10 offset:20480
    v_mfma_f32_16x16x32_bf16 v[168:171], a[52:55], v[72:75], v[168:171]
    ds_read_b64_tr_b16 v[90:91], v10 offset:20992
    buffer_load_dwordx2 v[24:25], v224, s[4:7], s52 offen sc1
    s_add_u32 s52, s52, 24576
    v_mfma_f32_16x16x32_bf16 v[200:203], a[56:59], v[72:75], v[200:203]
    ds_read_b64_tr_b16 v[92:93], v11 offset:20480
    s_waitcnt lgkmcnt(7)
    v_mfma_f32_16x16x32_bf16 v[140:143], a[48:51], v[76:79], v[140:143]
    ds_read_b64_tr_b16 v[94:95], v11 offset:20992
    v_mfma_f32_16x16x32_bf16 v[172:175], a[52:55], v[76:79], v[172:175]
    buffer_load_dwordx2 v[26:27], v224, s[4:7], s52 offen sc1
    s_add_u32 s52, s52, 24576
    v_mfma_f32_16x16x32_bf16 v[204:207], a[56:59], v[76:79], v[204:207]
    s_waitcnt lgkmcnt(6)
    v_mfma_f32_16x16x32_bf16 v[128:131], a[60:63], v[80:83], v[128:131]
    v_mfma_f32_16x16x32_bf16 v[160:163], a[64:67], v[80:83], v[160:163]
    buffer_load_dwordx2 v[28:29], v224, s[4:7], s52 offen sc1
    s_add_u32 s52, s52, 24576
    v_mfma_f32_16x16x32_bf16 v[192:195], a[68:71], v[80:83], v[192:195]
    ds_read_b64_tr_b16 v[64:65], v8 offset:24576
    s_waitcnt lgkmcnt(5)
    v_mfma_f32_16x16x32_bf16 v[132:135], a[60:63], v[84:87], v[132:135]
    ds_read_b64_tr_b16 v[66:67], v8 offset:25088
    v_mfma_f32_16x16x32_bf16 v[164:167], a[64:67], v[84:87], v[164:167]
    ds_read_b64_tr_b16 v[68:69], v9 offset:24576
    buffer_load_dwordx2 v[30:31], v224, s[4:7], s52 offen sc1
    s_add_u32 s52, s52, 24576
    v_mfma_f32_16x16x32_bf16 v[196:199], a[68:71], v[84:87], v[196:199]
    ds_read_b64_tr_b16 v[70:71], v9 offset:25088
    s_waitcnt lgkmcnt(6)
    v_mfma_f32_16x16x32_bf16 v[136:139], a[60:63], v[88:91], v[136:139]
    ds_read_b64_tr_b16 v[72:73], v10 offset:24576
    v_mfma_f32_16x16x32_bf16 v[168:171], a[64:67], v[88:91], v[168:171]
    ds_read_b64_tr_b16 v[74:75], v10 offset:25088
    buffer_load_dwordx2 v[32:33], v224, s[4:7], s52 offen sc1
    s_add_u32 s52, s52, 24576
    v_mfma_f32_16x16x32_bf16 v[200:203], a[68:71], v[88:91], v[200:203]
    ds_read_b64_tr_b16 v[76:77], v11 offset:24576
    s_waitcnt lgkmcnt(7)
    v_mfma_f32_16x16x32_bf16 v[140:143], a[60:63], v[92:95], v[140:143]
    ds_read_b64_tr_b16 v[78:79], v11 offset:25088
    v_mfma_f32_16x16x32_bf16 v[172:175], a[64:67], v[92:95], v[172:175]
    buffer_load_dwordx2 v[34:35], v224, s[4:7], s52 offen sc1
    s_add_u32 s52, s52, 24576
    v_mfma_f32_16x16x32_bf16 v[204:207], a[68:71], v[92:95], v[204:207]
    s_waitcnt lgkmcnt(6)
    v_mfma_f32_16x16x32_bf16 v[128:131], a[72:75], v[64:67], v[128:131]
    v_mfma_f32_16x16x32_bf16 v[160:163], a[76:79], v[64:67], v[160:163]
    buffer_load_dwordx2 v[36:37], v224, s[4:7], s52 offen sc1
    s_add_u32 s52, s52, 24576
    s_waitcnt vmcnt(18)
    s_barrier
    v_mfma_f32_16x16x32_bf16 v[192:195], a[80:83], v[64:67], v[192:195]
    ds_read_b64_tr_b16 v[80:81], v8 offset:28672
    s_waitcnt lgkmcnt(5)
    v_mfma_f32_16x16x32_bf16 v[132:135], a[72:75], v[68:71], v[132:135]
    ds_read_b64_tr_b16 v[82:83], v8 offset:29184
    v_mfma_f32_16x16x32_bf16 v[164:167], a[76:79], v[68:71], v[164:167]
    ds_read_b64_tr_b16 v[84:85], v9 offset:28672
    buffer_load_dwordx2 v[38:39], v224, s[4:7], s52 offen sc1
    s_add_u32 s52, s52, 24576
    v_mfma_f32_16x16x32_bf16 v[196:199], a[80:83], v[68:71], v[196:199]
    ds_read_b64_tr_b16 v[86:87], v9 offset:29184
    s_waitcnt lgkmcnt(6)
    v_mfma_f32_16x16x32_bf16 v[136:139], a[72:75], v[72:75], v[136:139]
    ds_read_b64_tr_b16 v[88:89], v10 offset:28672
    v_mfma_f32_16x16x32_bf16 v[168:171], a[76:79], v[72:75], v[168:171]
    ds_read_b64_tr_b16 v[90:91], v10 offset:29184
    buffer_load_dwordx2 v[40:41], v224, s[4:7], s52 offen sc1
    s_add_u32 s52, s52, 24576
    v_mfma_f32_16x16x32_bf16 v[200:203], a[80:83], v[72:75], v[200:203]
    ds_read_b64_tr_b16 v[92:93], v11 offset:28672
    s_waitcnt lgkmcnt(7)
    v_mfma_f32_16x16x32_bf16 v[140:143], a[72:75], v[76:79], v[140:143]
    ds_read_b64_tr_b16 v[94:95], v11 offset:29184
    v_mfma_f32_16x16x32_bf16 v[172:175], a[76:79], v[76:79], v[172:175]
    buffer_load_dwordx2 v[42:43], v224, s[4:7], s52 offen sc1
    s_add_u32 s52, s52, 24576
    v_mfma_f32_16x16x32_bf16 v[204:207], a[80:83], v[76:79], v[204:207]
    s_waitcnt lgkmcnt(6)
    v_mfma_f32_16x16x32_bf16 v[128:131], a[84:87], v[80:83], v[128:131]
    v_mfma_f32_16x16x32_bf16 v[160:163], a[88:91], v[80:83], v[160:163]
    buffer_load_dwordx2 v[44:45], v224, s[4:7], s52 offen sc1
    s_add_u32 s52, s52, 24576
    v_mfma_f32_16x16x32_bf16 v[192:195], a[92:95], v[80:83], v[192:195]
    ds_read_b64_tr_b16 v[64:65], v8 offset:32768
    s_waitcnt lgkmcnt(5)
    v_mfma_f32_16x16x32_bf16 v[132:135], a[84:87], v[84:87], v[132:135]
    ds_read_b64_tr_b16 v[66:67], v8 offset:33280
    v_mfma_f32_16x16x32_bf16 v[164:167], a[88:91], v[84:87], v[164:167]
    ds_read_b64_tr_b16 v[68:69], v9 offset:32768
    buffer_load_dwordx2 v[46:47], v224, s[4:7], s52 offen sc1
    s_add_u32 s52, s52, 24576
    v_mfma_f32_16x16x32_bf16 v[196:199], a[92:95], v[84:87], v[196:199]
    ds_read_b64_tr_b16 v[70:71], v9 offset:33280
    s_waitcnt lgkmcnt(6)
    v_mfma_f32_16x16x32_bf16 v[136:139], a[84:87], v[88:91], v[136:139]
    ds_read_b64_tr_b16 v[72:73], v10 offset:32768
    v_mfma_f32_16x16x32_bf16 v[168:171], a[88:91], v[88:91], v[168:171]
    ds_read_b64_tr_b16 v[74:75], v10 offset:33280
    buffer_load_dwordx4 v3, s[4:7], s48 offen sc1 lds
    s_add_u32 s49, s49, 0x1000
    s_add_u32 s48, s48, 32*4352
    s_mov_b32 m0, s49
    v_mfma_f32_16x16x32_bf16 v[200:203], a[92:95], v[88:91], v[200:203]
    ds_read_b64_tr_b16 v[76:77], v11 offset:32768
    s_waitcnt lgkmcnt(7)
    v_mfma_f32_16x16x32_bf16 v[140:143], a[84:87], v[92:95], v[140:143]
    ds_read_b64_tr_b16 v[78:79], v11 offset:33280
    v_mfma_f32_16x16x32_bf16 v[172:175], a[88:91], v[92:95], v[172:175]
    buffer_load_dwordx4 v3, s[4:7], s48 offen sc1 lds
    s_add_u32 s49, s49, 0x1000
    s_add_u32 s48, s48, 32*4352
    s_mov_b32 m0, s49
    v_mfma_f32_16x16x32_bf16 v[204:207], a[92:95], v[92:95], v[204:207]
    s_waitcnt lgkmcnt(6)
    v_mfma_f32_16x16x32_bf16 v[128:131], a[96:99], v[64:67], v[128:131]
    v_mfma_f32_16x16x32_bf16 v[160:163], a[100:103], v[64:67], v[160:163]
    buffer_load_dwordx4 v3, s[4:7], s48 offen sc1 lds
    s_add_u32 s49, s49, 0x1000
    s_add_u32 s48, s48, 32*4352
    s_mov_b32 m0, s49
    s_waitcnt vmcnt(24)
    s_barrier
    v_mfma_f32_16x16x32_bf16 v[192:195], a[104:107], v[64:67], v[192:195]
    ds_read_b64_tr_b16 v[80:81], v8 offset:36864
    s_waitcnt lgkmcnt(5)
    v_mfma_f32_16x16x32_bf16 v[132:135], a[96:99], v[68:71], v[132:135]
    ds_read_b64_tr_b16 v[82:83], v8 offset:37376
    v_mfma_f32_16x16x32_bf16 v[164:167], a[100:103], v[68:71], v[164:167]
    ds_read_b64_tr_b16 v[84:85], v9 offset:36864
    buffer_load_dwordx4 v3, s[4:7], s48 offen sc1 lds
    s_add_u32 s49, s49, 0x1000
    s_add_u32 s48, s48, 32*4352
    s_mov_b32 m0, s49
    v_mfma_f32_16x16x32_bf16 v[196:199], a[104:107], v[68:71], v[196:199]
    ds_read_b64_tr_b16 v[86:87], v9 offset:37376
    s_waitcnt lgkmcnt(6)
    v_mfma_f32_16x16x32_bf16 v[136:139], a[96:99], v[72:75], v[136:139]
    ds_read_b64_tr_b16 v[88:89], v10 offset:36864
    v_mfma_f32_16x16x32_bf16 v[168:171], a[100:103], v[72:75], v[168:171]
    ds_read_b64_tr_b16 v[90:91], v10 offset:37376
    buffer_load_dwordx4 v3, s[4:7], s48 offen sc1 lds
    s_add_u32 s49, s49, 0x1000
    s_add_u32 s48, s48, 32*4352
    s_mov_b32 m0, s49
    v_mfma_f32_16x16x32_bf16 v[200:203], a[104:107], v[72:75], v[200:203]
    ds_read_b64_tr_b16 v[92:93], v11 offset:36864
    s_waitcnt lgkmcnt(7)
    v_mfma_f32_16x16x32_bf16 v[140:143], a[96:99], v[76:79], v[140:143]
    ds_read_b64_tr_b16 v[94:95], v11 offset:37376
    v_mfma_f32_16x16x32_bf16 v[172:175], a[100:103], v[76:79], v[172:175]
    buffer_load_dwordx4 v3, s[4:7], s48 offen sc1 lds
    s_add_u32 s49, s49, 0x1000
    s_add_u32 s48, s48, 32*4352
    s_mov_b32 m0, s49
    v_mfma_f32_16x16x32_bf16 v[204:207], a[104:107], v[76:79], v[204:207]
    s_waitcnt lgkmcnt(6)
    v_mfma_f32_16x16x32_bf16 v[128:131], a[108:111], v[80:83], v[128:131]
    v_mfma_f32_16x16x32_bf16 v[160:163], a[112:115], v[80:83], v[160:163]
    buffer_load_dwordx4 v3, s[4:7], s48 offen sc1 lds
    s_add_u32 s49, s49, 0x1000
    s_add_u32 s48, s48, 32*4352
    s_mov_b32 m0, s49
    v_mfma_f32_16x16x32_bf16 v[192:195], a[116:119], v[80:83], v[192:195]
    ds_read_b64_tr_b16 v[64:65], v8 offset:40960
    s_waitcnt lgkmcnt(5)
    v_mfma_f32_16x16x32_bf16 v[132:135], a[108:111], v[84:87], v[132:135]
    ds_read_b64_tr_b16 v[66:67], v8 offset:41472
    v_mfma_f32_16x16x32_bf16 v[164:167], a[112:115], v[84:87], v[164:167]
    ds_read_b64_tr_b16 v[68:69], v9 offset:40960
    buffer_load_dwordx4 v3, s[4:7], s48 offen sc1 lds
    s_add_u32 s49, s49, 0x1000
    s_add_u32 s48, s48, 32*4352
    s_mov_b32 m0, s49
    v_mfma_f32_16x16x32_bf16 v[196:199], a[116:119], v[84:87], v[196:199]
    ds_read_b64_tr_b16 v[70:71], v9 offset:41472
    s_waitcnt lgkmcnt(6)
    v_mfma_f32_16x16x32_bf16 v[136:139], a[108:111], v[88:91], v[136:139]
    ds_read_b64_tr_b16 v[72:73], v10 offset:40960
    v_mfma_f32_16x16x32_bf16 v[168:171], a[112:115], v[88:91], v[168:171]
    ds_read_b64_tr_b16 v[74:75], v10 offset:41472
    buffer_load_dwordx4 v3, s[4:7], s48 offen sc1 lds
    s_add_u32 s49, s49, 0x1000
    s_add_u32 s48, s48, 32*4352
    s_mov_b32 m0, s49
    v_mfma_f32_16x16x32_bf16 v[200:203], a[116:119], v[88:91], v[200:203]
    ds_read_b64_tr_b16 v[76:77], v11 offset:40960
    s_waitcnt lgkmcnt(7)
    v_mfma_f32_16x16x32_bf16 v[140:143], a[108:111], v[92:95], v[140:143]
    ds_read_b64_tr_b16 v[78:79], v11 offset:41472
    v_mfma_f32_16x16x32_bf16 v[172:175], a[112:115], v[92:95], v[172:175]
    buffer_load_dwordx4 v3, s[4:7], s48 offen sc1 lds
    s_add_u32 s49, s49, 0x1000
    s_add_u32 s48, s48, 32*4352
    s_mov_b32 m0, s49
    v_mfma_f32_16x16x32_bf16 v[204:207], a[116:119], v[92:95], v[204:207]
    s_waitcnt lgkmcnt(6)
    v_mfma_f32_16x16x32_bf16 v[128:131], a[120:123], v[64:67], v[128:131]
    v_mfma_f32_16x16x32_bf16 v[160:163], a[124:127], v[64:67], v[160:163]
    buffer_load_dwordx4 v3, s[4:7], s48 offen sc1 lds
    s_add_u32 s49, s49, 0x1000
    s_add_u32 s48, s48, 32*4352
    s_mov_b32 m0, s49
    s_waitcnt vmcnt(30)
    s_barrier
    v_mfma_f32_16x16x32_bf16 v[192:195], a[128:131], v[64:67], v[192:195]
    ds_read_b64_tr_b16 v[80:81], v8 offset:45056
    s_waitcnt lgkmcnt(5)
    v_mfma_f32_16x16x32_bf16 v[132:135], a[120:123], v[68:71], v[132:135]
    ds_read_b64_tr_b16 v[82:83], v8 offset:45568
    v_mfma_f32_16x16x32_bf16 v[164:167], a[124:127], v[68:71], v[164:167]
    ds_read_b64_tr_b16 v[84:85], v9 offset:45056
    buffer_load_dwordx4 v3, s[4:7], s48 offen sc1 lds
    s_add_u32 s49, s49, 0x1000
    s_add_u32 s48, s48, 32*4352
    s_mov_b32 m0, s49
    v_mfma_f32_16x16x32_bf16 v[196:199], a[128:131], v[68:71], v[196:199]
    ds_read_b64_tr_b16 v[86:87], v9 offset:45568
    s_waitcnt lgkmcnt(6)
    v_mfma_f32_16x16x32_bf16 v[136:139], a[120:123], v[72:75], v[136:139]
    ds_read_b64_tr_b16 v[88:89], v10 offset:45056
    v_mfma_f32_16x16x32_bf16 v[168:171], a[124:127], v[72:75], v[168:171]
    ds_read_b64_tr_b16 v[90:91], v10 offset:45568
    buffer_load_dwordx4 v3, s[4:7], s48 offen sc1 lds
    s_add_u32 s49, s49, 0x1000
    s_add_u32 s48, s48, 32*4352
    s_mov_b32 m0, s49
    v_mfma_f32_16x16x32_bf16 v[200:203], a[128:131], v[72:75], v[200:203]
    ds_read_b64_tr_b16 v[92:93], v11 offset:45056
    s_waitcnt lgkmcnt(7)
    v_mfma_f32_16x16x32_bf16 v[140:143], a[120:123], v[76:79], v[140:143]
    ds_read_b64_tr_b16 v[94:95], v11 offset:45568
    v_mfma_f32_16x16x32_bf16 v[172:175], a[124:127], v[76:79], v[172:175]
    buffer_load_dwordx4 v3, s[4:7], s48 offen sc1 lds
    s_add_u32 s49, s49, 0x1000
    s_add_u32 s48, s48, 32*4352
    s_mov_b32 m0, s49
    v_mfma_f32_16x16x32_bf16 v[204:207], a[128:131], v[76:79], v[204:207]
    s_waitcnt lgkmcnt(6)
    v_mfma_f32_16x16x32_bf16 v[128:131], a[132:135], v[80:83], v[128:131]
    v_mfma_f32_16x16x32_bf16 v[160:163], a[136:139], v[80:83], v[160:163]
    buffer_load_dwordx4 v3, s[4:7], s48 offen sc1 lds
    s_add_u32 s49, s49, 0x1000
    s_add_u32 s48, s48, 32*4352
    s_mov_b32 m0, s49
    v_mfma_f32_16x16x32_bf16 v[192:195], a[140:143], v[80:83], v[192:195]
    ds_read_b64_tr_b16 v[64:65], v8 offset:49152
    s_waitcnt lgkmcnt(5)
    v_mfma_f32_16x16x32_bf16 v[132:135], a[132:135], v[84:87], v[132:135]
    ds_read_b64_tr_b16 v[66:67], v8 offset:49664
    v_mfma_f32_16x16x32_bf16 v[164:167], a[136:139], v[84:87], v[164:167]
    ds_read_b64_tr_b16 v[68:69], v9 offset:49152
    buffer_load_dwordx4 v3, s[4:7], s48 offen sc1 lds
    s_add_u32 s49, s49, 0x1000
    s_add_u32 s48, s48, 32*4352
    s_mov_b32 m0, s49
    v_mfma_f32_16x16x32_bf16 v[196:199], a[140:143], v[84:87], v[196:199]
    ds_read_b64_tr_b16 v[70:71], v9 offset:49664
    s_waitcnt lgkmcnt(6)
    v_mfma_f32_16x16x32_bf16 v[136:139], a[132:135], v[88:91], v[136:139]
    ds_read_b64_tr_b16 v[72:73], v10 offset:49152
    v_mfma_f32_16x16x32_bf16 v[168:171], a[136:139], v[88:91], v[168:171]
    ds_read_b64_tr_b16 v[74:75], v10 offset:49664
    buffer_load_dwordx4 a[192:195], v52, s[4:7], s60 offen offset:0 sc1
    v_mfma_f32_16x16x32_bf16 v[200:203], a[140:143], v[88:91], v[200:203]
    ds_read_b64_tr_b16 v[76:77], v11 offset:49152
    s_waitcnt lgkmcnt(7)
    v_mfma_f32_16x16x32_bf16 v[140:143], a[132:135], v[92:95], v[140:143]
    ds_read_b64_tr_b16 v[78:79], v11 offset:49664
    v_mfma_f32_16x16x32_bf16 v[172:175], a[136:139], v[92:95], v[172:175]
    buffer_load_dwordx4 a[196:199], v52, s[4:7], s60 offen offset:1024 sc1
    v_mfma_f32_16x16x32_bf16 v[204:207], a[140:143], v[92:95], v[204:207]
    s_waitcnt lgkmcnt(6)
    v_mfma_f32_16x16x32_bf16 v[128:131], a[144:147], v[64:67], v[128:131]
    v_mfma_f32_16x16x32_bf16 v[160:163], a[148:151], v[64:67], v[160:163]
    buffer_load_dwordx4 a[200:203], v52, s[4:7], s60 offen offset:2048 sc1
    s_waitcnt vmcnt(36)
    s_barrier
    v_mfma_f32_16x16x32_bf16 v[192:195], a[152:155], v[64:67], v[192:195]
    ds_read_b64_tr_b16 v[80:81], v8 offset:53248
    s_waitcnt lgkmcnt(5)
    v_mfma_f32_16x16x32_bf16 v[132:135], a[144:147], v[68:71], v[132:135]
    ds_read_b64_tr_b16 v[82:83], v8 offset:53760
    v_mfma_f32_16x16x32_bf16 v[164:167], a[148:151], v[68:71], v[164:167]
    ds_read_b64_tr_b16 v[84:85], v9 offset:53248
    buffer_load_dwordx4 a[204:207], v52, s[4:7], s60 offen offset:3072 sc1
    s_add_u32 s60, s60, 4096
    v_mfma_f32_16x16x32_bf16 v[196:199], a[152:155], v[68:71], v[196:199]
    ds_read_b64_tr_b16 v[86:87], v9 offset:53760
    s_waitcnt lgkmcnt(6)
    v_mfma_f32_16x16x32_bf16 v[136:139], a[144:147], v[72:75], v[136:139]
    ds_read_b64_tr_b16 v[88:89], v10 offset:53248
    v_mfma_f32_16x16x32_bf16 v[168:171], a[148:151], v[72:75], v[168:171]
    ds_read_b64_tr_b16 v[90:91], v10 offset:53760
    buffer_load_dwordx4 a[208:211], v52, s[4:7], s60 offen offset:0 sc1
    v_mfma_f32_16x16x32_bf16 v[200:203], a[152:155], v[72:75], v[200:203]
    ds_read_b64_tr_b16 v[92:93], v11 offset:53248
    s_waitcnt lgkmcnt(7)
    v_mfma_f32_16x16x32_bf16 v[140:143], a[144:147], v[76:79], v[140:143]
    ds_read_b64_tr_b16 v[94:95], v11 offset:53760
    v_mfma_f32_16x16x32_bf16 v[172:175], a[148:151], v[76:79], v[172:175]
    buffer_load_dwordx4 a[212:215], v52, s[4:7], s60 offen offset:1024 sc1
    v_mfma_f32_16x16x32_bf16 v[204:207], a[152:155], v[76:79], v[204:207]
    s_waitcnt lgkmcnt(6)
    v_mfma_f32_16x16x32_bf16 v[128:131], a[156:159], v[80:83], v[128:131]
    v_mfma_f32_16x16x32_bf16 v[160:163], a[160:163], v[80:83], v[160:163]
    buffer_load_dwordx4 a[216:219], v52, s[4:7], s60 offen offset:2048 sc1
    v_mfma_f32_16x16x32_bf16 v[192:195], a[164:167], v[80:83], v[192:195]
    ds_read_b64_tr_b16 v[64:65], v8 offset:57344
    s_waitcnt lgkmcnt(5)
    v_mfma_f32_16x16x32_bf16 v[132:135], a[156:159], v[84:87], v[132:135]
    ds_read_b64_tr_b16 v[66:67], v8 offset:57856
    v_mfma_f32_16x16x32_bf16 v[164:167], a[160:163], v[84:87], v[164:167]
    ds_read_b64_tr_b16 v[68:69], v9 offset:57344
    buffer_load_dwordx4 a[220:223], v52, s[4:7], s60 offen offset:3072 sc1
    s_add_u32 s60, s60, 4096
    v_mfma_f32_16x16x32_bf16 v[196:199], a[164:167], v[84:87], v[196:199]
    ds_read_b64_tr_b16 v[70:71], v9 offset:57856
    s_waitcnt lgkmcnt(6)
    v_mfma_f32_16x16x32_bf16 v[136:139], a[156:159], v[88:91], v[136:139]
    ds_read_b64_tr_b16 v[72:73], v10 offset:57344
    v_mfma_f32_16x16x32_bf16 v[168:171], a[160:163], v[88:91], v[168:171]
    ds_read_b64_tr_b16 v[74:75], v10 offset:57856
    v_mfma_f32_16x16x32_bf16 v[200:203], a[164:167], v[88:91], v[200:203]
    ds_read_b64_tr_b16 v[76:77], v11 offset:57344
    s_waitcnt lgkmcnt(7)
    v_mfma_f32_16x16x32_bf16 v[140:143], a[156:159], v[92:95], v[140:143]
    ds_read_b64_tr_b16 v[78:79], v11 offset:57856
    v_mfma_f32_16x16x32_bf16 v[172:175], a[160:163], v[92:95], v[172:175]
    v_mfma_f32_16x16x32_bf16 v[204:207], a[164:167], v[92:95], v[204:207]
    s_waitcnt vmcnt(24)
    s_waitcnt lgkmcnt(6)
    v_mfma_f32_16x16x32_bf16 v[128:131], a[168:171], v[64:67], v[128:131]
    v_add_f32 v16, v16, v32
    v_add_f32 v17, v17, v33
    v_mfma_f32_16x16x32_bf16 v[160:163], a[172:175], v[64:67], v[160:163]
    v_add_f32 v18, v18, v34
    v_add_f32 v19, v19, v35
    s_waitcnt vmcnt(22)
    s_barrier
    v_mfma_f32_16x16x32_bf16 v[192:195], a[176:179], v[64:67], v[192:195]
    ds_read_b64_tr_b16 v[80:81], v8 offset:61440
    v_add_f32 v20, v20, v36
    v_add_f32 v21, v21, v37
    s_waitcnt lgkmcnt(5)
    v_mfma_f32_16x16x32_bf16 v[132:135], a[168:171], v[68:71], v[132:135]
    ds_read_b64_tr_b16 v[82:83], v8 offset:61952
    v_add_f32 v22, v22, v38
    v_add_f32 v23, v23, v39
    v_mfma_f32_16x16x32_bf16 v[164:167], a[172:175], v[68:71], v[164:167]
    ds_read_b64_tr_b16 v[84:85], v9 offset:61440
    v_add_f32 v24, v24, v40
    v_add_f32 v25, v25, v41
    v_mfma_f32_16x16x32_bf16 v[196:199], a[176:179], v[68:71], v[196:199]
    ds_read_b64_tr_b16 v[86:87], v9 offset:61952
    v_add_f32 v26, v26, v42
    v_add_f32 v27, v27, v43
    s_waitcnt lgkmcnt(6)
    v_mfma_f32_16x16x32_bf16 v[136:139], a[168:171], v[72:75], v[136:139]
    ds_read_b64_tr_b16 v[88:89], v10 offset:61440
    v_add_f32 v28, v28, v44
    v_add_f32 v29, v29, v45
    v_mfma_f32_16x16x32_bf16 v[168:171], a[172:175], v[72:75], v[168:171]
    ds_read_b64_tr_b16 v[90:91], v10 offset:61952
    v_add_f32 v30, v30, v46
    v_add_f32 v31, v31, v47
    v_mfma_f32_16x16x32_bf16 v[200:203], a[176:179], v[72:75], v[200:203]
    ds_read_b64_tr_b16 v[92:93], v11 offset:61440
    s_waitcnt lgkmcnt(7)
    v_mfma_f32_16x16x32_bf16 v[140:143], a[168:171], v[76:79], v[140:143]
    ds_read_b64_tr_b16 v[94:95], v11 offset:61952
    v_mfma_f32_16x16x32_bf16 v[172:175], a[172:175], v[76:79], v[172:175]
    v_mfma_f32_16x16x32_bf16 v[204:207], a[176:179], v[76:79], v[204:207]
    s_waitcnt lgkmcnt(6)
    v_mfma_f32_16x16x32_bf16 v[128:131], a[180:183], v[80:83], v[128:131]
    v_add_f32 v16, v16, v18
    v_add_f32 v17, v17, v19
    v_mfma_f32_16x16x32_bf16 v[160:163], a[184:187], v[80:83], v[160:163]
    v_add_f32 v20, v20, v22
    v_add_f32 v21, v21, v23
    v_mfma_f32_16x16x32_bf16 v[192:195], a[188:191], v[80:83], v[192:195]
    ds_read_b64_tr_b16 v[64:65], v12 offset:0
    v_add_f32 v24, v24, v26
    v_add_f32 v25, v25, v27
    s_waitcnt lgkmcnt(5)
    v_mfma_f32_16x16x32_bf16 v[132:135], a[180:183], v[84:87], v[132:135]
    ds_read_b64_tr_b16 v[66:67], v12 offset:512
    v_add_f32 v28, v28, v30
    v_add_f32 v29, v29, v31
    v_mfma_f32_16x16x32_bf16 v[164:167], a[184:187], v[84:87], v[164:167]
    ds_read_b64_tr_b16 v[68:69], v13 offset:0
    v_add_f32 v16, v16, v20
    v_add_f32 v17, v17, v21
    v_mfma_f32_16x16x32_bf16 v[196:199], a[188:191], v[84:87], v[196:199]
    ds_read_b64_tr_b16 v[70:71], v13 offset:512
    v_add_f32 v24, v24, v28
    v_add_f32 v25, v25, v29
    s_waitcnt lgkmcnt(6)
    v_mfma_f32_16x16x32_bf16 v[136:139], a[180:183], v[88:91], v[136:139]
    ds_read_b64_tr_b16 v[72:73], v14 offset:0
    v_add_f32 v16, v16, v24
    v_add_f32 v17, v17, v25
    v_mfma_f32_16x16x32_bf16 v[168:171], a[184:187], v[88:91], v[168:171]
    ds_read_b64_tr_b16 v[74:75], v14 offset:512
    ds_write_b64 v228, v[16:17]
    v_mfma_f32_16x16x32_bf16 v[200:203], a[188:191], v[88:91], v[200:203]
    ds_read_b64_tr_b16 v[76:77], v15 offset:0
    s_waitcnt lgkmcnt(8)
    v_mfma_f32_16x16x32_bf16 v[140:143], a[180:183], v[92:95], v[140:143]
    ds_read_b64_tr_b16 v[78:79], v15 offset:512
    v_mfma_f32_16x16x32_bf16 v[172:175], a[184:187], v[92:95], v[172:175]
    v_mfma_f32_16x16x32_bf16 v[204:207], a[188:191], v[92:95], v[204:207]
    s_waitcnt lgkmcnt(7)
    v_mfma_f32_16x16x32_bf16 v[144:147], a[0:3], v[64:67], 0
    v_mfma_f32_16x16x32_bf16 v[176:179], a[4:7], v[64:67], 0
    v_mfma_f32_16x16x32_bf16 v[208:211], a[8:11], v[64:67], 0
    ds_read_b64_tr_b16 v[80:81], v12 offset:4096
    buffer_load_dwordx3 a[224:226], v53, s[4:7], s60 offen offset:0 sc1
    v_accvgpr_write_b32 a227, 0
    s_waitcnt lgkmcnt(6)
    v_mfma_f32_16x16x32_bf16 v[148:151], a[0:3], v[68:71], 0
    ds_read_b64_tr_b16 v[82:83], v12 offset:4608
    v_mfma_f32_16x16x32_bf16 v[180:183], a[4:7], v[68:71], 0
    ds_read_b64_tr_b16 v[84:85], v13 offset:4096
    v_mfma_f32_16x16x32_bf16 v[212:215], a[8:11], v[68:71], 0
    ds_read_b64_tr_b16 v[86:87], v13 offset:4608
    buffer_load_dwordx3 a[228:230], v53, s[4:7], s60 offen offset:768 sc1
    v_accvgpr_write_b32 a231, 0
    s_waitcnt lgkmcnt(7)
    v_mfma_f32_16x16x32_bf16 v[152:155], a[0:3], v[72:75], 0
    ds_read_b64_tr_b16 v[88:89], v14 offset:4096
    v_mfma_f32_16x16x32_bf16 v[184:187], a[4:7], v[72:75], 0
    ds_read_b64_tr_b16 v[90:91], v14 offset:4608
    v_mfma_f32_16x16x32_bf16 v[216:219], a[8:11], v[72:75], 0
    ds_read_b64_tr_b16 v[92:93], v15 offset:4096
    buffer_load_dwordx3 a[232:234], v53, s[4:7], s60 offen offset:1536 sc1
    v_accvgpr_write_b32 a235, 0
    s_waitcnt lgkmcnt(7)
    v_mfma_f32_16x16x32_bf16 v[156:159], a[0:3], v[76:79], 0
    ds_read_b64_tr_b16 v[94:95], v15 offset:4608
    v_mfma_f32_16x16x32_bf16 v[188:191], a[4:7], v[76:79], 0
    v_mfma_f32_16x16x32_bf16 v[220:223], a[8:11], v[76:79], 0
    buffer_load_dwordx3 a[236:238], v53, s[4:7], s60 offen offset:2304 sc1
    v_accvgpr_write_b32 a239, 0
    s_add_u32 s60, s60, 3072
    s_waitcnt vmcnt(20)
    s_waitcnt lgkmcnt(0)
    s_barrier
    ds_read2st64_b32 v[120:121], v227 offset0:0 offset1:1
    ds_read2st64_b32 v[124:125], v226 offset0:0 offset1:4
    ds_read2st64_b32 v[122:123], v227 offset0:2 offset1:3
    ds_read2st64_b32 v[126:127], v226 offset0:8 offset1:12
    ds_read_b128 v[16:19], v232 offset:0
    ds_read_b128 v[20:23], v232 offset:64
    ds_read_b128 v[24:27], v232 offset:128
    ds_read_b128 v[28:31], v232 offset:768
    ds_read_b128 v[32:35], v232 offset:832
    ds_read_b128 v[36:39], v232 offset:896
    v_mfma_f32_16x16x32_bf16 v[144:147], a[12:15], v[80:83], v[144:147]
    v_mfma_f32_16x16x32_bf16 v[176:179], a[16:19], v[80:83], v[176:179]
    v_mfma_f32_16x16x32_bf16 v[208:211], a[20:23], v[80:83], v[208:211]
    ds_read_b64_tr_b16 v[64:65], v12 offset:8192
    buffer_load_dwordx4 a[240:243], v52, s[4:7], s60 offen offset:0 sc1
    v_mfma_f32_16x16x32_bf16 v[148:151], a[12:15], v[84:87], v[148:151]
    ds_read_b64_tr_b16 v[66:67], v12 offset:8704
    v_mfma_f32_16x16x32_bf16 v[180:183], a[16:19], v[84:87], v[180:183]
    ds_read_b64_tr_b16 v[68:69], v13 offset:8192
    v_mfma_f32_16x16x32_bf16 v[212:215], a[20:23], v[84:87], v[212:215]
    ds_read_b64_tr_b16 v[70:71], v13 offset:8704
    buffer_load_dwordx4 a[244:247], v52, s[4:7], s60 offen offset:1024 sc1
    v_mfma_f32_16x16x32_bf16 v[152:155], a[12:15], v[88:91], v[152:155]
    ds_read_b64_tr_b16 v[72:73], v14 offset:8192
    v_mfma_f32_16x16x32_bf16 v[184:187], a[16:19], v[88:91], v[184:187]
    ds_read_b64_tr_b16 v[74:75], v14 offset:8704
    v_mfma_f32_16x16x32_bf16 v[216:219], a[20:23], v[88:91], v[216:219]
    ds_read_b64_tr_b16 v[76:77], v15 offset:8192
    buffer_load_dwordx4 a[248:251], v52, s[4:7], s60 offen offset:2048 sc1
    v_mfma_f32_16x16x32_bf16 v[156:159], a[12:15], v[92:95], v[156:159]
    ds_read_b64_tr_b16 v[78:79], v15 offset:8704
    v_mfma_f32_16x16x32_bf16 v[188:191], a[16:19], v[92:95], v[188:191]
    v_mfma_f32_16x16x32_bf16 v[220:223], a[20:23], v[92:95], v[220:223]
    buffer_load_dwordx4 a[252:255], v52, s[4:7], s60 offen offset:3072 sc1
    s_add_u32 s60, s60, 4096
    s_waitcnt lgkmcnt(6)
    v_mfma_f32_16x16x32_bf16 v[144:147], a[24:27], v[64:67], v[144:147]
    v_mul_f32 v120, v230, v120
    v_mul_f32 v121, v230, v121
    v_mul_f32 v122, v230, v122
    v_mfma_f32_16x16x32_bf16 v[176:179], a[28:31], v[64:67], v[176:179]
    v_mul_f32 v123, v230, v123
    v_fma_f32 v124, v124, v230, v231
    v_fma_f32 v125, v125, v230, v231
    v_mfma_f32_16x16x32_bf16 v[208:211], a[32:35], v[64:67], v[208:211]
    ds_read_b64_tr_b16 v[80:81], v12 offset:12288
    buffer_load_dwordx4 a[0:3], v52, s[4:7], s60 offen offset:0 sc1
    v_fma_f32 v126, v126, v230, v231
    v_fma_f32 v127, v127, v230, v231
    v_fma_f32 v124, -v120, v120, v124
    s_waitcnt lgkmcnt(5)
    v_mfma_f32_16x16x32_bf16 v[148:151], a[24:27], v[68:71], v[148:151]
    ds_read_b64_tr_b16 v[82:83], v12 offset:12800
    v_fma_f32 v125, -v121, v121, v125
    v_fma_f32 v126, -v122, v122, v126
    v_fma_f32 v127, -v123, v123, v127
    v_mfma_f32_16x16x32_bf16 v[180:183], a[28:31], v[68:71], v[180:183]
    ds_read_b64_tr_b16 v[84:85], v13 offset:12288
    v_rsq_f32 v40, v124
    v_rsq_f32 v42, v125
    v_mfma_f32_16x16x32_bf16 v[212:215], a[32:35], v[68:71], v[212:215]
    ds_read_b64_tr_b16 v[86:87], v13 offset:12800
    buffer_load_dwordx4 a[4:7], v52, s[4:7], s60 offen offset:1024 sc1
    v_rsq_f32 v44, v126
    v_rsq_f32 v46, v127
    s_waitcnt lgkmcnt(6)
    v_mfma_f32_16x16x32_bf16 v[152:155], a[24:27], v[72:75], v[152:155]
    ds_read_b64_tr_b16 v[88:89], v14 offset:12288
    v_mul_f32 v41, -v120, v40
    v_mul_f32 v43, -v121, v42
    v_mul_f32 v45, -v122, v44
    v_mfma_f32_16x16x32_bf16 v[184:187], a[28:31], v[72:75], v[184:187]
    ds_read_b64_tr_b16 v[90:91], v14 offset:12800
    v_mul_f32 v47, -v123, v46
    v_fma_f32 v96, v16, v41, v28
    v_fma_f32 v97, v17, v41, v29
    v_mfma_f32_16x16x32_bf16 v[216:219], a[32:35], v[72:75], v[216:219]
    ds_read_b64_tr_b16 v[92:93], v15 offset:12288
    buffer_load_dwordx4 a[8:11], v52, s[4:7], s60 offen offset:2048 sc1
    v_fma_f32 v98, v18, v41, v30
    v_fma_f32 v99, v19, v41, v31
    v_fma_f32 v104, v20, v41, v32
    s_waitcnt lgkmcnt(7)
    v_mfma_f32_16x16x32_bf16 v[156:159], a[24:27], v[76:79], v[156:159]
    ds_read_b64_tr_b16 v[94:95], v15 offset:12800
    v_fma_f32 v105, v21, v41, v33
    v_fma_f32 v106, v22, v41, v34
    v_fma_f32 v107, v23, v41, v35
    v_mfma_f32_16x16x32_bf16 v[188:191], a[28:31], v[76:79], v[188:191]
    v_fma_f32 v112, v24, v41, v36
    v_fma_f32 v113, v25, v41, v37
    v_fma_f32 v114, v26, v41, v38
    v_mfma_f32_16x16x32_bf16 v[220:223], a[32:35], v[76:79], v[220:223]
    buffer_load_dwordx4 a[12:15], v52, s[4:7], s60 offen offset:3072 sc1
    s_add_u32 s60, s60, 4096
    v_fma_f32 v115, v27, v41, v39
    v_fmac_f32 v96, v128, v40
    v_fmac_f32 v97, v129, v40
    s_waitcnt lgkmcnt(6)
    v_mfma_f32_16x16x32_bf16 v[144:147], a[36:39], v[80:83], v[144:147]
    v_fmac_f32 v98, v130, v40
    v_fmac_f32 v99, v131, v40
    v_fmac_f32 v104, v160, v40
    v_mfma_f32_16x16x32_bf16 v[176:179], a[40:43], v[80:83], v[176:179]
    v_fmac_f32 v105, v161, v40
    v_fmac_f32 v106, v162, v40
    v_fmac_f32 v107, v163, v40
    v_mfma_f32_16x16x32_bf16 v[208:211], a[44:47], v[80:83], v[208:211]
    ds_read_b64_tr_b16 v[64:65], v12 offset:16384
    buffer_load_dwordx3 a[16:18], v53, s[4:7], s60 offen offset:0 sc1
    v_accvgpr_write_b32 a19, 0
    v_fmac_f32 v112, v192, v40
    v_fmac_f32 v113, v193, v40
    v_fmac_f32 v114, v194, v40
    s_waitcnt lgkmcnt(5)
    v_mfma_f32_16x16x32_bf16 v[148:151], a[36:39], v[84:87], v[148:151]
    ds_read_b64_tr_b16 v[66:67], v12 offset:16896
    v_fmac_f32 v115, v195, v40
    v_mul_f32 v100, v96, v96
    v_mul_f32 v101, v97, v97
    v_mfma_f32_16x16x32_bf16 v[180:183], a[40:43], v[84:87], v[180:183]
    ds_read_b64_tr_b16 v[68:69], v13 offset:16384
    v_mul_f32 v108, v104, v104
    v_mul_f32 v109, v105, v105
    v_mul_f32 v116, v112, v112
    v_mfma_f32_16x16x32_bf16 v[212:215], a[44:47], v[84:87], v[212:215]
    ds_read_b64_tr_b16 v[70:71], v13 offset:16896
    buffer_load_dwordx3 a[20:22], v53, s[4:7], s60 offen offset:768 sc1
    v_accvgpr_write_b32 a23, 0
    v_mul_f32 v117, v113, v113
    v_fma_f32 v100, v100, s56, v51
    v_fma_f32 v101, v101, s56, v51
    s_waitcnt lgkmcnt(6)
    v_mfma_f32_16x16x32_bf16 v[152:155], a[36:39], v[88:91], v[152:155]
    ds_read_b64_tr_b16 v[72:73], v14 offset:16384
    v_fma_f32 v108, v108, s56, v51
    v_fma_f32 v109, v109, s56, v51
    v_fma_f32 v116, v116, s56, v51
    v_mfma_f32_16x16x32_bf16 v[184:187], a[40:43], v[88:91], v[184:187]
    ds_read_b64_tr_b16 v[74:75], v14 offset:16896
    v_fma_f32 v117, v117, s56, v51
    v_mul_f32 v100, v100, v96
    v_mul_f32 v101, v101, v97
    v_mfma_f32_16x16x32_bf16 v[216:219], a[44:47], v[88:91], v[216:219]
    ds_read_b64_tr_b16 v[76:77], v15 offset:16384
    buffer_load_dwordx3 a[24:26], v53, s[4:7], s60 offen offset:1536 sc1
    v_accvgpr_write_b32 a27, 0
    v_mul_f32 v108, v108, v104
    v_mul_f32 v109, v109, v105
    v_mul_f32 v116, v116, v112
    s_waitcnt lgkmcnt(7)
    v_mfma_f32_16x16x32_bf16 v[156:159], a[36:39], v[92:95], v[156:159]
    ds_read_b64_tr_b16 v[78:79], v15 offset:16896
    v_mul_f32 v117, v117, v113
    v_exp_f32 v100, v100
    v_mfma_f32_16x16x32_bf16 v[188:191], a[40:43], v[92:95], v[188:191]
    v_exp_f32 v101, v101
    v_exp_f32 v108, v108
    v_mfma_f32_16x16x32_bf16 v[220:223], a[44:47], v[92:95], v[220:223]
    buffer_load_dwordx3 a[28:30], v53, s[4:7], s60 offen offset:2304 sc1
    v_accvgpr_write_b32 a31, 0
    s_add_u32 s60, s60, 3072
    v_exp_f32 v109, v109
    v_exp_f32 v116, v116
    s_waitcnt lgkmcnt(6)
    v_mfma_f32_16x16x32_bf16 v[144:147], a[48:51], v[64:67], v[144:147]
    v_exp_f32 v117, v117
    v_mul_f32 v96, v96, v98
    v_mfma_f32_16x16x32_bf16 v[176:179], a[52:55], v[64:67], v[176:179]
    v_mul_f32 v97, v97, v99
    v_mul_f32 v104, v104, v106
    v_mul_f32 v105, v105, v107
    v_mfma_f32_16x16x32_bf16 v[208:211], a[56:59], v[64:67], v[208:211]
    ds_read_b64_tr_b16 v[80:81], v12 offset:20480
    buffer_load_dwordx4 a[32:35], v52, s[4:7], s60 offen offset:0 sc1
    v_mul_f32 v112, v112, v114
    v_mul_f32 v113, v113, v115
    v_add_f32 v100, 1.0, v100
    s_waitcnt lgkmcnt(5)
    v_mfma_f32_16x16x32_bf16 v[148:151], a[48:51], v[68:71], v[148:151]
    ds_read_b64_tr_b16 v[82:83], v12 offset:20992
    v_add_f32 v101, 1.0, v101
    v_add_f32 v108, 1.0, v108
    v_add_f32 v109, 1.0, v109
    v_mfma_f32_16x16x32_bf16 v[180:183], a[52:55], v[68:71], v[180:183]
    ds_read_b64_tr_b16 v[84:85], v13 offset:20480
    v_add_f32 v116, 1.0, v116
    v_add_f32 v117, 1.0, v117
    v_rcp_f32 v100, v100
    v_mfma_f32_16x16x32_bf16 v[212:215], a[56:59], v[68:71], v[212:215]
    ds_read_b64_tr_b16 v[86:87], v13 offset:20992
    buffer_load_dwordx4 a[36:39], v52, s[4:7], s60 offen offset:1024 sc1
    v_rcp_f32 v101, v101
    v_rcp_f32 v108, v108
    s_waitcnt lgkmcnt(6)
    v_mfma_f32_16x16x32_bf16 v[152:155], a[48:51], v[72:75], v[152:155]
    ds_read_b64_tr_b16 v[88:89], v14 offset:20480
    v_rcp_f32 v109, v109
    v_rcp_f32 v116, v116
    v_mfma_f32_16x16x32_bf16 v[184:187], a[52:55], v[72:75], v[184:187]
    ds_read_b64_tr_b16 v[90:91], v14 offset:20992
    v_rcp_f32 v117, v117
    v_mul_f32 v96, v96, v100
    v_mfma_f32_16x16x32_bf16 v[216:219], a[56:59], v[72:75], v[216:219]
    ds_read_b64_tr_b16 v[92:93], v15 offset:20480
    buffer_load_dwordx4 a[40:43], v52, s[4:7], s60 offen offset:2048 sc1
    v_mul_f32 v97, v97, v101
    v_mul_f32 v104, v104, v108
    v_mul_f32 v105, v105, v109
    s_waitcnt lgkmcnt(7)
    v_mfma_f32_16x16x32_bf16 v[156:159], a[48:51], v[76:79], v[156:159]
    ds_read_b64_tr_b16 v[94:95], v15 offset:20992
    v_mul_f32 v112, v112, v116
    v_mul_f32 v113, v113, v117
    v_cvt_pk_bf16_f32 v236, v96, v97
    v_mfma_f32_16x16x32_bf16 v[188:191], a[52:55], v[76:79], v[188:191]
    v_cvt_pk_bf16_f32 v237, v104, v105
    v_cvt_pk_bf16_f32 v238, v112, v113
    v_mfma_f32_16x16x32_bf16 v[220:223], a[56:59], v[76:79], v[220:223]
    buffer_load_dwordx4 a[44:47], v52, s[4:7], s60 offen offset:3072 sc1
    s_add_u32 s60, s60, 4096
    v_fma_f32 v96, v16, v43, v28
    v_fma_f32 v97, v17, v43, v29
    v_fma_f32 v98, v18, v43, v30
    s_waitcnt lgkmcnt(6)
    v_mfma_f32_16x16x32_bf16 v[144:147], a[60:63], v[80:83], v[144:147]
    v_fma_f32 v99, v19, v43, v31
    v_fma_f32 v104, v20, v43, v32
    v_fma_f32 v105, v21, v43, v33
    v_mfma_f32_16x16x32_bf16 v[176:179], a[64:67], v[80:83], v[176:179]
    v_fma_f32 v106, v22, v43, v34
    v_fma_f32 v107, v23, v43, v35
    v_fma_f32 v112, v24, v43, v36
    v_mfma_f32_16x16x32_bf16 v[208:211], a[68:71], v[80:83], v[208:211]
    ds_read_b64_tr_b16 v[64:65], v12 offset:24576
    buffer_load_dwordx4 a[48:51], v52, s[4:7], s60 offen offset:0 sc1
    v_fma_f32 v113, v25, v43, v37
    v_fma_f32 v114, v26, v43, v38
    v_fma_f32 v115, v27, v43, v39
    s_waitcnt lgkmcnt(5)
    v_mfma_f32_16x16x32_bf16 v[148:151], a[60:63], v[84:87], v[148:151]
    ds_read_b64_tr_b16 v[66:67], v12 offset:25088
    v_fmac_f32 v96, v132, v42
    v_fmac_f32 v97, v133, v42
    v_fmac_f32 v98, v134, v42
    v_mfma_f32_16x16x32_bf16 v[180:183], a[64:67], v[84:87], v[180:183]
    ds_read_b64_tr_b16 v[68:69], v13 offset:24576
    v_fmac_f32 v99, v135, v42
    v_fmac_f32 v104, v164, v42
    v_fmac_f32 v105, v165, v42
    v_mfma_f32_16x16x32_bf16 v[212:215], a[68:71], v[84:87], v[212:215]
    ds_read_b64_tr_b16 v[70:71], v13 offset:25088
    buffer_load_dwordx4 a[52:55], v52, s[4:7], s60 offen offset:1024 sc1
    v_fmac_f32 v106, v166, v42
    v_fmac_f32 v107, v167, v42
    v_fmac_f32 v112, v196, v42
    s_waitcnt lgkmcnt(6)
    v_mfma_f32_16x16x32_bf16 v[152:155], a[60:63], v[88:91], v[152:155]
    ds_read_b64_tr_b16 v[72:73], v14 offset:24576
    v_fmac_f32 v113, v197, v42
    v_fmac_f32 v114, v198, v42
    v_fmac_f32 v115, v199, v42
    v_mfma_f32_16x16x32_bf16 v[184:187], a[64:67], v[88:91], v[184:187]
    ds_read_b64_tr_b16 v[74:75], v14 offset:25088
    v_mul_f32 v100, v96, v96
    v_mul_f32 v101, v97, v97
    v_mul_f32 v108, v104, v104
    v_mfma_f32_16x16x32_bf16 v[216:219], a[68:71], v[88:91], v[216:219]
    ds_read_b64_tr_b16 v[76:77], v15 offset:24576
    buffer_load_dwordx4 a[56:59], v52, s[4:7], s60 offen offset:2048 sc1
    v_mul_f32 v109, v105, v105
    v_mul_f32 v116, v112, v112
    v_mul_f32 v117, v113, v113
    s_waitcnt lgkmcnt(7)
    v_mfma_f32_16x16x32_bf16 v[156:159], a[60:63], v[92:95], v[156:159]
    ds_read_b64_tr_b16 v[78:79], v15 offset:25088
    v_fma_f32 v100, v100, s56, v51
    v_fma_f32 v101, v101, s56, v51
    v_fma_f32 v108, v108, s56, v51
    v_mfma_f32_16x16x32_bf16 v[188:191], a[64:67], v[92:95], v[188:191]
    v_fma_f32 v109, v109, s56, v51
    v_fma_f32 v116, v116, s56, v51
    v_fma_f32 v117, v117, s56, v51
    v_mfma_f32_16x16x32_bf16 v[220:223], a[68:71], v[92:95], v[220:223]
    v_mul_f32 v100, v100, v96
    v_mul_f32 v101, v101, v97
    v_mul_f32 v108, v108, v104
    s_waitcnt lgkmcnt(6)
    v_mfma_f32_16x16x32_bf16 v[144:147], a[72:75], v[64:67], v[144:147]
    v_mul_f32 v109, v109, v105
    v_mul_f32 v116, v116, v112
    v_mul_f32 v117, v117, v113
    v_mfma_f32_16x16x32_bf16 v[176:179], a[76:79], v[64:67], v[176:179]
    v_exp_f32 v100, v100
    v_exp_f32 v101, v101
    v_mfma_f32_16x16x32_bf16 v[208:211], a[80:83], v[64:67], v[208:211]
    ds_read_b64_tr_b16 v[80:81], v12 offset:28672
    buffer_load_dwordx4 a[60:63], v52, s[4:7], s60 offen offset:3072 sc1
    s_add_u32 s60, s60, 4096
    v_exp_f32 v108, v108
    v_exp_f32 v109, v109
    s_waitcnt lgkmcnt(5)
    v_mfma_f32_16x16x32_bf16 v[148:151], a[72:75], v[68:71], v[148:151]
    ds_read_b64_tr_b16 v[82:83], v12 offset:29184
    v_exp_f32 v116, v116
    v_exp_f32 v117, v117
    v_mfma_f32_16x16x32_bf16 v[180:183], a[76:79], v[68:71], v[180:183]
    ds_read_b64_tr_b16 v[84:85], v13 offset:28672
    v_mul_f32 v96, v96, v98
    v_mul_f32 v97, v97, v99
    v_mul_f32 v104, v104, v106
    v_mfma_f32_16x16x32_bf16 v[212:215], a[80:83], v[68:71], v[212:215]
    ds_read_b64_tr_b16 v[86:87], v13 offset:29184
    buffer_load_dwordx3 a[64:66], v53, s[4:7], s60 offen offset:0 sc1
    v_accvgpr_write_b32 a67, 0
    v_mul_f32 v105, v105, v107
    v_mul_f32 v112, v112, v114
    v_mul_f32 v113, v113, v115
    s_waitcnt lgkmcnt(6)
    v_mfma_f32_16x16x32_bf16 v[152:155], a[72:75], v[72:75], v[152:155]
    ds_read_b64_tr_b16 v[88:89], v14 offset:28672
    v_add_f32 v100, 1.0, v100
    v_add_f32 v101, 1.0, v101
    v_add_f32 v108, 1.0, v108
    v_mfma_f32_16x16x32_bf16 v[184:187], a[76:79], v[72:75], v[184:187]
    ds_read_b64_tr_b16 v[90:91], v14 offset:29184
    v_add_f32 v109, 1.0, v109
    v_add_f32 v116, 1.0, v116
    v_add_f32 v117, 1.0, v117
    v_mfma_f32_16x16x32_bf16 v[216:219], a[80:83], v[72:75], v[216:219]
    ds_read_b64_tr_b16 v[92:93], v15 offset:28672
    buffer_load_dwordx3 a[68:70], v53, s[4:7], s60 offen offset:768 sc1
    v_accvgpr_write_b32 a71, 0
    v_rcp_f32 v100, v100
    v_rcp_f32 v101, v101
    s_waitcnt lgkmcnt(7)
    v_mfma_f32_16x16x32_bf16 v[156:159], a[72:75], v[76:79], v[156:159]
    ds_read_b64_tr_b16 v[94:95], v15 offset:29184
    v_rcp_f32 v108, v108
    v_rcp_f32 v109, v109
    v_mfma_f32_16x16x32_bf16 v[188:191], a[76:79], v[76:79], v[188:191]
    v_rcp_f32 v116, v116
    v_rcp_f32 v117, v117
    v_mfma_f32_16x16x32_bf16 v[220:223], a[80:83], v[76:79], v[220:223]
    v_mul_f32 v96, v96, v100
    v_mul_f32 v97, v97, v101
    v_mul_f32 v104, v104, v108
    s_waitcnt vmcnt(38)
    s_waitcnt lgkmcnt(0)
    s_barrier
    ds_read_b32 v239, v234 offset:0
    ds_read_b32 v243, v234 offset:256
    v_mfma_f32_16x16x32_bf16 v[144:147], a[84:87], v[80:83], v[144:147]
    v_mul_f32 v105, v105, v109
    v_mul_f32 v112, v112, v116
    v_mul_f32 v113, v113, v117
    v_mfma_f32_16x16x32_bf16 v[176:179], a[88:91], v[80:83], v[176:179]
    v_cvt_pk_bf16_f32 v240, v96, v97
    v_cvt_pk_bf16_f32 v241, v104, v105
    v_cvt_pk_bf16_f32 v242, v112, v113
    v_mfma_f32_16x16x32_bf16 v[208:211], a[92:95], v[80:83], v[208:211]
    ds_read_b64_tr_b16 v[64:65], v12 offset:32768
    buffer_load_dwordx3 a[72:74], v53, s[4:7], s60 offen offset:1536 sc1
    v_accvgpr_write_b32 a75, 0
    v_fma_f32 v96, v16, v45, v28
    v_fma_f32 v97, v17, v45, v29
    v_mfma_f32_16x16x32_bf16 v[148:151], a[84:87], v[84:87], v[148:151]
    ds_read_b64_tr_b16 v[66:67], v12 offset:33280
    v_fma_f32 v98, v18, v45, v30
    v_fma_f32 v99, v19, v45, v31
    v_fma_f32 v104, v20, v45, v32
    v_mfma_f32_16x16x32_bf16 v[180:183], a[88:91], v[84:87], v[180:183]
    ds_read_b64_tr_b16 v[68:69], v13 offset:32768
    v_fma_f32 v105, v21, v45, v33
    v_fma_f32 v106, v22, v45, v34
    v_fma_f32 v107, v23, v45, v35
    v_mfma_f32_16x16x32_bf16 v[212:215], a[92:95], v[84:87], v[212:215]
    ds_read_b64_tr_b16 v[70:71], v13 offset:33280
    buffer_load_dwordx3 a[76:78], v53, s[4:7], s60 offen offset:2304 sc1
    v_accvgpr_write_b32 a79, 0
    s_add_u32 s60, s60, 3072
    v_fma_f32 v112, v24, v45, v36
    v_fma_f32 v113, v25, v45, v37
    v_fma_f32 v114, v26, v45, v38
    v_mfma_f32_16x16x32_bf16 v[152:155], a[84:87], v[88:91], v[152:155]
    ds_read_b64_tr_b16 v[72:73], v14 offset:32768
    v_fma_f32 v115, v27, v45, v39
    v_fmac_f32 v96, v136, v44
    v_fmac_f32 v97, v137, v44
    s_waitcnt lgkmcnt(6)
    buffer_store_dwordx4 v[236:239], v229, s[4:7], s54 offen sc1
    s_add_u32 s54, s54, 49152
    v_mfma_f32_16x16x32_bf16 v[184:187], a[88:91], v[88:91], v[184:187]
    ds_read_b64_tr_b16 v[74:75], v14 offset:33280
    v_fmac_f32 v98, v138, v44
    v_fmac_f32 v99, v139, v44
    v_fmac_f32 v104, v168, v44
    v_mfma_f32_16x16x32_bf16 v[216:219], a[92:95], v[88:91], v[216:219]
    ds_read_b64_tr_b16 v[76:77], v15 offset:32768
    buffer_load_dwordx4 a[80:83], v52, s[4:7], s60 offen offset:0 sc1
    v_fmac_f32 v105, v169, v44
    v_fmac_f32 v106, v170, v44
    v_fmac_f32 v107, v171, v44
    v_mfma_f32_16x16x32_bf16 v[156:159], a[84:87], v[92:95], v[156:159]
    ds_read_b64_tr_b16 v[78:79], v15 offset:33280
    v_fmac_f32 v112, v200, v44
    v_fmac_f32 v113, v201, v44
    v_fmac_f32 v114, v202, v44
    v_mfma_f32_16x16x32_bf16 v[188:191], a[88:91], v[92:95], v[188:191]
    v_fmac_f32 v115, v203, v44
    v_mul_f32 v100, v96, v96
    v_mul_f32 v101, v97, v97
    v_mfma_f32_16x16x32_bf16 v[220:223], a[92:95], v[92:95], v[220:223]
    v_mul_f32 v108, v104, v104
    v_mul_f32 v109, v105, v105
    v_mul_f32 v116, v112, v112
    s_waitcnt lgkmcnt(6)
    v_mfma_f32_16x16x32_bf16 v[144:147], a[96:99], v[64:67], v[144:147]
    v_mul_f32 v117, v113, v113
    v_fma_f32 v100, v100, s56, v51
    v_fma_f32 v101, v101, s56, v51
    v_mfma_f32_16x16x32_bf16 v[176:179], a[100:103], v[64:67], v[176:179]
    v_fma_f32 v108, v108, s56, v51
    v_fma_f32 v109, v109, s56, v51
    v_fma_f32 v116, v116, s56, v51
    v_mfma_f32_16x16x32_bf16 v[208:211], a[104:107], v[64:67], v[208:211]
    ds_read_b64_tr_b16 v[80:81], v12 offset:36864
    buffer_load_dwordx4 a[84:87], v52, s[4:7], s60 offen offset:1024 sc1
    v_fma_f32 v117, v117, s56, v51
    v_mul_f32 v100, v100, v96
    v_mul_f32 v101, v101, v97
    s_waitcnt lgkmcnt(5)
    v_mfma_f32_16x16x32_bf16 v[148:151], a[96:99], v[68:71], v[148:151]
    ds_read_b64_tr_b16 v[82:83], v12 offset:37376
    v_mul_f32 v108, v108, v104
    v_mul_f32 v109, v109, v105
    v_mul_f32 v116, v116, v112
    v_mfma_f32_16x16x32_bf16 v[180:183], a[100:103], v[68:71], v[180:183]
    ds_read_b64_tr_b16 v[84:85], v13 offset:36864
    v_mul_f32 v117, v117, v113
    v_exp_f32 v100, v100
    v_mfma_f32_16x16x32_bf16 v[212:215], a[104:107], v[68:71], v[212:215]
    ds_read_b64_tr_b16 v[86:87], v13 offset:37376
    buffer_load_dwordx4 a[88:91], v52, s[4:7], s60 offen offset:2048 sc1
    v_exp_f32 v101, v101
    v_exp_f32 v108, v108
    s_waitcnt lgkmcnt(6)
    v_mfma_f32_16x16x32_bf16 v[152:155], a[96:99], v[72:75], v[152:155]
    ds_read_b64_tr_b16 v[88:89], v14 offset:36864
    v_exp_f32 v109, v109
    v_exp_f32 v116, v116
    buffer_store_dwordx4 v[240:243], v229, s[4:7], s54 offen sc1
    s_add_u32 s54, s54, 49152
    v_mfma_f32_16x16x32_bf16 v[184:187], a[100:103], v[72:75], v[184:187]
    ds_read_b64_tr_b16 v[90:91], v14 offset:37376
    v_exp_f32 v117, v117
    v_mul_f32 v96, v96, v98
    v_mfma_f32_16x16x32_bf16 v[216:219], a[104:107], v[72:75], v[216:219]
    ds_read_b64_tr_b16 v[92:93], v15 offset:36864
    buffer_load_dwordx4 a[92:95], v52, s[4:7], s60 offen offset:3072 sc1
    s_add_u32 s60, s60, 4096
    v_mul_f32 v97, v97, v99
    v_mul_f32 v104, v104, v106
    v_mul_f32 v105, v105, v107
    s_waitcnt lgkmcnt(7)
    v_mfma_f32_16x16x32_bf16 v[156:159], a[96:99], v[76:79], v[156:159]
    ds_read_b64_tr_b16 v[94:95], v15 offset:37376
    v_mul_f32 v112, v112, v114
    v_mul_f32 v113, v113, v115
    v_add_f32 v100, 1.0, v100
    v_mfma_f32_16x16x32_bf16 v[188:191], a[100:103], v[76:79], v[188:191]
    v_add_f32 v101, 1.0, v101
    v_add_f32 v108, 1.0, v108
    v_add_f32 v109, 1.0, v109
    v_mfma_f32_16x16x32_bf16 v[220:223], a[104:107], v[76:79], v[220:223]
    v_add_f32 v116, 1.0, v116
    v_add_f32 v117, 1.0, v117
    v_rcp_f32 v100, v100
    s_waitcnt lgkmcnt(6)
    v_mfma_f32_16x16x32_bf16 v[144:147], a[108:111], v[80:83], v[144:147]
    v_rcp_f32 v101, v101
    v_rcp_f32 v108, v108
    v_mfma_f32_16x16x32_bf16 v[176:179], a[112:115], v[80:83], v[176:179]
    v_rcp_f32 v109, v109
    v_rcp_f32 v116, v116
    v_mfma_f32_16x16x32_bf16 v[208:211], a[116:119], v[80:83], v[208:211]
    ds_read_b64_tr_b16 v[64:65], v12 offset:40960
    buffer_load_dwordx4 a[96:99], v52, s[4:7], s60 offen offset:0 sc1
    v_rcp_f32 v117, v117
    v_mul_f32 v96, v96, v100
    s_waitcnt lgkmcnt(5)
    v_mfma_f32_16x16x32_bf16 v[148:151], a[108:111], v[84:87], v[148:151]
    ds_read_b64_tr_b16 v[66:67], v12 offset:41472
    v_mul_f32 v97, v97, v101
    v_mul_f32 v104, v104, v108
    v_mul_f32 v105, v105, v109
    v_mfma_f32_16x16x32_bf16 v[180:183], a[112:115], v[84:87], v[180:183]
    ds_read_b64_tr_b16 v[68:69], v13 offset:40960
    v_mul_f32 v112, v112, v116
    v_mul_f32 v113, v113, v117
    v_cvt_pk_bf16_f32 v244, v96, v97
    v_mfma_f32_16x16x32_bf16 v[212:215], a[116:119], v[84:87], v[212:215]
    ds_read_b64_tr_b16 v[70:71], v13 offset:41472
    buffer_load_dwordx4 a[100:103], v52, s[4:7], s60 offen offset:1024 sc1
    v_cvt_pk_bf16_f32 v245, v104, v105
    v_cvt_pk_bf16_f32 v246, v112, v113
    s_waitcnt lgkmcnt(6)
    v_mfma_f32_16x16x32_bf16 v[152:155], a[108:111], v[88:91], v[152:155]
    ds_read_b64_tr_b16 v[72:73], v14 offset:40960
    v_fma_f32 v96, v16, v47, v28
    v_fma_f32 v97, v17, v47, v29
    v_fma_f32 v98, v18, v47, v30
    v_mfma_f32_16x16x32_bf16 v[184:187], a[112:115], v[88:91], v[184:187]
    ds_read_b64_tr_b16 v[74:75], v14 offset:41472
    v_fma_f32 v99, v19, v47, v31
    v_fma_f32 v104, v20, v47, v32
    v_fma_f32 v105, v21, v47, v33
    v_mfma_f32_16x16x32_bf16 v[216:219], a[116:119], v[88:91], v[216:219]
    ds_read_b64_tr_b16 v[76:77], v15 offset:40960
    buffer_load_dwordx4 a[104:107], v52, s[4:7], s60 offen offset:2048 sc1
    v_fma_f32 v106, v22, v47, v34
    v_fma_f32 v107, v23, v47, v35
    v_fma_f32 v112, v24, v47, v36
    s_waitcnt lgkmcnt(7)
    v_mfma_f32_16x16x32_bf16 v[156:159], a[108:111], v[92:95], v[156:159]
    ds_read_b64_tr_b16 v[78:79], v15 offset:41472
    v_fma_f32 v113, v25, v47, v37
    v_fma_f32 v114, v26, v47, v38
    v_fma_f32 v115, v27, v47, v39
    v_mfma_f32_16x16x32_bf16 v[188:191], a[112:115], v[92:95], v[188:191]
    v_fmac_f32 v96, v140, v46
    v_fmac_f32 v97, v141, v46
    v_fmac_f32 v98, v142, v46
    v_mfma_f32_16x16x32_bf16 v[220:223], a[116:119], v[92:95], v[220:223]
    v_fmac_f32 v99, v143, v46
    v_fmac_f32 v104, v172, v46
    v_fmac_f32 v105, v173, v46
    s_waitcnt lgkmcnt(6)
    v_mfma_f32_16x16x32_bf16 v[144:147], a[120:123], v[64:67], v[144:147]
    v_fmac_f32 v106, v174, v46
    v_fmac_f32 v107, v175, v46
    v_fmac_f32 v112, v204, v46
    v_mfma_f32_16x16x32_bf16 v[176:179], a[124:127], v[64:67], v[176:179]
    v_fmac_f32 v113, v205, v46
    v_fmac_f32 v114, v206, v46
    v_fmac_f32 v115, v207, v46
    v_mfma_f32_16x16x32_bf16 v[208:211], a[128:131], v[64:67], v[208:211]
    ds_read_b64_tr_b16 v[80:81], v12 offset:45056
    buffer_load_dwordx4 a[108:111], v52, s[4:7], s60 offen offset:3072 sc1
    s_add_u32 s60, s60, 4096
    v_mul_f32 v100, v96, v96
    v_mul_f32 v101, v97, v97
    v_mul_f32 v108, v104, v104
    s_waitcnt lgkmcnt(5)
    v_mfma_f32_16x16x32_bf16 v[148:151], a[120:123], v[68:71], v[148:151]
    ds_read_b64_tr_b16 v[82:83], v12 offset:45568
    v_mul_f32 v109, v105, v105
    v_mul_f32 v116, v112, v112
    v_mul_f32 v117, v113, v113
    v_mfma_f32_16x16x32_bf16 v[180:183], a[124:127], v[68:71], v[180:183]
    ds_read_b64_tr_b16 v[84:85], v13 offset:45056
    v_fma_f32 v100, v100, s56, v51
    v_fma_f32 v101, v101, s56, v51
    v_fma_f32 v108, v108, s56, v51
    v_mfma_f32_16x16x32_bf16 v[212:215], a[128:131], v[68:71], v[212:215]
    ds_read_b64_tr_b16 v[86:87], v13 offset:45568
    buffer_load_dwordx3 a[112:114], v53, s[4:7], s60 offen offset:0 sc1
    v_accvgpr_write_b32 a115, 0
    v_fma_f32 v109, v109, s56, v51
    v_fma_f32 v116, v116, s56, v51
    v_fma_f32 v117, v117, s56, v51
    s_waitcnt lgkmcnt(6)
    v_mfma_f32_16x16x32_bf16 v[152:155], a[120:123], v[72:75], v[152:155]
    ds_read_b64_tr_b16 v[88:89], v14 offset:45056
    v_mul_f32 v100, v100, v96
    v_mul_f32 v101, v101, v97
    v_mul_f32 v108, v108, v104
    v_mfma_f32_16x16x32_bf16 v[184:187], a[124:127], v[72:75], v[184:187]
    ds_read_b64_tr_b16 v[90:91], v14 offset:45568
    v_mul_f32 v109, v109, v105
    v_mul_f32 v116, v116, v112
    v_mul_f32 v117, v117, v113
    v_mfma_f32_16x16x32_bf16 v[216:219], a[128:131], v[72:75], v[216:219]
    ds_read_b64_tr_b16 v[92:93], v15 offset:45056
    buffer_load_dwordx3 a[116:118], v53, s[4:7], s60 offen offset:768 sc1
    v_accvgpr_write_b32 a119, 0
    v_exp_f32 v100, v100
    v_exp_f32 v101, v101
    s_waitcnt lgkmcnt(7)
    v_mfma_f32_16x16x32_bf16 v[156:159], a[120:123], v[76:79], v[156:159]
    ds_read_b64_tr_b16 v[94:95], v15 offset:45568
    v_exp_f32 v108, v108
    v_exp_f32 v109, v109
    v_mfma_f32_16x16x32_bf16 v[188:191], a[124:127], v[76:79], v[188:191]
    v_exp_f32 v116, v116
    v_exp_f32 v117, v117
    v_mfma_f32_16x16x32_bf16 v[220:223], a[128:131], v[76:79], v[220:223]
    v_mul_f32 v96, v96, v98
    v_mul_f32 v97, v97, v99
    v_mul_f32 v104, v104, v106
    s_waitcnt vmcnt(48)
    s_waitcnt vmcnt(7)
    s_waitcnt lgkmcnt(0)
    s_barrier
    s_mov_b64 exec, s[76:77]
    buffer_store_dword v56, v50, s[4:7], s66 offen offset:0 sc1
    s_mov_b64 exec, -1
    ds_read_b32 v247, v234 offset:512
    ds_read_b32 v251, v234 offset:768
    v_mfma_f32_16x16x32_bf16 v[144:147], a[132:135], v[80:83], v[144:147]
    v_mul_f32 v105, v105, v107
    v_mul_f32 v112, v112, v114
    v_mul_f32 v113, v113, v115
    v_mfma_f32_16x16x32_bf16 v[176:179], a[136:139], v[80:83], v[176:179]
    v_add_f32 v100, 1.0, v100
    v_add_f32 v101, 1.0, v101
    v_add_f32 v108, 1.0, v108
    v_mfma_f32_16x16x32_bf16 v[208:211], a[140:143], v[80:83], v[208:211]
    ds_read_b64_tr_b16 v[64:65], v12 offset:49152
    buffer_load_dwordx3 a[120:122], v53, s[4:7], s60 offen offset:1536 sc1
    v_accvgpr_write_b32 a123, 0
    v_add_f32 v109, 1.0, v109
    v_add_f32 v116, 1.0, v116
    v_add_f32 v117, 1.0, v117
    v_mfma_f32_16x16x32_bf16 v[148:151], a[132:135], v[84:87], v[148:151]
    ds_read_b64_tr_b16 v[66:67], v12 offset:49664
    v_rcp_f32 v100, v100
    v_rcp_f32 v101, v101
    v_mfma_f32_16x16x32_bf16 v[180:183], a[136:139], v[84:87], v[180:183]
    ds_read_b64_tr_b16 v[68:69], v13 offset:49152
    v_rcp_f32 v108, v108
    v_rcp_f32 v109, v109
    v_mfma_f32_16x16x32_bf16 v[212:215], a[140:143], v[84:87], v[212:215]
    ds_read_b64_tr_b16 v[70:71], v13 offset:49664
    buffer_load_dwordx3 a[124:126], v53, s[4:7], s60 offen offset:2304 sc1
    v_accvgpr_write_b32 a127, 0
    s_add_u32 s60, s60, 3072
    v_rcp_f32 v116, v116
    v_rcp_f32 v117, v117
    v_mfma_f32_16x16x32_bf16 v[152:155], a[132:135], v[88:91], v[152:155]
    ds_read_b64_tr_b16 v[72:73], v14 offset:49152
    v_mul_f32 v96, v96, v100
    v_mul_f32 v97, v97, v101
    v_mul_f32 v104, v104, v108
    s_waitcnt lgkmcnt(6)
    buffer_store_dwordx4 v[244:247], v229, s[4:7], s54 offen sc1
    s_add_u32 s54, s54, 49152
    v_mfma_f32_16x16x32_bf16 v[184:187], a[136:139], v[88:91], v[184:187]
    ds_read_b64_tr_b16 v[74:75], v14 offset:49664
    v_mul_f32 v105, v105, v109
    v_mul_f32 v112, v112, v116
    v_mul_f32 v113, v113, v117
    v_mfma_f32_16x16x32_bf16 v[216:219], a[140:143], v[88:91], v[216:219]
    ds_read_b64_tr_b16 v[76:77], v15 offset:49152
    v_cvt_pk_bf16_f32 v248, v96, v97
    v_cvt_pk_bf16_f32 v249, v104, v105
    v_cvt_pk_bf16_f32 v250, v112, v113
    v_mfma_f32_16x16x32_bf16 v[156:159], a[132:135], v[92:95], v[156:159]
    ds_read_b64_tr_b16 v[78:79], v15 offset:49664
    v_mfma_f32_16x16x32_bf16 v[188:191], a[136:139], v[92:95], v[188:191]
    v_mfma_f32_16x16x32_bf16 v[220:223], a[140:143], v[92:95], v[220:223]
    s_waitcnt lgkmcnt(6)
    v_mfma_f32_16x16x32_bf16 v[144:147], a[144:147], v[64:67], v[144:147]
    v_mfma_f32_16x16x32_bf16 v[176:179], a[148:151], v[64:67], v[176:179]
    v_mfma_f32_16x16x32_bf16 v[208:211], a[152:155], v[64:67], v[208:211]
    ds_read_b64_tr_b16 v[80:81], v12 offset:53248
    s_waitcnt lgkmcnt(5)
    v_mfma_f32_16x16x32_bf16 v[148:151], a[144:147], v[68:71], v[148:151]
    ds_read_b64_tr_b16 v[82:83], v12 offset:53760
    v_mfma_f32_16x16x32_bf16 v[180:183], a[148:151], v[68:71], v[180:183]
    ds_read_b64_tr_b16 v[84:85], v13 offset:53248
    v_mfma_f32_16x16x32_bf16 v[212:215], a[152:155], v[68:71], v[212:215]
    ds_read_b64_tr_b16 v[86:87], v13 offset:53760
    s_waitcnt lgkmcnt(6)
    v_mfma_f32_16x16x32_bf16 v[152:155], a[144:147], v[72:75], v[152:155]
    ds_read_b64_tr_b16 v[88:89], v14 offset:53248
    buffer_store_dwordx4 v[248:251], v229, s[4:7], s54 offen sc1
    s_add_u32 s54, s54, 49152
    v_mfma_f32_16x16x32_bf16 v[184:187], a[148:151], v[72:75], v[184:187]
    ds_read_b64_tr_b16 v[90:91], v14 offset:53760
    v_mfma_f32_16x16x32_bf16 v[216:219], a[152:155], v[72:75], v[216:219]
    ds_read_b64_tr_b16 v[92:93], v15 offset:53248
    s_waitcnt lgkmcnt(7)
    v_mfma_f32_16x16x32_bf16 v[156:159], a[144:147], v[76:79], v[156:159]
    ds_read_b64_tr_b16 v[94:95], v15 offset:53760
    v_mfma_f32_16x16x32_bf16 v[188:191], a[148:151], v[76:79], v[188:191]
    v_mfma_f32_16x16x32_bf16 v[220:223], a[152:155], v[76:79], v[220:223]
    s_waitcnt lgkmcnt(6)
    v_mfma_f32_16x16x32_bf16 v[144:147], a[156:159], v[80:83], v[144:147]
    v_mfma_f32_16x16x32_bf16 v[176:179], a[160:163], v[80:83], v[176:179]
    v_mfma_f32_16x16x32_bf16 v[208:211], a[164:167], v[80:83], v[208:211]
    ds_read_b64_tr_b16 v[64:65], v12 offset:57344
    s_waitcnt lgkmcnt(5)
    v_mfma_f32_16x16x32_bf16 v[148:151], a[156:159], v[84:87], v[148:151]
    ds_read_b64_tr_b16 v[66:67], v12 offset:57856
    v_mfma_f32_16x16x32_bf16 v[180:183], a[160:163], v[84:87], v[180:183]
    ds_read_b64_tr_b16 v[68:69], v13 offset:57344
    v_mfma_f32_16x16x32_bf16 v[212:215], a[164:167], v[84:87], v[212:215]
    ds_read_b64_tr_b16 v[70:71], v13 offset:57856
    s_waitcnt lgkmcnt(6)
    v_mfma_f32_16x16x32_bf16 v[152:155], a[156:159], v[88:91], v[152:155]
    ds_read_b64_tr_b16 v[72:73], v14 offset:57344
    v_mfma_f32_16x16x32_bf16 v[184:187], a[160:163], v[88:91], v[184:187]
    ds_read_b64_tr_b16 v[74:75], v14 offset:57856
    v_mfma_f32_16x16x32_bf16 v[216:219], a[164:167], v[88:91], v[216:219]
    ds_read_b64_tr_b16 v[76:77], v15 offset:57344
    s_waitcnt lgkmcnt(7)
    v_mfma_f32_16x16x32_bf16 v[156:159], a[156:159], v[92:95], v[156:159]
    ds_read_b64_tr_b16 v[78:79], v15 offset:57856
    v_mfma_f32_16x16x32_bf16 v[188:191], a[160:163], v[92:95], v[188:191]
    v_mfma_f32_16x16x32_bf16 v[220:223], a[164:167], v[92:95], v[220:223]
    s_waitcnt lgkmcnt(6)
    v_mfma_f32_16x16x32_bf16 v[144:147], a[168:171], v[64:67], v[144:147]
    v_mfma_f32_16x16x32_bf16 v[176:179], a[172:175], v[64:67], v[176:179]
    v_mfma_f32_16x16x32_bf16 v[208:211], a[176:179], v[64:67], v[208:211]
    ds_read_b64_tr_b16 v[80:81], v12 offset:61440
    s_waitcnt lgkmcnt(5)
    v_mfma_f32_16x16x32_bf16 v[148:151], a[168:171], v[68:71], v[148:151]
    ds_read_b64_tr_b16 v[82:83], v12 offset:61952
    v_mfma_f32_16x16x32_bf16 v[180:183], a[172:175], v[68:71], v[180:183]
    ds_read_b64_tr_b16 v[84:85], v13 offset:61440
    v_mfma_f32_16x16x32_bf16 v[212:215], a[176:179], v[68:71], v[212:215]
    ds_read_b64_tr_b16 v[86:87], v13 offset:61952
    s_waitcnt lgkmcnt(6)
    v_mfma_f32_16x16x32_bf16 v[152:155], a[168:171], v[72:75], v[152:155]
    ds_read_b64_tr_b16 v[88:89], v14 offset:61440
    v_mfma_f32_16x16x32_bf16 v[184:187], a[172:175], v[72:75], v[184:187]
    ds_read_b64_tr_b16 v[90:91], v14 offset:61952
    v_mfma_f32_16x16x32_bf16 v[216:219], a[176:179], v[72:75], v[216:219]
    ds_read_b64_tr_b16 v[92:93], v15 offset:61440
    s_waitcnt lgkmcnt(7)
    v_mfma_f32_16x16x32_bf16 v[156:159], a[168:171], v[76:79], v[156:159]
    ds_read_b64_tr_b16 v[94:95], v15 offset:61952
    v_mfma_f32_16x16x32_bf16 v[188:191], a[172:175], v[76:79], v[188:191]
    v_mfma_f32_16x16x32_bf16 v[220:223], a[176:179], v[76:79], v[220:223]
    buffer_load_dword v62, v63, s[4:7], s74 offen offset:0 sc1
    s_waitcnt lgkmcnt(6)
    v_mfma_f32_16x16x32_bf16 v[144:147], a[180:183], v[80:83], v[144:147]
    v_mfma_f32_16x16x32_bf16 v[176:179], a[184:187], v[80:83], v[176:179]
    v_mfma_f32_16x16x32_bf16 v[208:211], a[188:191], v[80:83], v[208:211]
    s_waitcnt lgkmcnt(4)
    v_mfma_f32_16x16x32_bf16 v[148:151], a[180:183], v[84:87], v[148:151]
    v_mfma_f32_16x16x32_bf16 v[180:183], a[184:187], v[84:87], v[180:183]
    v_mfma_f32_16x16x32_bf16 v[212:215], a[188:191], v[84:87], v[212:215]
    s_waitcnt lgkmcnt(2)
    v_mfma_f32_16x16x32_bf16 v[152:155], a[180:183], v[88:91], v[152:155]
    v_mfma_f32_16x16x32_bf16 v[184:187], a[184:187], v[88:91], v[184:187]
    v_mfma_f32_16x16x32_bf16 v[216:219], a[188:191], v[88:91], v[216:219]
    s_waitcnt lgkmcnt(0)
    v_mfma_f32_16x16x32_bf16 v[156:159], a[180:183], v[92:95], v[156:159]
    v_mfma_f32_16x16x32_bf16 v[188:191], a[184:187], v[92:95], v[188:191]
    v_mfma_f32_16x16x32_bf16 v[220:223], a[188:191], v[92:95], v[220:223]
    s_waitcnt lgkmcnt(0)
    s_waitcnt vmcnt(1)
    s_barrier
    s_mov_b64 exec, s[76:77]
    buffer_store_dword v56, v50, s[4:7], s66 offen offset:128 sc1
    s_mov_b64 exec, -1
    ds_read2st64_b32 v[120:121], v227 offset0:4 offset1:5
    ds_read2st64_b32 v[124:125], v226 offset0:16 offset1:20
    ds_read2st64_b32 v[122:123], v227 offset0:6 offset1:7
    ds_read2st64_b32 v[126:127], v226 offset0:24 offset1:28
    s_waitcnt lgkmcnt(2)
    v_pk_mul_f32 v[120:121], v[120:121], v[230:231] op_sel_hi:[1,0]
    v_pk_fma_f32 v[124:125], v[124:125], v[230:231], v[230:231] op_sel:[0,0,1] op_sel_hi:[1,0,1]
    v_pk_fma_f32 v[124:125], v[120:121], v[120:121], v[124:125] neg_lo:[1,0,0] neg_hi:[1,0,0]
    v_rsq_f32 v40, v124
    v_rsq_f32 v42, v125
    v_mul_f32 v41, -v120, v40
    v_mul_f32 v43, -v121, v42

    s_waitcnt lgkmcnt(0)
    v_pk_mul_f32 v[122:123], v[122:123], v[230:231] op_sel_hi:[1,0]
    v_pk_fma_f32 v[126:127], v[126:127], v[230:231], v[230:231] op_sel:[0,0,1] op_sel_hi:[1,0,1]
    v_pk_fma_f32 v[126:127], v[122:123], v[122:123], v[126:127] neg_lo:[1,0,0] neg_hi:[1,0,0]
    v_rsq_f32 v44, v126
    v_rsq_f32 v46, v127
    v_mul_f32 v45, -v122, v44
    v_mul_f32 v47, -v123, v46

    v_pk_fma_f32 v[96:97], v[16:17], v[40:41], v[28:29] op_sel:[0,1,0] op_sel_hi:[1,1,1]
    v_pk_fma_f32 v[98:99], v[18:19], v[40:41], v[30:31] op_sel:[0,1,0] op_sel_hi:[1,1,1]
    v_pk_fma_f32 v[104:105], v[20:21], v[40:41], v[32:33] op_sel:[0,1,0] op_sel_hi:[1,1,1]
    v_pk_fma_f32 v[106:107], v[22:23], v[40:41], v[34:35] op_sel:[0,1,0] op_sel_hi:[1,1,1]
    v_pk_fma_f32 v[112:113], v[24:25], v[40:41], v[36:37] op_sel:[0,1,0] op_sel_hi:[1,1,1]
    v_pk_fma_f32 v[114:115], v[26:27], v[40:41], v[38:39] op_sel:[0,1,0] op_sel_hi:[1,1,1]
    v_pk_fma_f32 v[96:97], v[144:145], v[40:41], v[96:97] op_sel_hi:[1,0,1]
    v_pk_fma_f32 v[98:99], v[146:147], v[40:41], v[98:99] op_sel_hi:[1,0,1]
    v_pk_fma_f32 v[104:105], v[176:177], v[40:41], v[104:105] op_sel_hi:[1,0,1]
    v_pk_fma_f32 v[106:107], v[178:179], v[40:41], v[106:107] op_sel_hi:[1,0,1]
    v_pk_fma_f32 v[112:113], v[208:209], v[40:41], v[112:113] op_sel_hi:[1,0,1]
    v_pk_fma_f32 v[114:115], v[210:211], v[40:41], v[114:115] op_sel_hi:[1,0,1]
    v_pk_mul_f32 v[100:101], v[96:97], v[96:97]
    v_pk_mul_f32 v[108:109], v[104:105], v[104:105]
    v_pk_mul_f32 v[116:117], v[112:113], v[112:113]
    v_pk_fma_f32 v[100:101], v[100:101], s[56:57], s[56:57] op_sel:[0,0,1] op_sel_hi:[1,0,1]
    v_pk_fma_f32 v[108:109], v[108:109], s[56:57], s[56:57] op_sel:[0,0,1] op_sel_hi:[1,0,1]
    v_pk_fma_f32 v[116:117], v[116:117], s[56:57], s[56:57] op_sel:[0,0,1] op_sel_hi:[1,0,1]
    v_pk_mul_f32 v[100:101], v[100:101], v[96:97]
    v_pk_mul_f32 v[108:109], v[108:109], v[104:105]
    v_pk_mul_f32 v[116:117], v[116:117], v[112:113]
    v_exp_f32 v100, v100
    v_exp_f32 v101, v101
    v_exp_f32 v108, v108
    v_exp_f32 v109, v109
    v_exp_f32 v116, v116
    v_exp_f32 v117, v117
    v_pk_mul_f32 v[96:97], v[96:97], v[98:99]
    v_pk_mul_f32 v[104:105], v[104:105], v[106:107]
    v_pk_mul_f32 v[112:113], v[112:113], v[114:115]
    v_pk_add_f32 v[100:101], v[100:101], 1.0 op_sel_hi:[1,0]
    v_pk_add_f32 v[108:109], v[108:109], 1.0 op_sel_hi:[1,0]
    v_pk_add_f32 v[116:117], v[116:117], 1.0 op_sel_hi:[1,0]
    v_rcp_f32 v100, v100
    v_rcp_f32 v101, v101
    v_rcp_f32 v108, v108
    v_rcp_f32 v109, v109
    v_rcp_f32 v116, v116
    v_rcp_f32 v117, v117
    v_pk_mul_f32 v[96:97], v[96:97], v[100:101]
    v_pk_mul_f32 v[104:105], v[104:105], v[108:109]
    v_pk_mul_f32 v[112:113], v[112:113], v[116:117]
    v_cvt_pk_bf16_f32 v236, v96, v97
    v_cvt_pk_bf16_f32 v237, v104, v105
    v_cvt_pk_bf16_f32 v238, v112, v113
    s_waitcnt vmcnt(1)
    s_mov_b32 s75, 0
    s_branch K3_ph0w0_c
K3_ph0w0:
    buffer_load_dword v62, v63, s[4:7], s74 offen offset:0 sc1
    s_add_u32 s75, s75, 1
    s_waitcnt vmcnt(0)
K3_ph0w0_c:
    v_cmpx_ne_u32 vcc, s30, v62
    s_cmp_gt_u32 s75, 0x40000
    s_cbranch_scc1 K3_ph0w0_x
    s_cbranch_execnz K3_ph0w0
K3_ph0w0_x:
    s_mov_b64 exec, -1

    v_pk_fma_f32 v[96:97], v[16:17], v[42:43], v[28:29] op_sel:[0,1,0] op_sel_hi:[1,1,1]
    v_pk_fma_f32 v[98:99], v[18:19], v[42:43], v[30:31] op_sel:[0,1,0] op_sel_hi:[1,1,1]
    v_pk_fma_f32 v[104:105], v[20:21], v[42:43], v[32:33] op_sel:[0,1,0] op_sel_hi:[1,1,1]
    v_pk_fma_f32 v[106:107], v[22:23], v[42:43], v[34:35] op_sel:[0,1,0] op_sel_hi:[1,1,1]
    v_pk_fma_f32 v[112:113], v[24:25], v[42:43], v[36:37] op_sel:[0,1,0] op_sel_hi:[1,1,1]
    v_pk_fma_f32 v[114:115], v[26:27], v[42:43], v[38:39] op_sel:[0,1,0] op_sel_hi:[1,1,1]
    buffer_load_dwordx4 v[64:67], v52, s[4:7], s64 offen offset:0 sc1
    buffer_load_dwordx4 v[68:71], v52, s[4:7], s64 offen offset:1024 sc1
    v_pk_fma_f32 v[96:97], v[148:149], v[42:43], v[96:97] op_sel_hi:[1,0,1]
    v_pk_fma_f32 v[98:99], v[150:151], v[42:43], v[98:99] op_sel_hi:[1,0,1]
    v_pk_fma_f32 v[104:105], v[180:181], v[42:43], v[104:105] op_sel_hi:[1,0,1]
    v_pk_fma_f32 v[106:107], v[182:183], v[42:43], v[106:107] op_sel_hi:[1,0,1]
    v_pk_fma_f32 v[112:113], v[212:213], v[42:43], v[112:113] op_sel_hi:[1,0,1]
    v_pk_fma_f32 v[114:115], v[214:215], v[42:43], v[114:115] op_sel_hi:[1,0,1]
    buffer_load_dwordx4 v[72:75], v52, s[4:7], s64 offen offset:2048 sc1
    buffer_load_dwordx4 v[76:79], v52, s[4:7], s64 offen offset:3072 sc1
    s_add_u32 s64, s64, 4096
    v_pk_mul_f32 v[100:101], v[96:97], v[96:97]
    v_pk_mul_f32 v[108:109], v[104:105], v[104:105]
    v_pk_mul_f32 v[116:117], v[112:113], v[112:113]
    v_pk_fma_f32 v[100:101], v[100:101], s[56:57], s[56:57] op_sel:[0,0,1] op_sel_hi:[1,0,1]
    v_pk_fma_f32 v[108:109], v[108:109], s[56:57], s[56:57] op_sel:[0,0,1] op_sel_hi:[1,0,1]
    v_pk_fma_f32 v[116:117], v[116:117], s[56:57], s[56:57] op_sel:[0,0,1] op_sel_hi:[1,0,1]
    buffer_load_dwordx4 v[80:83], v52, s[4:7], s64 offen offset:0 sc1
    v_pk_mul_f32 v[100:101], v[100:101], v[96:97]
    v_pk_mul_f32 v[108:109], v[108:109], v[104:105]
    v_pk_mul_f32 v[116:117], v[116:117], v[112:113]
    s_barrier
    ds_read_b32 v239, v234 offset:1024
    ds_read_b32 v243, v234 offset:1280
    v_exp_f32 v100, v100
    v_exp_f32 v101, v101
    v_exp_f32 v108, v108
    v_exp_f32 v109, v109
    v_exp_f32 v116, v116
    v_exp_f32 v117, v117
    buffer_load_dwordx4 v[84:87], v52, s[4:7], s64 offen offset:1024 sc1
    v_pk_mul_f32 v[96:97], v[96:97], v[98:99]
    v_pk_mul_f32 v[104:105], v[104:105], v[106:107]
    v_pk_mul_f32 v[112:113], v[112:113], v[114:115]
    v_pk_add_f32 v[100:101], v[100:101], 1.0 op_sel_hi:[1,0]
    v_pk_add_f32 v[108:109], v[108:109], 1.0 op_sel_hi:[1,0]
    v_pk_add_f32 v[116:117], v[116:117], 1.0 op_sel_hi:[1,0]
    s_waitcnt lgkmcnt(0)
    buffer_store_dwordx4 v[236:239], v229, s[4:7], s54 offen sc1
    s_add_u32 s54, s54, 49152
    v_rcp_f32 v100, v100
    v_rcp_f32 v101, v101
    v_rcp_f32 v108, v108
    v_rcp_f32 v109, v109
    v_rcp_f32 v116, v116
    v_rcp_f32 v117, v117
    buffer_load_dwordx4 v[88:91], v52, s[4:7], s64 offen offset:2048 sc1
    buffer_load_dwordx4 v[92:95], v52, s[4:7], s64 offen offset:3072 sc1
    s_add_u32 s64, s64, 4096
    v_pk_mul_f32 v[96:97], v[96:97], v[100:101]
    v_pk_mul_f32 v[104:105], v[104:105], v[108:109]
    v_pk_mul_f32 v[112:113], v[112:113], v[116:117]
    v_cvt_pk_bf16_f32 v240, v96, v97
    v_cvt_pk_bf16_f32 v241, v104, v105
    v_cvt_pk_bf16_f32 v242, v112, v113
    v_pk_fma_f32 v[96:97], v[16:17], v[44:45], v[28:29] op_sel:[0,1,0] op_sel_hi:[1,1,1]
    v_pk_fma_f32 v[98:99], v[18:19], v[44:45], v[30:31] op_sel:[0,1,0] op_sel_hi:[1,1,1]
    v_pk_fma_f32 v[104:105], v[20:21], v[44:45], v[32:33] op_sel:[0,1,0] op_sel_hi:[1,1,1]
    v_pk_fma_f32 v[106:107], v[22:23], v[44:45], v[34:35] op_sel:[0,1,0] op_sel_hi:[1,1,1]
    v_pk_fma_f32 v[112:113], v[24:25], v[44:45], v[36:37] op_sel:[0,1,0] op_sel_hi:[1,1,1]
    v_pk_fma_f32 v[114:115], v[26:27], v[44:45], v[38:39] op_sel:[0,1,0] op_sel_hi:[1,1,1]
    buffer_load_dwordx4 v[128:131], v52, s[4:7], s64 offen offset:0 sc1
    buffer_load_dwordx4 v[132:135], v52, s[4:7], s64 offen offset:1024 sc1
    v_pk_fma_f32 v[96:97], v[152:153], v[44:45], v[96:97] op_sel_hi:[1,0,1]
    v_pk_fma_f32 v[98:99], v[154:155], v[44:45], v[98:99] op_sel_hi:[1,0,1]
    v_pk_fma_f32 v[104:105], v[184:185], v[44:45], v[104:105] op_sel_hi:[1,0,1]
    v_pk_fma_f32 v[106:107], v[186:187], v[44:45], v[106:107] op_sel_hi:[1,0,1]
    v_pk_fma_f32 v[112:113], v[216:217], v[44:45], v[112:113] op_sel_hi:[1,0,1]
    v_pk_fma_f32 v[114:115], v[218:219], v[44:45], v[114:115] op_sel_hi:[1,0,1]
    buffer_load_dwordx4 v[136:139], v52, s[4:7], s64 offen offset:2048 sc1
    buffer_load_dwordx4 v[140:143], v52, s[4:7], s64 offen offset:3072 sc1
    s_add_u32 s64, s64, 90112
    v_pk_mul_f32 v[100:101], v[96:97], v[96:97]
    v_pk_mul_f32 v[108:109], v[104:105], v[104:105]
    v_pk_mul_f32 v[116:117], v[112:113], v[112:113]
    v_pk_fma_f32 v[100:101], v[100:101], s[56:57], s[56:57] op_sel:[0,0,1] op_sel_hi:[1,0,1]
    v_pk_fma_f32 v[108:109], v[108:109], s[56:57], s[56:57] op_sel:[0,0,1] op_sel_hi:[1,0,1]
    v_pk_fma_f32 v[116:117], v[116:117], s[56:57], s[56:57] op_sel:[0,0,1] op_sel_hi:[1,0,1]
    v_pk_mul_f32 v[100:101], v[100:101], v[96:97]
    v_pk_mul_f32 v[108:109], v[108:109], v[104:105]
    v_pk_mul_f32 v[116:117], v[116:117], v[112:113]
    v_exp_f32 v100, v100
    v_exp_f32 v101, v101
    v_exp_f32 v108, v108
    v_exp_f32 v109, v109
    v_exp_f32 v116, v116
    v_exp_f32 v117, v117
    v_pk_mul_f32 v[96:97], v[96:97], v[98:99]
    v_pk_mul_f32 v[104:105], v[104:105], v[106:107]
    v_pk_mul_f32 v[112:113], v[112:113], v[114:115]
    v_pk_add_f32 v[100:101], v[100:101], 1.0 op_sel_hi:[1,0]
    v_pk_add_f32 v[108:109], v[108:109], 1.0 op_sel_hi:[1,0]
    v_pk_add_f32 v[116:117], v[116:117], 1.0 op_sel_hi:[1,0]
    buffer_store_dwordx4 v[240:243], v229, s[4:7], s54 offen sc1
    s_add_u32 s54, s54, 49152
    v_rcp_f32 v100, v100
    v_rcp_f32 v101, v101
    v_rcp_f32 v108, v108
    v_rcp_f32 v109, v109
    v_rcp_f32 v116, v116
    v_rcp_f32 v117, v117
    v_pk_mul_f32 v[96:97], v[96:97], v[100:101]
    v_pk_mul_f32 v[104:105], v[104:105], v[108:109]
    v_pk_mul_f32 v[112:113], v[112:113], v[116:117]
    v_cvt_pk_bf16_f32 v244, v96, v97
    v_cvt_pk_bf16_f32 v245, v104, v105
    v_cvt_pk_bf16_f32 v246, v112, v113
    buffer_load_dword v62, v63, s[4:7], s74 offen offset:128 sc1
    v_pk_fma_f32 v[96:97], v[16:17], v[46:47], v[28:29] op_sel:[0,1,0] op_sel_hi:[1,1,1]
    v_pk_fma_f32 v[98:99], v[18:19], v[46:47], v[30:31] op_sel:[0,1,0] op_sel_hi:[1,1,1]
    v_pk_fma_f32 v[104:105], v[20:21], v[46:47], v[32:33] op_sel:[0,1,0] op_sel_hi:[1,1,1]
    v_pk_fma_f32 v[106:107], v[22:23], v[46:47], v[34:35] op_sel:[0,1,0] op_sel_hi:[1,1,1]
    v_pk_fma_f32 v[112:113], v[24:25], v[46:47], v[36:37] op_sel:[0,1,0] op_sel_hi:[1,1,1]
    v_pk_fma_f32 v[114:115], v[26:27], v[46:47], v[38:39] op_sel:[0,1,0] op_sel_hi:[1,1,1]
    v_pk_fma_f32 v[96:97], v[156:157], v[46:47], v[96:97] op_sel_hi:[1,0,1]
    v_pk_fma_f32 v[98:99], v[158:159], v[46:47], v[98:99] op_sel_hi:[1,0,1]
    v_pk_fma_f32 v[104:105], v[188:189], v[46:47], v[104:105] op_sel_hi:[1,0,1]
    v_pk_fma_f32 v[106:107], v[190:191], v[46:47], v[106:107] op_sel_hi:[1,0,1]
    v_pk_fma_f32 v[112:113], v[220:221], v[46:47], v[112:113] op_sel_hi:[1,0,1]
    v_pk_fma_f32 v[114:115], v[222:223], v[46:47], v[114:115] op_sel_hi:[1,0,1]
    v_pk_mul_f32 v[100:101], v[96:97], v[96:97]
    v_pk_mul_f32 v[108:109], v[104:105], v[104:105]
    v_pk_mul_f32 v[116:117], v[112:113], v[112:113]
    v_pk_fma_f32 v[100:101], v[100:101], s[56:57], s[56:57] op_sel:[0,0,1] op_sel_hi:[1,0,1]
    v_pk_fma_f32 v[108:109], v[108:109], s[56:57], s[56:57] op_sel:[0,0,1] op_sel_hi:[1,0,1]
    v_pk_fma_f32 v[116:117], v[116:117], s[56:57], s[56:57] op_sel:[0,0,1] op_sel_hi:[1,0,1]
    v_pk_mul_f32 v[100:101], v[100:101], v[96:97]
    v_pk_mul_f32 v[108:109], v[108:109], v[104:105]
    v_pk_mul_f32 v[116:117], v[116:117], v[112:113]
    s_barrier
    ds_read_b32 v247, v234 offset:1536
    ds_read_b32 v251, v234 offset:1792
    v_exp_f32 v100, v100
    v_exp_f32 v101, v101
    v_exp_f32 v108, v108
    v_exp_f32 v109, v109
    v_exp_f32 v116, v116
    v_exp_f32 v117, v117
    v_pk_mul_f32 v[96:97], v[96:97], v[98:99]
    v_pk_mul_f32 v[104:105], v[104:105], v[106:107]
    v_pk_mul_f32 v[112:113], v[112:113], v[114:115]
    v_pk_add_f32 v[100:101], v[100:101], 1.0 op_sel_hi:[1,0]
    v_pk_add_f32 v[108:109], v[108:109], 1.0 op_sel_hi:[1,0]
    v_pk_add_f32 v[116:117], v[116:117], 1.0 op_sel_hi:[1,0]
    s_waitcnt lgkmcnt(0)
    buffer_store_dwordx4 v[244:247], v229, s[4:7], s54 offen sc1
    s_add_u32 s54, s54, 49152
    v_rcp_f32 v100, v100
    v_rcp_f32 v101, v101
    v_rcp_f32 v108, v108
    v_rcp_f32 v109, v109
    v_rcp_f32 v116, v116
    v_rcp_f32 v117, v117
    v_pk_mul_f32 v[96:97], v[96:97], v[100:101]
    v_pk_mul_f32 v[104:105], v[104:105], v[108:109]
    v_pk_mul_f32 v[112:113], v[112:113], v[116:117]
    v_cvt_pk_bf16_f32 v248, v96, v97
    v_cvt_pk_bf16_f32 v249, v104, v105
    v_cvt_pk_bf16_f32 v250, v112, v113
    buffer_store_dwordx4 v[248:251], v229, s[4:7], s54 offen sc1
    s_add_u32 s54, s54, 49152
    s_branch K3_p2
K3_w3:
    buffer_load_dwordx4 a[0:3], v7, s[4:7], s50 offen offset:0 sc1
    buffer_load_dwordx4 a[4:7], v7, s[4:7], s50 offen offset:1024 sc1
    s_add_u32 s50, s50, 11264
    buffer_load_dwordx4 a[12:15], v7, s[4:7], s50 offen offset:0 sc1
    buffer_load_dwordx4 a[16:19], v7, s[4:7], s50 offen offset:1024 sc1
    s_add_u32 s50, s50, 11264
    buffer_load_dwordx4 a[24:27], v7, s[4:7], s50 offen offset:0 sc1
    buffer_load_dwordx4 a[28:31], v7, s[4:7], s50 offen offset:1024 sc1
    s_add_u32 s50, s50, 11264
    buffer_load_dwordx4 a[36:39], v7, s[4:7], s50 offen offset:0 sc1
    buffer_load_dwordx4 a[40:43], v7, s[4:7], s50 offen offset:1024 sc1
    s_add_u32 s50, s50, 11264
    v_lshlrev_b32 v224, 3, v0
    s_mul_i32 s52, s10, 1536
    s_add_u32 s52, s52, 17170432
    s_lshl_b32 s54, s8, 7
    s_add_u32 s54, s54, s10
    s_mul_i32 s54, s54, 3072
    s_add_u32 s54, s54, 10878976
    s_mov_b32 s56, 0xbdd2d3e8
    s_mov_b32 s57, 0xc0135761
    v_and_b32 v225, 15, v2
    v_lshl_add_u32 v226, v5, 4, v225
    v_lshlrev_b32 v226, 4, v226
    v_and_b32 v227, 3, v2
    v_lshl_add_u32 v226, v227, 2, v226
    v_add_u32 v226, 131072, v226
    v_lshlrev_b32 v227, 2, v225
    v_add_u32 v227, 139456, v227
    v_lshrrev_b32 v228, 3, v0
    v_lshlrev_b32 v228, 6, v228
    v_and_b32 v229, 3, v0
    v_lshl_add_u32 v228, v229, 4, v228
    v_bfe_u32 v229, v0, 2, 1
    v_lshl_add_u32 v228, v229, 3, v228
    v_add_u32 v228, 141312, v228
    s_mul_i32 s53, s3, 192
    s_add_u32 s53, s53, 141312
    v_lshl_add_u32 v232, v4, 4, s53
    v_mov_b32 v230, 0x3b000000
    v_mov_b32 v231, 0x3727c5ac
    s_mov_b32 s59, 0

    v_lshlrev_b32 v52, 4, v2
    v_mul_u32_u24 v53, 12, v2
    s_lshl_b32 s60, s62, 4
    s_lshl_b32 s63, s3, 2
    s_add_u32 s60, s60, s63
    s_mul_i32 s60, s60, 11264
    s_add_u32 s60, s60, 4390912

    s_lshr_b32 s63, s61, 1
    s_lshl_b32 s63, s63, 3
    s_and_b32 s64, s61, 1
    s_add_u32 s63, s63, s64
    s_lshl_b32 s64, s63, 4
    s_lshl_b32 s65, s3, 2
    s_add_u32 s64, s64, s65
    s_mul_i32 s64, s64, 3072
    s_add_u32 s64, s64, 10878976
    s_lshl_b32 s65, s3, 1
    s_add_u32 s63, s63, s65
    v_and_b32 v57, 15, v2
    v_lshrrev_b32 v58, 4, v2
    v_mul_u32_u24 v59, 4*4352, v57
    v_lshl_add_u32 v59, v58, 3, v59
    s_mul_i32 s70, s62, 64*4352
    s_lshl_b32 s71, s63, 5
    s_add_u32 s70, s70, s71
    s_add_u32 s70, s70, 18874368
    v_lshlrev_b32 v60, 4, v57
    s_lshl_b32 s71, s62, 8
    s_add_u32 s71, s71, 2123776
    v_lshlrev_b32 v61, 12, v58
    v_lshl_add_u32 v61, v57, 3, v61
    s_lshl_b32 s72, s63, 14
    s_lshl_b32 s73, s62, 7
    s_add_u32 s72, s72, s73
    s_lshl_b32 s73, s3, 12
    v_add_u32 v54, s73, v52
    s_lshl_b32 s73, s3, 14
    v_add_u32 v55, s73, v52
    s_mov_b32 s14, 0x200000
    s_mov_b32 s15, 0x20000

    s_lshl_b32 s74, s8, 13
    s_add_u32 s74, s74, 2359296
    s_lshl_b32 s66, s10, 9
    s_add_u32 s66, s66, s74
    s_lshl_b32 s75, s3, 11
    s_add_u32 s74, s74, s75
    v_and_b32 v63, 3, v2
    v_lshlrev_b32 v63, 9, v63
    s_mov_b32 s76, 1
    s_mov_b32 s77, 0
    s_lshl_b32 s28, s2, 7
    s_add_u32 s28, s28, 2269184
    s_mov_b32 s29, 2269184
    v_mov_b32 v56, s30
    v_lshlrev_b32 v49, 7, v0
    s_cmp_eq_u32 s3, 1
    s_waitcnt vmcnt(8)
    s_barrier
    s_cbranch_scc0 K3_nf1
    s_mov_b64 exec, 1
    buffer_store_dword v56, off, s[4:7], s28 sc1
    s_mov_b64 exec, -1
K3_nf1:

    buffer_load_dwordx4 a[48:51], v7, s[4:7], s50 offen offset:0 sc1
    buffer_load_dwordx4 a[52:55], v7, s[4:7], s50 offen offset:1024 sc1
    s_add_u32 s50, s50, 11264
    buffer_load_dwordx4 a[60:63], v7, s[4:7], s50 offen offset:0 sc1
    buffer_load_dwordx4 a[64:67], v7, s[4:7], s50 offen offset:1024 sc1
    s_add_u32 s50, s50, 11264
    buffer_load_dwordx4 a[72:75], v7, s[4:7], s50 offen offset:0 sc1
    buffer_load_dwordx4 a[76:79], v7, s[4:7], s50 offen offset:1024 sc1
    s_add_u32 s50, s50, 11264
    buffer_load_dwordx4 a[84:87], v7, s[4:7], s50 offen offset:0 sc1
    buffer_load_dwordx4 a[88:91], v7, s[4:7], s50 offen offset:1024 sc1
    s_add_u32 s50, s50, 11264
    buffer_load_dwordx4 a[96:99], v7, s[4:7], s50 offen offset:0 sc1
    buffer_load_dwordx4 a[100:103], v7, s[4:7], s50 offen offset:1024 sc1
    s_add_u32 s50, s50, 11264
    buffer_load_dwordx4 a[108:111], v7, s[4:7], s50 offen offset:0 sc1
    buffer_load_dwordx4 a[112:115], v7, s[4:7], s50 offen offset:1024 sc1
    s_add_u32 s50, s50, 11264
    buffer_load_dwordx4 a[120:123], v7, s[4:7], s50 offen offset:0 sc1
    buffer_load_dwordx4 a[124:127], v7, s[4:7], s50 offen offset:1024 sc1
    s_add_u32 s50, s50, 11264
    buffer_load_dwordx4 a[132:135], v7, s[4:7], s50 offen offset:0 sc1
    buffer_load_dwordx4 a[136:139], v7, s[4:7], s50 offen offset:1024 sc1
    s_add_u32 s50, s50, 11264
    buffer_load_dwordx4 a[144:147], v7, s[4:7], s50 offen offset:0 sc1
    buffer_load_dwordx4 a[148:151], v7, s[4:7], s50 offen offset:1024 sc1
    s_add_u32 s50, s50, 11264
    buffer_load_dwordx4 a[156:159], v7, s[4:7], s50 offen offset:0 sc1
    buffer_load_dwordx4 a[160:163], v7, s[4:7], s50 offen offset:1024 sc1
    s_add_u32 s50, s50, 11264
    buffer_load_dword v62, v49, s[4:7], s29 offen sc1
    buffer_load_dwordx4 a[168:171], v7, s[4:7], s50 offen offset:0 sc1
    buffer_load_dwordx4 a[172:175], v7, s[4:7], s50 offen offset:1024 sc1
    s_add_u32 s50, s50, 11264
    buffer_load_dwordx4 a[180:183], v7, s[4:7], s50 offen offset:0 sc1
    buffer_load_dwordx4 a[184:187], v7, s[4:7], s50 offen offset:1024 sc1
    s_add_u32 s50, s50, 11264
    v_lshlrev_b32 v233, 4, v2
    v_add_u32 v233, 131072, v233
    v_lshlrev_b32 v234, 2, v2
    v_add_u32 v234, 139264, v234
    v_mov_b32 v229, 0x40000000
    v_mov_b32 v50, 0
    s_waitcnt vmcnt(4)
    s_mov_b32 s75, 0
    s_branch K3_px1_c
K3_px1:
    buffer_load_dword v62, v49, s[4:7], s29 offen offset:0 sc1
    s_add_u32 s75, s75, 1
    s_waitcnt vmcnt(0)
K3_px1_c:
    v_cmpx_ne_u32 vcc, s30, v62
    s_cmp_gt_u32 s75, 0x40000
    s_cbranch_scc1 K3_px1_x
    s_cbranch_execnz K3_px1
K3_px1_x:
    s_mov_b64 exec, -1

    s_barrier
    buffer_load_dwordx4 v3, s[4:7], s48 offen sc1 lds
    s_add_u32 s49, s49, 0x1000
    s_add_u32 s48, s48, 32*4352
    s_mov_b32 m0, s49
    s_nop 0
    buffer_load_dwordx4 v3, s[4:7], s48 offen sc1 lds
    s_add_u32 s49, s49, 0x1000
    s_add_u32 s48, s48, 32*4352
    s_mov_b32 m0, s49
    s_nop 0
    buffer_load_dwordx4 v3, s[4:7], s48 offen sc1 lds
    s_add_u32 s49, s49, 0x1000
    s_add_u32 s48, s48, 32*4352
    s_mov_b32 m0, s49
    s_nop 0
    buffer_load_dwordx4 v3, s[4:7], s48 offen sc1 lds
    s_add_u32 s49, s49, 0x1000
    s_add_u32 s48, s48, 32*4352
    s_mov_b32 m0, s49
    s_nop 0
    buffer_load_dwordx4 v3, s[4:7], s48 offen sc1 lds
    s_add_u32 s49, s49, 0x1000
    s_add_u32 s48, s48, 32*4352
    s_mov_b32 m0, s49
    s_nop 0
    buffer_load_dwordx4 v3, s[4:7], s48 offen sc1 lds
    s_add_u32 s49, s49, 0x1000
    s_add_u32 s48, s48, 32*4352
    s_mov_b32 m0, s49
    s_nop 0
    buffer_load_dwordx4 v3, s[4:7], s48 offen sc1 lds
    s_add_u32 s49, s49, 0x1000
    s_add_u32 s48, s48, 32*4352
    s_mov_b32 m0, s49
    s_nop 0
    buffer_load_dwordx4 v3, s[4:7], s48 offen sc1 lds
    s_add_u32 s49, s49, 0x1000
    s_add_u32 s48, s48, 32*4352
    s_mov_b32 m0, s49
    s_nop 0
    s_waitcnt vmcnt(7)
    s_barrier
    ds_read_b64_tr_b16 v[64:65], v8 offset:0
    ds_read_b64_tr_b16 v[66:67], v8 offset:512
    ds_read_b64_tr_b16 v[68:69], v9 offset:0
    ds_read_b64_tr_b16 v[70:71], v9 offset:512
    ds_read_b64_tr_b16 v[72:73], v10 offset:0
    ds_read_b64_tr_b16 v[74:75], v10 offset:512
    ds_read_b64_tr_b16 v[76:77], v11 offset:0
    ds_read_b64_tr_b16 v[78:79], v11 offset:512
    v_mov_b32 v51, s57
    s_waitcnt lgkmcnt(6)
    v_mfma_f32_16x16x32_bf16 v[128:131], a[0:3], v[64:67], 0
    v_mfma_f32_16x16x32_bf16 v[160:163], a[4:7], v[64:67], 0
    buffer_load_dwordx4 v3, s[4:7], s48 offen sc1 lds
    s_add_u32 s49, s49, 0x1000
    s_add_u32 s48, s48, 32*4352
    s_mov_b32 m0, s49
    s_waitcnt vmcnt(6)
    s_barrier
    v_mfma_f32_16x16x32_bf16 v[192:195], v[64:67], v[64:67], 0
    ds_read_b64_tr_b16 v[80:81], v8 offset:4096
    s_waitcnt lgkmcnt(5)
    v_mfma_f32_16x16x32_bf16 v[132:135], a[0:3], v[68:71], 0
    ds_read_b64_tr_b16 v[82:83], v8 offset:4608
    v_mfma_f32_16x16x32_bf16 v[164:167], a[4:7], v[68:71], 0
    ds_read_b64_tr_b16 v[84:85], v9 offset:4096
    v_mfma_f32_16x16x32_bf16 v[196:199], v[68:71], v[68:71], 0
    ds_read_b64_tr_b16 v[86:87], v9 offset:4608
    s_waitcnt lgkmcnt(6)
    v_mfma_f32_16x16x32_bf16 v[136:139], a[0:3], v[72:75], 0
    ds_read_b64_tr_b16 v[88:89], v10 offset:4096
    v_mfma_f32_16x16x32_bf16 v[168:171], a[4:7], v[72:75], 0
    ds_read_b64_tr_b16 v[90:91], v10 offset:4608
    buffer_load_dwordx4 v3, s[4:7], s48 offen sc1 lds
    s_add_u32 s49, s49, 0x1000
    s_add_u32 s48, s48, 32*4352
    s_mov_b32 m0, s49
    v_mfma_f32_16x16x32_bf16 v[200:203], v[72:75], v[72:75], 0
    ds_read_b64_tr_b16 v[92:93], v11 offset:4096
    s_waitcnt lgkmcnt(7)
    v_mfma_f32_16x16x32_bf16 v[140:143], a[0:3], v[76:79], 0
    ds_read_b64_tr_b16 v[94:95], v11 offset:4608
    v_mfma_f32_16x16x32_bf16 v[172:175], a[4:7], v[76:79], 0
    v_mfma_f32_16x16x32_bf16 v[204:207], v[76:79], v[76:79], 0
    s_waitcnt lgkmcnt(6)
    v_mfma_f32_16x16x32_bf16 v[128:131], a[12:15], v[80:83], v[128:131]
    v_mfma_f32_16x16x32_bf16 v[160:163], a[16:19], v[80:83], v[160:163]
    buffer_load_dwordx4 v3, s[4:7], s48 offen sc1 lds
    s_add_u32 s49, s49, 0x1000
    s_add_u32 s48, s48, 32*4352
    s_mov_b32 m0, s49
    v_mfma_f32_16x16x32_bf16 v[192:195], v[80:83], v[80:83], v[192:195]
    ds_read_b64_tr_b16 v[64:65], v8 offset:8192
    s_waitcnt lgkmcnt(5)
    v_mfma_f32_16x16x32_bf16 v[132:135], a[12:15], v[84:87], v[132:135]
    ds_read_b64_tr_b16 v[66:67], v8 offset:8704
    v_mfma_f32_16x16x32_bf16 v[164:167], a[16:19], v[84:87], v[164:167]
    ds_read_b64_tr_b16 v[68:69], v9 offset:8192
    v_mfma_f32_16x16x32_bf16 v[196:199], v[84:87], v[84:87], v[196:199]
    ds_read_b64_tr_b16 v[70:71], v9 offset:8704
    s_waitcnt lgkmcnt(6)
    v_mfma_f32_16x16x32_bf16 v[136:139], a[12:15], v[88:91], v[136:139]
    ds_read_b64_tr_b16 v[72:73], v10 offset:8192
    v_mfma_f32_16x16x32_bf16 v[168:171], a[16:19], v[88:91], v[168:171]
    ds_read_b64_tr_b16 v[74:75], v10 offset:8704
    buffer_load_dwordx4 v3, s[4:7], s48 offen sc1 lds
    s_add_u32 s49, s49, 0x1000
    s_add_u32 s48, s48, 32*4352
    s_mov_b32 m0, s49
    v_mfma_f32_16x16x32_bf16 v[200:203], v[88:91], v[88:91], v[200:203]
    ds_read_b64_tr_b16 v[76:77], v11 offset:8192
    s_waitcnt lgkmcnt(7)
    v_mfma_f32_16x16x32_bf16 v[140:143], a[12:15], v[92:95], v[140:143]
    ds_read_b64_tr_b16 v[78:79], v11 offset:8704
    v_mfma_f32_16x16x32_bf16 v[172:175], a[16:19], v[92:95], v[172:175]
    v_mfma_f32_16x16x32_bf16 v[204:207], v[92:95], v[92:95], v[204:207]
    s_waitcnt lgkmcnt(6)
    v_mfma_f32_16x16x32_bf16 v[128:131], a[24:27], v[64:67], v[128:131]
    v_mfma_f32_16x16x32_bf16 v[160:163], a[28:31], v[64:67], v[160:163]
    buffer_load_dwordx4 v3, s[4:7], s48 offen sc1 lds
    s_add_u32 s49, s49, 0x1000
    s_add_u32 s48, s48, 32*4352
    s_mov_b32 m0, s49
    s_waitcnt vmcnt(8)
    s_barrier
    v_mfma_f32_16x16x32_bf16 v[192:195], v[64:67], v[64:67], v[192:195]
    ds_read_b64_tr_b16 v[80:81], v8 offset:12288
    s_waitcnt lgkmcnt(5)
    v_mfma_f32_16x16x32_bf16 v[132:135], a[24:27], v[68:71], v[132:135]
    ds_read_b64_tr_b16 v[82:83], v8 offset:12800
    v_mfma_f32_16x16x32_bf16 v[164:167], a[28:31], v[68:71], v[164:167]
    ds_read_b64_tr_b16 v[84:85], v9 offset:12288
    v_mfma_f32_16x16x32_bf16 v[196:199], v[68:71], v[68:71], v[196:199]
    ds_read_b64_tr_b16 v[86:87], v9 offset:12800
    s_waitcnt lgkmcnt(6)
    v_mfma_f32_16x16x32_bf16 v[136:139], a[24:27], v[72:75], v[136:139]
    ds_read_b64_tr_b16 v[88:89], v10 offset:12288
    v_mfma_f32_16x16x32_bf16 v[168:171], a[28:31], v[72:75], v[168:171]
    ds_read_b64_tr_b16 v[90:91], v10 offset:12800
    buffer_load_dwordx4 v3, s[4:7], s48 offen sc1 lds
    s_add_u32 s49, s49, 0x1000
    s_add_u32 s48, s48, 32*4352
    s_mov_b32 m0, s49
    v_mfma_f32_16x16x32_bf16 v[200:203], v[72:75], v[72:75], v[200:203]
    ds_read_b64_tr_b16 v[92:93], v11 offset:12288
    s_waitcnt lgkmcnt(7)
    v_mfma_f32_16x16x32_bf16 v[140:143], a[24:27], v[76:79], v[140:143]
    ds_read_b64_tr_b16 v[94:95], v11 offset:12800
    v_mfma_f32_16x16x32_bf16 v[172:175], a[28:31], v[76:79], v[172:175]
    v_mfma_f32_16x16x32_bf16 v[204:207], v[76:79], v[76:79], v[204:207]
    s_waitcnt lgkmcnt(6)
    v_mfma_f32_16x16x32_bf16 v[128:131], a[36:39], v[80:83], v[128:131]
    v_mfma_f32_16x16x32_bf16 v[160:163], a[40:43], v[80:83], v[160:163]
    buffer_load_dwordx4 v3, s[4:7], s48 offen sc1 lds
    s_add_u32 s49, s49, 0x1000
    s_add_u32 s48, s48, 32*4352
    s_mov_b32 m0, s49
    v_mfma_f32_16x16x32_bf16 v[192:195], v[80:83], v[80:83], v[192:195]
    ds_read_b64_tr_b16 v[64:65], v8 offset:16384
    s_waitcnt lgkmcnt(5)
    v_mfma_f32_16x16x32_bf16 v[132:135], a[36:39], v[84:87], v[132:135]
    ds_read_b64_tr_b16 v[66:67], v8 offset:16896
    v_mfma_f32_16x16x32_bf16 v[164:167], a[40:43], v[84:87], v[164:167]
    ds_read_b64_tr_b16 v[68:69], v9 offset:16384
    buffer_load_dwordx4 v3, s[4:7], s48 offen sc1 lds
    s_add_u32 s49, s49, 0x1000
    s_sub_u32 s48, s48, 480*4352-128
    s_mov_b32 m0, s49
    v_mfma_f32_16x16x32_bf16 v[196:199], v[84:87], v[84:87], v[196:199]
    ds_read_b64_tr_b16 v[70:71], v9 offset:16896
    s_waitcnt lgkmcnt(6)
    v_mfma_f32_16x16x32_bf16 v[136:139], a[36:39], v[88:91], v[136:139]
    ds_read_b64_tr_b16 v[72:73], v10 offset:16384
    v_mfma_f32_16x16x32_bf16 v[168:171], a[40:43], v[88:91], v[168:171]
    ds_read_b64_tr_b16 v[74:75], v10 offset:16896
    buffer_load_dwordx4 v3, s[4:7], s48 offen sc1 lds
    s_add_u32 s49, s49, 0x1000
    s_add_u32 s48, s48, 32*4352
    s_mov_b32 m0, s49
    v_mfma_f32_16x16x32_bf16 v[200:203], v[88:91], v[88:91], v[200:203]
    ds_read_b64_tr_b16 v[76:77], v11 offset:16384
    s_waitcnt lgkmcnt(7)
    v_mfma_f32_16x16x32_bf16 v[140:143], a[36:39], v[92:95], v[140:143]
    ds_read_b64_tr_b16 v[78:79], v11 offset:16896
    v_mfma_f32_16x16x32_bf16 v[172:175], a[40:43], v[92:95], v[172:175]
    buffer_load_dwordx4 v3, s[4:7], s48 offen sc1 lds
    s_add_u32 s49, s49, 0x1000
    s_add_u32 s48, s48, 32*4352
    s_mov_b32 m0, s49
    v_mfma_f32_16x16x32_bf16 v[204:207], v[92:95], v[92:95], v[204:207]
    s_waitcnt lgkmcnt(6)
    v_mfma_f32_16x16x32_bf16 v[128:131], a[48:51], v[64:67], v[128:131]
    v_mfma_f32_16x16x32_bf16 v[160:163], a[52:55], v[64:67], v[160:163]
    buffer_load_dwordx4 v3, s[4:7], s48 offen sc1 lds
    s_add_u32 s49, s49, 0x1000
    s_add_u32 s48, s48, 32*4352
    s_mov_b32 m0, s49
    s_waitcnt vmcnt(12)
    s_barrier
    v_mfma_f32_16x16x32_bf16 v[192:195], v[64:67], v[64:67], v[192:195]
    ds_read_b64_tr_b16 v[80:81], v8 offset:20480
    s_waitcnt lgkmcnt(5)
    v_mfma_f32_16x16x32_bf16 v[132:135], a[48:51], v[68:71], v[132:135]
    ds_read_b64_tr_b16 v[82:83], v8 offset:20992
    v_mfma_f32_16x16x32_bf16 v[164:167], a[52:55], v[68:71], v[164:167]
    ds_read_b64_tr_b16 v[84:85], v9 offset:20480
    buffer_load_dwordx4 v3, s[4:7], s48 offen sc1 lds
    s_add_u32 s49, s49, 0x1000
    s_add_u32 s48, s48, 32*4352
    s_mov_b32 m0, s49
    v_mfma_f32_16x16x32_bf16 v[196:199], v[68:71], v[68:71], v[196:199]
    ds_read_b64_tr_b16 v[86:87], v9 offset:20992
    s_waitcnt lgkmcnt(6)
    v_mfma_f32_16x16x32_bf16 v[136:139], a[48:51], v[72:75], v[136:139]
    ds_read_b64_tr_b16 v[88:89], v10 offset:20480
    v_mfma_f32_16x16x32_bf16 v[168:171], a[52:55], v[72:75], v[168:171]
    ds_read_b64_tr_b16 v[90:91], v10 offset:20992
    buffer_load_dwordx4 v3, s[4:7], s48 offen sc1 lds
    s_add_u32 s49, s49, 0x1000
    s_add_u32 s48, s48, 32*4352
    s_mov_b32 m0, s49
    v_mfma_f32_16x16x32_bf16 v[200:203], v[72:75], v[72:75], v[200:203]
    ds_read_b64_tr_b16 v[92:93], v11 offset:20480
    s_waitcnt lgkmcnt(7)
    v_mfma_f32_16x16x32_bf16 v[140:143], a[48:51], v[76:79], v[140:143]
    ds_read_b64_tr_b16 v[94:95], v11 offset:20992
    v_mfma_f32_16x16x32_bf16 v[172:175], a[52:55], v[76:79], v[172:175]
    buffer_load_dwordx4 v3, s[4:7], s48 offen sc1 lds
    s_add_u32 s49, s49, 0x1000
    s_add_u32 s48, s48, 32*4352
    s_mov_b32 m0, s49
    v_mfma_f32_16x16x32_bf16 v[204:207], v[76:79], v[76:79], v[204:207]
    s_waitcnt lgkmcnt(6)
    v_mfma_f32_16x16x32_bf16 v[128:131], a[60:63], v[80:83], v[128:131]
    v_mfma_f32_16x16x32_bf16 v[160:163], a[64:67], v[80:83], v[160:163]
    buffer_load_dwordx4 v3, s[4:7], s48 offen sc1 lds
    s_add_u32 s49, s49, 0x1000
    s_add_u32 s48, s48, 32*4352
    s_mov_b32 m0, s49
    v_mfma_f32_16x16x32_bf16 v[192:195], v[80:83], v[80:83], v[192:195]
    ds_read_b64_tr_b16 v[64:65], v8 offset:24576
    s_waitcnt lgkmcnt(5)
    v_mfma_f32_16x16x32_bf16 v[132:135], a[60:63], v[84:87], v[132:135]
    ds_read_b64_tr_b16 v[66:67], v8 offset:25088
    v_mfma_f32_16x16x32_bf16 v[164:167], a[64:67], v[84:87], v[164:167]
    ds_read_b64_tr_b16 v[68:69], v9 offset:24576
    buffer_load_dwordx4 v3, s[4:7], s48 offen sc1 lds
    s_add_u32 s49, s49, 0x1000
    s_add_u32 s48, s48, 32*4352
    s_mov_b32 m0, s49
    v_mfma_f32_16x16x32_bf16 v[196:199], v[84:87], v[84:87], v[196:199]
    ds_read_b64_tr_b16 v[70:71], v9 offset:25088
    s_waitcnt lgkmcnt(6)
    v_mfma_f32_16x16x32_bf16 v[136:139], a[60:63], v[88:91], v[136:139]
    ds_read_b64_tr_b16 v[72:73], v10 offset:24576
    v_mfma_f32_16x16x32_bf16 v[168:171], a[64:67], v[88:91], v[168:171]
    ds_read_b64_tr_b16 v[74:75], v10 offset:25088
    buffer_load_dwordx4 v3, s[4:7], s48 offen sc1 lds
    s_add_u32 s49, s49, 0x1000
    s_add_u32 s48, s48, 32*4352
    s_mov_b32 m0, s49
    v_mfma_f32_16x16x32_bf16 v[200:203], v[88:91], v[88:91], v[200:203]
    ds_read_b64_tr_b16 v[76:77], v11 offset:24576
    s_waitcnt lgkmcnt(7)
    v_mfma_f32_16x16x32_bf16 v[140:143], a[60:63], v[92:95], v[140:143]
    ds_read_b64_tr_b16 v[78:79], v11 offset:25088
    v_mfma_f32_16x16x32_bf16 v[172:175], a[64:67], v[92:95], v[172:175]
    buffer_load_dwordx4 v3, s[4:7], s48 offen sc1 lds
    s_add_u32 s49, s49, 0x1000
    s_add_u32 s48, s48, 32*4352
    s_mov_b32 m0, s49
    v_mfma_f32_16x16x32_bf16 v[204:207], v[92:95], v[92:95], v[204:207]
    s_waitcnt lgkmcnt(6)
    v_mfma_f32_16x16x32_bf16 v[128:131], a[72:75], v[64:67], v[128:131]
    v_mfma_f32_16x16x32_bf16 v[160:163], a[76:79], v[64:67], v[160:163]
    buffer_load_dwordx4 v3, s[4:7], s48 offen sc1 lds
    s_add_u32 s49, s49, 0x1000
    s_add_u32 s48, s48, 32*4352
    s_mov_b32 m0, s49
    s_waitcnt vmcnt(18)
    s_barrier
    v_mfma_f32_16x16x32_bf16 v[192:195], v[64:67], v[64:67], v[192:195]
    ds_read_b64_tr_b16 v[80:81], v8 offset:28672
    s_waitcnt lgkmcnt(5)
    v_mfma_f32_16x16x32_bf16 v[132:135], a[72:75], v[68:71], v[132:135]
    ds_read_b64_tr_b16 v[82:83], v8 offset:29184
    v_mfma_f32_16x16x32_bf16 v[164:167], a[76:79], v[68:71], v[164:167]
    ds_read_b64_tr_b16 v[84:85], v9 offset:28672
    buffer_load_dwordx4 v3, s[4:7], s48 offen sc1 lds
    s_add_u32 s49, s49, 0x1000
    s_add_u32 s48, s48, 32*4352
    s_mov_b32 m0, s49
    v_mfma_f32_16x16x32_bf16 v[196:199], v[68:71], v[68:71], v[196:199]
    ds_read_b64_tr_b16 v[86:87], v9 offset:29184
    s_waitcnt lgkmcnt(6)
    v_mfma_f32_16x16x32_bf16 v[136:139], a[72:75], v[72:75], v[136:139]
    ds_read_b64_tr_b16 v[88:89], v10 offset:28672
    v_mfma_f32_16x16x32_bf16 v[168:171], a[76:79], v[72:75], v[168:171]
    ds_read_b64_tr_b16 v[90:91], v10 offset:29184
    buffer_load_dwordx4 v3, s[4:7], s48 offen sc1 lds
    s_add_u32 s49, s49, 0x1000
    s_add_u32 s48, s48, 32*4352
    s_mov_b32 m0, s49
    v_mfma_f32_16x16x32_bf16 v[200:203], v[72:75], v[72:75], v[200:203]
    ds_read_b64_tr_b16 v[92:93], v11 offset:28672
    s_waitcnt lgkmcnt(7)
    v_mfma_f32_16x16x32_bf16 v[140:143], a[72:75], v[76:79], v[140:143]
    ds_read_b64_tr_b16 v[94:95], v11 offset:29184
    v_mfma_f32_16x16x32_bf16 v[172:175], a[76:79], v[76:79], v[172:175]
    buffer_load_dwordx4 v3, s[4:7], s48 offen sc1 lds
    s_add_u32 s49, s49, 0x1000
    s_add_u32 s48, s48, 32*4352
    s_mov_b32 m0, s49
    v_mfma_f32_16x16x32_bf16 v[204:207], v[76:79], v[76:79], v[204:207]
    s_waitcnt lgkmcnt(6)
    v_mfma_f32_16x16x32_bf16 v[128:131], a[84:87], v[80:83], v[128:131]
    v_mfma_f32_16x16x32_bf16 v[160:163], a[88:91], v[80:83], v[160:163]
    buffer_load_dwordx4 v3, s[4:7], s48 offen sc1 lds
    s_add_u32 s49, s49, 0x1000
    s_add_u32 s48, s48, 32*4352
    s_mov_b32 m0, s49
    v_mfma_f32_16x16x32_bf16 v[192:195], v[80:83], v[80:83], v[192:195]
    ds_read_b64_tr_b16 v[64:65], v8 offset:32768
    s_waitcnt lgkmcnt(5)
    v_mfma_f32_16x16x32_bf16 v[132:135], a[84:87], v[84:87], v[132:135]
    ds_read_b64_tr_b16 v[66:67], v8 offset:33280
    v_mfma_f32_16x16x32_bf16 v[164:167], a[88:91], v[84:87], v[164:167]
    ds_read_b64_tr_b16 v[68:69], v9 offset:32768
    buffer_load_dwordx4 v3, s[4:7], s48 offen sc1 lds
    s_add_u32 s49, s49, 0x1000
    s_add_u32 s48, s48, 32*4352
    s_mov_b32 m0, s49
    v_mfma_f32_16x16x32_bf16 v[196:199], v[84:87], v[84:87], v[196:199]
    ds_read_b64_tr_b16 v[70:71], v9 offset:33280
    s_waitcnt lgkmcnt(6)
    v_mfma_f32_16x16x32_bf16 v[136:139], a[84:87], v[88:91], v[136:139]
    ds_read_b64_tr_b16 v[72:73], v10 offset:32768
    v_mfma_f32_16x16x32_bf16 v[168:171], a[88:91], v[88:91], v[168:171]
    ds_read_b64_tr_b16 v[74:75], v10 offset:33280
    buffer_load_dwordx4 a[192:195], v52, s[4:7], s60 offen offset:0 sc1
    v_mfma_f32_16x16x32_bf16 v[200:203], v[88:91], v[88:91], v[200:203]
    ds_read_b64_tr_b16 v[76:77], v11 offset:32768
    s_waitcnt lgkmcnt(7)
    v_mfma_f32_16x16x32_bf16 v[140:143], a[84:87], v[92:95], v[140:143]
    ds_read_b64_tr_b16 v[78:79], v11 offset:33280
    v_mfma_f32_16x16x32_bf16 v[172:175], a[88:91], v[92:95], v[172:175]
    buffer_load_dwordx4 a[196:199], v52, s[4:7], s60 offen offset:1024 sc1
    v_mfma_f32_16x16x32_bf16 v[204:207], v[92:95], v[92:95], v[204:207]
    s_waitcnt lgkmcnt(6)
    v_mfma_f32_16x16x32_bf16 v[128:131], a[96:99], v[64:67], v[128:131]
    v_mfma_f32_16x16x32_bf16 v[160:163], a[100:103], v[64:67], v[160:163]
    buffer_load_dwordx4 a[200:203], v52, s[4:7], s60 offen offset:2048 sc1
    s_waitcnt vmcnt(24)
    s_barrier
    v_mfma_f32_16x16x32_bf16 v[192:195], v[64:67], v[64:67], v[192:195]
    ds_read_b64_tr_b16 v[80:81], v8 offset:36864
    s_waitcnt lgkmcnt(5)
    v_mfma_f32_16x16x32_bf16 v[132:135], a[96:99], v[68:71], v[132:135]
    ds_read_b64_tr_b16 v[82:83], v8 offset:37376
    v_mfma_f32_16x16x32_bf16 v[164:167], a[100:103], v[68:71], v[164:167]
    ds_read_b64_tr_b16 v[84:85], v9 offset:36864
    buffer_load_dwordx4 a[204:207], v52, s[4:7], s60 offen offset:3072 sc1
    s_add_u32 s60, s60, 4096
    v_mfma_f32_16x16x32_bf16 v[196:199], v[68:71], v[68:71], v[196:199]
    ds_read_b64_tr_b16 v[86:87], v9 offset:37376
    s_waitcnt lgkmcnt(6)
    v_mfma_f32_16x16x32_bf16 v[136:139], a[96:99], v[72:75], v[136:139]
    ds_read_b64_tr_b16 v[88:89], v10 offset:36864
    v_mfma_f32_16x16x32_bf16 v[168:171], a[100:103], v[72:75], v[168:171]
    ds_read_b64_tr_b16 v[90:91], v10 offset:37376
    buffer_load_dwordx4 a[208:211], v52, s[4:7], s60 offen offset:0 sc1
    v_mfma_f32_16x16x32_bf16 v[200:203], v[72:75], v[72:75], v[200:203]
    ds_read_b64_tr_b16 v[92:93], v11 offset:36864
    s_waitcnt lgkmcnt(7)
    v_mfma_f32_16x16x32_bf16 v[140:143], a[96:99], v[76:79], v[140:143]
    ds_read_b64_tr_b16 v[94:95], v11 offset:37376
    v_mfma_f32_16x16x32_bf16 v[172:175], a[100:103], v[76:79], v[172:175]
    buffer_load_dwordx4 a[212:215], v52, s[4:7], s60 offen offset:1024 sc1
    v_mfma_f32_16x16x32_bf16 v[204:207], v[76:79], v[76:79], v[204:207]
    s_waitcnt lgkmcnt(6)
    v_mfma_f32_16x16x32_bf16 v[128:131], a[108:111], v[80:83], v[128:131]
    v_mfma_f32_16x16x32_bf16 v[160:163], a[112:115], v[80:83], v[160:163]
    buffer_load_dwordx4 a[216:219], v52, s[4:7], s60 offen offset:2048 sc1
    v_mfma_f32_16x16x32_bf16 v[192:195], v[80:83], v[80:83], v[192:195]
    ds_read_b64_tr_b16 v[64:65], v8 offset:40960
    s_waitcnt lgkmcnt(5)
    v_mfma_f32_16x16x32_bf16 v[132:135], a[108:111], v[84:87], v[132:135]
    ds_read_b64_tr_b16 v[66:67], v8 offset:41472
    v_mfma_f32_16x16x32_bf16 v[164:167], a[112:115], v[84:87], v[164:167]
    ds_read_b64_tr_b16 v[68:69], v9 offset:40960
    buffer_load_dwordx4 a[220:223], v52, s[4:7], s60 offen offset:3072 sc1
    s_add_u32 s60, s60, 4096
    v_mfma_f32_16x16x32_bf16 v[196:199], v[84:87], v[84:87], v[196:199]
    ds_read_b64_tr_b16 v[70:71], v9 offset:41472
    s_waitcnt lgkmcnt(6)
    v_mfma_f32_16x16x32_bf16 v[136:139], a[108:111], v[88:91], v[136:139]
    ds_read_b64_tr_b16 v[72:73], v10 offset:40960
    v_mfma_f32_16x16x32_bf16 v[168:171], a[112:115], v[88:91], v[168:171]
    ds_read_b64_tr_b16 v[74:75], v10 offset:41472
    v_mfma_f32_16x16x32_bf16 v[200:203], v[88:91], v[88:91], v[200:203]
    ds_read_b64_tr_b16 v[76:77], v11 offset:40960
    s_waitcnt lgkmcnt(7)
    v_mfma_f32_16x16x32_bf16 v[140:143], a[108:111], v[92:95], v[140:143]
    ds_read_b64_tr_b16 v[78:79], v11 offset:41472
    v_mfma_f32_16x16x32_bf16 v[172:175], a[112:115], v[92:95], v[172:175]
    v_mfma_f32_16x16x32_bf16 v[204:207], v[92:95], v[92:95], v[204:207]
    s_waitcnt lgkmcnt(6)
    v_mfma_f32_16x16x32_bf16 v[128:131], a[120:123], v[64:67], v[128:131]
    v_mfma_f32_16x16x32_bf16 v[160:163], a[124:127], v[64:67], v[160:163]
    s_waitcnt vmcnt(27)
    s_barrier
    v_mfma_f32_16x16x32_bf16 v[192:195], v[64:67], v[64:67], v[192:195]
    ds_read_b64_tr_b16 v[80:81], v8 offset:45056
    s_waitcnt lgkmcnt(5)
    v_mfma_f32_16x16x32_bf16 v[132:135], a[120:123], v[68:71], v[132:135]
    ds_read_b64_tr_b16 v[82:83], v8 offset:45568
    v_mfma_f32_16x16x32_bf16 v[164:167], a[124:127], v[68:71], v[164:167]
    ds_read_b64_tr_b16 v[84:85], v9 offset:45056
    v_mfma_f32_16x16x32_bf16 v[196:199], v[68:71], v[68:71], v[196:199]
    ds_read_b64_tr_b16 v[86:87], v9 offset:45568
    s_waitcnt lgkmcnt(6)
    v_mfma_f32_16x16x32_bf16 v[136:139], a[120:123], v[72:75], v[136:139]
    ds_read_b64_tr_b16 v[88:89], v10 offset:45056
    v_mfma_f32_16x16x32_bf16 v[168:171], a[124:127], v[72:75], v[168:171]
    ds_read_b64_tr_b16 v[90:91], v10 offset:45568
    v_mfma_f32_16x16x32_bf16 v[200:203], v[72:75], v[72:75], v[200:203]
    ds_read_b64_tr_b16 v[92:93], v11 offset:45056
    s_waitcnt lgkmcnt(7)
    v_mfma_f32_16x16x32_bf16 v[140:143], a[120:123], v[76:79], v[140:143]
    ds_read_b64_tr_b16 v[94:95], v11 offset:45568
    v_mfma_f32_16x16x32_bf16 v[172:175], a[124:127], v[76:79], v[172:175]
    v_mfma_f32_16x16x32_bf16 v[204:207], v[76:79], v[76:79], v[204:207]
    s_waitcnt lgkmcnt(6)
    v_mfma_f32_16x16x32_bf16 v[128:131], a[132:135], v[80:83], v[128:131]
    v_mfma_f32_16x16x32_bf16 v[160:163], a[136:139], v[80:83], v[160:163]
    v_mfma_f32_16x16x32_bf16 v[192:195], v[80:83], v[80:83], v[192:195]
    ds_read_b64_tr_b16 v[64:65], v8 offset:49152
    s_waitcnt lgkmcnt(5)
    v_mfma_f32_16x16x32_bf16 v[132:135], a[132:135], v[84:87], v[132:135]
    ds_read_b64_tr_b16 v[66:67], v8 offset:49664
    v_mfma_f32_16x16x32_bf16 v[164:167], a[136:139], v[84:87], v[164:167]
    ds_read_b64_tr_b16 v[68:69], v9 offset:49152
    v_mfma_f32_16x16x32_bf16 v[196:199], v[84:87], v[84:87], v[196:199]
    ds_read_b64_tr_b16 v[70:71], v9 offset:49664
    s_waitcnt lgkmcnt(6)
    v_mfma_f32_16x16x32_bf16 v[136:139], a[132:135], v[88:91], v[136:139]
    ds_read_b64_tr_b16 v[72:73], v10 offset:49152
    v_mfma_f32_16x16x32_bf16 v[168:171], a[136:139], v[88:91], v[168:171]
    ds_read_b64_tr_b16 v[74:75], v10 offset:49664
    v_mfma_f32_16x16x32_bf16 v[200:203], v[88:91], v[88:91], v[200:203]
    ds_read_b64_tr_b16 v[76:77], v11 offset:49152
    s_waitcnt lgkmcnt(7)
    v_mfma_f32_16x16x32_bf16 v[140:143], a[132:135], v[92:95], v[140:143]
    ds_read_b64_tr_b16 v[78:79], v11 offset:49664
    v_mfma_f32_16x16x32_bf16 v[172:175], a[136:139], v[92:95], v[172:175]
    v_mfma_f32_16x16x32_bf16 v[204:207], v[92:95], v[92:95], v[204:207]
    s_waitcnt lgkmcnt(6)
    v_mfma_f32_16x16x32_bf16 v[128:131], a[144:147], v[64:67], v[128:131]
    v_mfma_f32_16x16x32_bf16 v[160:163], a[148:151], v[64:67], v[160:163]
    s_waitcnt vmcnt(25)
    s_barrier
    v_mfma_f32_16x16x32_bf16 v[192:195], v[64:67], v[64:67], v[192:195]
    ds_read_b64_tr_b16 v[80:81], v8 offset:53248
    s_waitcnt lgkmcnt(5)
    v_mfma_f32_16x16x32_bf16 v[132:135], a[144:147], v[68:71], v[132:135]
    ds_read_b64_tr_b16 v[82:83], v8 offset:53760
    v_mfma_f32_16x16x32_bf16 v[164:167], a[148:151], v[68:71], v[164:167]
    ds_read_b64_tr_b16 v[84:85], v9 offset:53248
    v_mfma_f32_16x16x32_bf16 v[196:199], v[68:71], v[68:71], v[196:199]
    ds_read_b64_tr_b16 v[86:87], v9 offset:53760
    s_waitcnt lgkmcnt(6)
    v_mfma_f32_16x16x32_bf16 v[136:139], a[144:147], v[72:75], v[136:139]
    ds_read_b64_tr_b16 v[88:89], v10 offset:53248
    v_mfma_f32_16x16x32_bf16 v[168:171], a[148:151], v[72:75], v[168:171]
    ds_read_b64_tr_b16 v[90:91], v10 offset:53760
    v_mfma_f32_16x16x32_bf16 v[200:203], v[72:75], v[72:75], v[200:203]
    ds_read_b64_tr_b16 v[92:93], v11 offset:53248
    s_waitcnt lgkmcnt(7)
    v_mfma_f32_16x16x32_bf16 v[140:143], a[144:147], v[76:79], v[140:143]
    ds_read_b64_tr_b16 v[94:95], v11 offset:53760
    v_mfma_f32_16x16x32_bf16 v[172:175], a[148:151], v[76:79], v[172:175]
    v_mfma_f32_16x16x32_bf16 v[204:207], v[76:79], v[76:79], v[204:207]
    s_waitcnt lgkmcnt(6)
    v_mfma_f32_16x16x32_bf16 v[128:131], a[156:159], v[80:83], v[128:131]
    v_mfma_f32_16x16x32_bf16 v[160:163], a[160:163], v[80:83], v[160:163]
    v_mfma_f32_16x16x32_bf16 v[192:195], v[80:83], v[80:83], v[192:195]
    ds_read_b64_tr_b16 v[64:65], v8 offset:57344
    s_waitcnt lgkmcnt(5)
    v_mfma_f32_16x16x32_bf16 v[132:135], a[156:159], v[84:87], v[132:135]
    ds_read_b64_tr_b16 v[66:67], v8 offset:57856
    v_mfma_f32_16x16x32_bf16 v[164:167], a[160:163], v[84:87], v[164:167]
    ds_read_b64_tr_b16 v[68:69], v9 offset:57344
    v_mfma_f32_16x16x32_bf16 v[196:199], v[84:87], v[84:87], v[196:199]
    ds_read_b64_tr_b16 v[70:71], v9 offset:57856
    s_waitcnt lgkmcnt(6)
    v_mfma_f32_16x16x32_bf16 v[136:139], a[156:159], v[88:91], v[136:139]
    ds_read_b64_tr_b16 v[72:73], v10 offset:57344
    v_mfma_f32_16x16x32_bf16 v[168:171], a[160:163], v[88:91], v[168:171]
    ds_read_b64_tr_b16 v[74:75], v10 offset:57856
    v_mfma_f32_16x16x32_bf16 v[200:203], v[88:91], v[88:91], v[200:203]
    ds_read_b64_tr_b16 v[76:77], v11 offset:57344
    s_waitcnt lgkmcnt(7)
    v_mfma_f32_16x16x32_bf16 v[140:143], a[156:159], v[92:95], v[140:143]
    ds_read_b64_tr_b16 v[78:79], v11 offset:57856
    v_mfma_f32_16x16x32_bf16 v[172:175], a[160:163], v[92:95], v[172:175]
    v_mfma_f32_16x16x32_bf16 v[204:207], v[92:95], v[92:95], v[204:207]
    s_waitcnt lgkmcnt(6)
    v_mfma_f32_16x16x32_bf16 v[128:131], a[168:171], v[64:67], v[128:131]
    v_mfma_f32_16x16x32_bf16 v[160:163], a[172:175], v[64:67], v[160:163]
    s_waitcnt vmcnt(22)
    s_barrier
    v_mfma_f32_16x16x32_bf16 v[192:195], v[64:67], v[64:67], v[192:195]
    ds_read_b64_tr_b16 v[80:81], v8 offset:61440
    s_waitcnt lgkmcnt(5)
    v_mfma_f32_16x16x32_bf16 v[132:135], a[168:171], v[68:71], v[132:135]
    ds_read_b64_tr_b16 v[82:83], v8 offset:61952
    v_mfma_f32_16x16x32_bf16 v[164:167], a[172:175], v[68:71], v[164:167]
    ds_read_b64_tr_b16 v[84:85], v9 offset:61440
    v_mfma_f32_16x16x32_bf16 v[196:199], v[68:71], v[68:71], v[196:199]
    ds_read_b64_tr_b16 v[86:87], v9 offset:61952
    s_waitcnt lgkmcnt(6)
    v_mfma_f32_16x16x32_bf16 v[136:139], a[168:171], v[72:75], v[136:139]
    ds_read_b64_tr_b16 v[88:89], v10 offset:61440
    v_mfma_f32_16x16x32_bf16 v[168:171], a[172:175], v[72:75], v[168:171]
    ds_read_b64_tr_b16 v[90:91], v10 offset:61952
    v_mfma_f32_16x16x32_bf16 v[200:203], v[72:75], v[72:75], v[200:203]
    ds_read_b64_tr_b16 v[92:93], v11 offset:61440
    s_waitcnt lgkmcnt(7)
    v_mfma_f32_16x16x32_bf16 v[140:143], a[168:171], v[76:79], v[140:143]
    ds_read_b64_tr_b16 v[94:95], v11 offset:61952
    v_mfma_f32_16x16x32_bf16 v[172:175], a[172:175], v[76:79], v[172:175]
    v_mfma_f32_16x16x32_bf16 v[204:207], v[76:79], v[76:79], v[204:207]
    s_waitcnt lgkmcnt(6)
    v_mfma_f32_16x16x32_bf16 v[128:131], a[180:183], v[80:83], v[128:131]
    v_mfma_f32_16x16x32_bf16 v[160:163], a[184:187], v[80:83], v[160:163]
    v_mfma_f32_16x16x32_bf16 v[192:195], v[80:83], v[80:83], v[192:195]
    ds_read_b64_tr_b16 v[64:65], v12 offset:0
    s_waitcnt lgkmcnt(5)
    v_mfma_f32_16x16x32_bf16 v[132:135], a[180:183], v[84:87], v[132:135]
    ds_read_b64_tr_b16 v[66:67], v12 offset:512
    v_mfma_f32_16x16x32_bf16 v[164:167], a[184:187], v[84:87], v[164:167]
    ds_read_b64_tr_b16 v[68:69], v13 offset:0
    v_mfma_f32_16x16x32_bf16 v[196:199], v[84:87], v[84:87], v[196:199]
    ds_read_b64_tr_b16 v[70:71], v13 offset:512
    s_waitcnt lgkmcnt(6)
    v_mfma_f32_16x16x32_bf16 v[136:139], a[180:183], v[88:91], v[136:139]
    ds_read_b64_tr_b16 v[72:73], v14 offset:0
    v_mfma_f32_16x16x32_bf16 v[168:171], a[184:187], v[88:91], v[168:171]
    ds_read_b64_tr_b16 v[74:75], v14 offset:512
    v_mfma_f32_16x16x32_bf16 v[200:203], v[88:91], v[88:91], v[200:203]
    ds_read_b64_tr_b16 v[76:77], v15 offset:0
    s_waitcnt lgkmcnt(7)
    v_mfma_f32_16x16x32_bf16 v[140:143], a[180:183], v[92:95], v[140:143]
    ds_read_b64_tr_b16 v[78:79], v15 offset:512
    v_mfma_f32_16x16x32_bf16 v[172:175], a[184:187], v[92:95], v[172:175]
    v_mfma_f32_16x16x32_bf16 v[204:207], v[92:95], v[92:95], v[204:207]
    s_waitcnt lgkmcnt(6)
    v_mfma_f32_16x16x32_bf16 v[144:147], a[0:3], v[64:67], 0
    v_mfma_f32_16x16x32_bf16 v[176:179], a[4:7], v[64:67], 0
    v_mfma_f32_16x16x32_bf16 v[208:211], v[64:67], v[64:67], 0
    ds_read_b64_tr_b16 v[80:81], v12 offset:4096
    buffer_load_dwordx3 a[224:226], v53, s[4:7], s60 offen offset:0 sc1
    v_accvgpr_write_b32 a227, 0
    ds_write_b128 v233, v[192:195] offset:0
    s_waitcnt lgkmcnt(6)
    v_mfma_f32_16x16x32_bf16 v[148:151], a[0:3], v[68:71], 0
    ds_read_b64_tr_b16 v[82:83], v12 offset:4608
    ds_write_b128 v233, v[196:199] offset:1024
    v_mfma_f32_16x16x32_bf16 v[180:183], a[4:7], v[68:71], 0
    ds_read_b64_tr_b16 v[84:85], v13 offset:4096
    ds_write_b128 v233, v[200:203] offset:2048
    v_mfma_f32_16x16x32_bf16 v[212:215], v[68:71], v[68:71], 0
    ds_read_b64_tr_b16 v[86:87], v13 offset:4608
    buffer_load_dwordx3 a[228:230], v53, s[4:7], s60 offen offset:768 sc1
    v_accvgpr_write_b32 a231, 0
    ds_write_b128 v233, v[204:207] offset:3072
    s_waitcnt lgkmcnt(10)
    v_mfma_f32_16x16x32_bf16 v[152:155], a[0:3], v[72:75], 0
    ds_read_b64_tr_b16 v[88:89], v14 offset:4096
    ds_write_b32 v234, v129 offset:0
    v_mfma_f32_16x16x32_bf16 v[184:187], a[4:7], v[72:75], 0
    ds_read_b64_tr_b16 v[90:91], v14 offset:4608
    ds_write_b32 v234, v133 offset:256
    v_mfma_f32_16x16x32_bf16 v[216:219], v[72:75], v[72:75], 0
    ds_read_b64_tr_b16 v[92:93], v15 offset:4096
    buffer_load_dwordx3 a[232:234], v53, s[4:7], s60 offen offset:1536 sc1
    v_accvgpr_write_b32 a235, 0
    ds_write_b32 v234, v137 offset:512
    s_waitcnt lgkmcnt(14)
    v_mfma_f32_16x16x32_bf16 v[156:159], a[0:3], v[76:79], 0
    ds_read_b64_tr_b16 v[94:95], v15 offset:4608
    ds_write_b32 v234, v141 offset:768
    v_mfma_f32_16x16x32_bf16 v[188:191], a[4:7], v[76:79], 0
    v_mfma_f32_16x16x32_bf16 v[220:223], v[76:79], v[76:79], 0
    buffer_load_dwordx3 a[236:238], v53, s[4:7], s60 offen offset:2304 sc1
    v_accvgpr_write_b32 a239, 0
    s_add_u32 s60, s60, 3072
    s_waitcnt vmcnt(20)
    s_waitcnt lgkmcnt(0)
    s_barrier
    ds_read2st64_b32 v[120:121], v227 offset0:0 offset1:1
    ds_read2st64_b32 v[124:125], v226 offset0:0 offset1:4
    ds_read2st64_b32 v[122:123], v227 offset0:2 offset1:3
    ds_read2st64_b32 v[126:127], v226 offset0:8 offset1:12
    ds_read_b128 v[16:19], v232 offset:0
    ds_read_b128 v[20:23], v232 offset:64
    ds_read_b128 v[28:31], v232 offset:768
    ds_read_b128 v[32:35], v232 offset:832
    v_mfma_f32_16x16x32_bf16 v[144:147], a[12:15], v[80:83], v[144:147]
    v_mfma_f32_16x16x32_bf16 v[176:179], a[16:19], v[80:83], v[176:179]
    v_mfma_f32_16x16x32_bf16 v[208:211], v[80:83], v[80:83], v[208:211]
    ds_read_b64_tr_b16 v[64:65], v12 offset:8192
    buffer_load_dwordx4 a[240:243], v52, s[4:7], s60 offen offset:0 sc1
    v_mfma_f32_16x16x32_bf16 v[148:151], a[12:15], v[84:87], v[148:151]
    ds_read_b64_tr_b16 v[66:67], v12 offset:8704
    v_mfma_f32_16x16x32_bf16 v[180:183], a[16:19], v[84:87], v[180:183]
    ds_read_b64_tr_b16 v[68:69], v13 offset:8192
    v_mfma_f32_16x16x32_bf16 v[212:215], v[84:87], v[84:87], v[212:215]
    ds_read_b64_tr_b16 v[70:71], v13 offset:8704
    buffer_load_dwordx4 a[244:247], v52, s[4:7], s60 offen offset:1024 sc1
    v_mfma_f32_16x16x32_bf16 v[152:155], a[12:15], v[88:91], v[152:155]
    ds_read_b64_tr_b16 v[72:73], v14 offset:8192
    v_mfma_f32_16x16x32_bf16 v[184:187], a[16:19], v[88:91], v[184:187]
    ds_read_b64_tr_b16 v[74:75], v14 offset:8704
    v_mfma_f32_16x16x32_bf16 v[216:219], v[88:91], v[88:91], v[216:219]
    ds_read_b64_tr_b16 v[76:77], v15 offset:8192
    buffer_load_dwordx4 a[248:251], v52, s[4:7], s60 offen offset:2048 sc1
    v_mfma_f32_16x16x32_bf16 v[156:159], a[12:15], v[92:95], v[156:159]
    ds_read_b64_tr_b16 v[78:79], v15 offset:8704
    v_mfma_f32_16x16x32_bf16 v[188:191], a[16:19], v[92:95], v[188:191]
    v_mfma_f32_16x16x32_bf16 v[220:223], v[92:95], v[92:95], v[220:223]
    buffer_load_dwordx4 a[252:255], v52, s[4:7], s60 offen offset:3072 sc1
    s_add_u32 s60, s60, 4096
    s_waitcnt lgkmcnt(6)
    v_mfma_f32_16x16x32_bf16 v[144:147], a[24:27], v[64:67], v[144:147]
    v_mul_f32 v120, v230, v120
    v_mul_f32 v121, v230, v121
    v_mul_f32 v122, v230, v122
    v_mfma_f32_16x16x32_bf16 v[176:179], a[28:31], v[64:67], v[176:179]
    v_mul_f32 v123, v230, v123
    v_fma_f32 v124, v124, v230, v231
    v_fma_f32 v125, v125, v230, v231
    v_mfma_f32_16x16x32_bf16 v[208:211], v[64:67], v[64:67], v[208:211]
    ds_read_b64_tr_b16 v[80:81], v12 offset:12288
    buffer_load_dwordx4 a[0:3], v52, s[4:7], s60 offen offset:0 sc1
    v_fma_f32 v126, v126, v230, v231
    v_fma_f32 v127, v127, v230, v231
    v_fma_f32 v124, -v120, v120, v124
    s_waitcnt lgkmcnt(5)
    v_mfma_f32_16x16x32_bf16 v[148:151], a[24:27], v[68:71], v[148:151]
    ds_read_b64_tr_b16 v[82:83], v12 offset:12800
    v_fma_f32 v125, -v121, v121, v125
    v_fma_f32 v126, -v122, v122, v126
    v_fma_f32 v127, -v123, v123, v127
    v_mfma_f32_16x16x32_bf16 v[180:183], a[28:31], v[68:71], v[180:183]
    ds_read_b64_tr_b16 v[84:85], v13 offset:12288
    v_rsq_f32 v40, v124
    v_rsq_f32 v42, v125
    v_mfma_f32_16x16x32_bf16 v[212:215], v[68:71], v[68:71], v[212:215]
    ds_read_b64_tr_b16 v[86:87], v13 offset:12800
    buffer_load_dwordx4 a[4:7], v52, s[4:7], s60 offen offset:1024 sc1
    v_rsq_f32 v44, v126
    v_rsq_f32 v46, v127
    s_waitcnt lgkmcnt(6)
    v_mfma_f32_16x16x32_bf16 v[152:155], a[24:27], v[72:75], v[152:155]
    ds_read_b64_tr_b16 v[88:89], v14 offset:12288
    v_mul_f32 v41, -v120, v40
    v_mul_f32 v43, -v121, v42
    v_mul_f32 v45, -v122, v44
    v_mfma_f32_16x16x32_bf16 v[184:187], a[28:31], v[72:75], v[184:187]
    ds_read_b64_tr_b16 v[90:91], v14 offset:12800
    v_mul_f32 v47, -v123, v46
    v_fma_f32 v96, v16, v41, v28
    v_fma_f32 v97, v17, v41, v29
    v_mfma_f32_16x16x32_bf16 v[216:219], v[72:75], v[72:75], v[216:219]
    ds_read_b64_tr_b16 v[92:93], v15 offset:12288
    buffer_load_dwordx4 a[8:11], v52, s[4:7], s60 offen offset:2048 sc1
    v_fma_f32 v98, v18, v41, v30
    v_fma_f32 v99, v19, v41, v31
    v_fma_f32 v104, v20, v41, v32
    s_waitcnt lgkmcnt(7)
    v_mfma_f32_16x16x32_bf16 v[156:159], a[24:27], v[76:79], v[156:159]
    ds_read_b64_tr_b16 v[94:95], v15 offset:12800
    v_fma_f32 v105, v21, v41, v33
    v_fma_f32 v106, v22, v41, v34
    v_fma_f32 v107, v23, v41, v35
    v_mfma_f32_16x16x32_bf16 v[188:191], a[28:31], v[76:79], v[188:191]
    v_fmac_f32 v96, v128, v40
    v_fmac_f32 v97, v129, v40
    v_fmac_f32 v98, v130, v40
    v_mfma_f32_16x16x32_bf16 v[220:223], v[76:79], v[76:79], v[220:223]
    buffer_load_dwordx4 a[12:15], v52, s[4:7], s60 offen offset:3072 sc1
    s_add_u32 s60, s60, 4096
    v_fmac_f32 v99, v131, v40
    v_fmac_f32 v104, v160, v40
    v_fmac_f32 v105, v161, v40
    s_waitcnt lgkmcnt(6)
    v_mfma_f32_16x16x32_bf16 v[144:147], a[36:39], v[80:83], v[144:147]
    v_fmac_f32 v106, v162, v40
    v_fmac_f32 v107, v163, v40
    v_mul_f32 v100, v96, v96
    v_mfma_f32_16x16x32_bf16 v[176:179], a[40:43], v[80:83], v[176:179]
    v_mul_f32 v101, v97, v97
    v_mul_f32 v108, v104, v104
    v_mul_f32 v109, v105, v105
    v_mfma_f32_16x16x32_bf16 v[208:211], v[80:83], v[80:83], v[208:211]
    ds_read_b64_tr_b16 v[64:65], v12 offset:16384
    buffer_load_dwordx3 a[16:18], v53, s[4:7], s60 offen offset:0 sc1
    v_accvgpr_write_b32 a19, 0
    v_fma_f32 v100, v100, s56, v51
    v_fma_f32 v101, v101, s56, v51
    v_fma_f32 v108, v108, s56, v51
    s_waitcnt lgkmcnt(5)
    v_mfma_f32_16x16x32_bf16 v[148:151], a[36:39], v[84:87], v[148:151]
    ds_read_b64_tr_b16 v[66:67], v12 offset:16896
    v_fma_f32 v109, v109, s56, v51
    v_mul_f32 v100, v100, v96
    v_mul_f32 v101, v101, v97
    v_mfma_f32_16x16x32_bf16 v[180:183], a[40:43], v[84:87], v[180:183]
    ds_read_b64_tr_b16 v[68:69], v13 offset:16384
    v_mul_f32 v108, v108, v104
    v_mul_f32 v109, v109, v105
    v_exp_f32 v100, v100
    v_mfma_f32_16x16x32_bf16 v[212:215], v[84:87], v[84:87], v[212:215]
    ds_read_b64_tr_b16 v[70:71], v13 offset:16896
    buffer_load_dwordx3 a[20:22], v53, s[4:7], s60 offen offset:768 sc1
    v_accvgpr_write_b32 a23, 0
    v_exp_f32 v101, v101
    v_exp_f32 v108, v108
    s_waitcnt lgkmcnt(6)
    v_mfma_f32_16x16x32_bf16 v[152:155], a[36:39], v[88:91], v[152:155]
    ds_read_b64_tr_b16 v[72:73], v14 offset:16384
    v_exp_f32 v109, v109
    v_mul_f32 v96, v96, v98
    v_mfma_f32_16x16x32_bf16 v[184:187], a[40:43], v[88:91], v[184:187]
    ds_read_b64_tr_b16 v[74:75], v14 offset:16896
    v_mul_f32 v97, v97, v99
    v_mul_f32 v104, v104, v106
    v_mul_f32 v105, v105, v107
    v_mfma_f32_16x16x32_bf16 v[216:219], v[88:91], v[88:91], v[216:219]
    ds_read_b64_tr_b16 v[76:77], v15 offset:16384
    buffer_load_dwordx3 a[24:26], v53, s[4:7], s60 offen offset:1536 sc1
    v_accvgpr_write_b32 a27, 0
    v_add_f32 v100, 1.0, v100
    v_add_f32 v101, 1.0, v101
    v_add_f32 v108, 1.0, v108
    s_waitcnt lgkmcnt(7)
    v_mfma_f32_16x16x32_bf16 v[156:159], a[36:39], v[92:95], v[156:159]
    ds_read_b64_tr_b16 v[78:79], v15 offset:16896
    v_add_f32 v109, 1.0, v109
    v_rcp_f32 v100, v100
    v_mfma_f32_16x16x32_bf16 v[188:191], a[40:43], v[92:95], v[188:191]
    v_rcp_f32 v101, v101
    v_rcp_f32 v108, v108
    v_mfma_f32_16x16x32_bf16 v[220:223], v[92:95], v[92:95], v[220:223]
    buffer_load_dwordx3 a[28:30], v53, s[4:7], s60 offen offset:2304 sc1
    v_accvgpr_write_b32 a31, 0
    s_add_u32 s60, s60, 3072
    v_rcp_f32 v109, v109
    v_mul_f32 v96, v96, v100
    s_waitcnt lgkmcnt(6)
    v_mfma_f32_16x16x32_bf16 v[144:147], a[48:51], v[64:67], v[144:147]
    v_mul_f32 v97, v97, v101
    v_mul_f32 v104, v104, v108
    v_mul_f32 v105, v105, v109
    v_mfma_f32_16x16x32_bf16 v[176:179], a[52:55], v[64:67], v[176:179]
    v_cvt_pk_bf16_f32 v236, v96, v97
    v_cvt_pk_bf16_f32 v237, v104, v105
    ds_write2st64_b32 v234, v236, v237 offset0:14 offset1:22
    v_mfma_f32_16x16x32_bf16 v[208:211], v[64:67], v[64:67], v[208:211]
    ds_read_b64_tr_b16 v[80:81], v12 offset:20480
    buffer_load_dwordx4 a[32:35], v52, s[4:7], s60 offen offset:0 sc1
    v_fma_f32 v96, v16, v43, v28
    v_fma_f32 v97, v17, v43, v29
    v_fma_f32 v98, v18, v43, v30
    s_waitcnt lgkmcnt(6)
    v_mfma_f32_16x16x32_bf16 v[148:151], a[48:51], v[68:71], v[148:151]
    ds_read_b64_tr_b16 v[82:83], v12 offset:20992
    v_fma_f32 v99, v19, v43, v31
    v_fma_f32 v104, v20, v43, v32
    v_fma_f32 v105, v21, v43, v33
    v_mfma_f32_16x16x32_bf16 v[180:183], a[52:55], v[68:71], v[180:183]
    ds_read_b64_tr_b16 v[84:85], v13 offset:20480
    v_fma_f32 v106, v22, v43, v34
    v_fma_f32 v107, v23, v43, v35
    v_fmac_f32 v96, v132, v42
    v_mfma_f32_16x16x32_bf16 v[212:215], v[68:71], v[68:71], v[212:215]
    ds_read_b64_tr_b16 v[86:87], v13 offset:20992
    buffer_load_dwordx4 a[36:39], v52, s[4:7], s60 offen offset:1024 sc1
    v_fmac_f32 v97, v133, v42
    v_fmac_f32 v98, v134, v42
    v_fmac_f32 v99, v135, v42
    s_waitcnt lgkmcnt(7)
    v_mfma_f32_16x16x32_bf16 v[152:155], a[48:51], v[72:75], v[152:155]
    ds_read_b64_tr_b16 v[88:89], v14 offset:20480
    v_fmac_f32 v104, v164, v42
    v_fmac_f32 v105, v165, v42
    v_fmac_f32 v106, v166, v42
    v_mfma_f32_16x16x32_bf16 v[184:187], a[52:55], v[72:75], v[184:187]
    ds_read_b64_tr_b16 v[90:91], v14 offset:20992
    v_fmac_f32 v107, v167, v42
    v_mul_f32 v100, v96, v96
    v_mul_f32 v101, v97, v97
    v_mfma_f32_16x16x32_bf16 v[216:219], v[72:75], v[72:75], v[216:219]
    ds_read_b64_tr_b16 v[92:93], v15 offset:20480
    buffer_load_dwordx4 a[40:43], v52, s[4:7], s60 offen offset:2048 sc1
    v_mul_f32 v108, v104, v104
    v_mul_f32 v109, v105, v105
    v_fma_f32 v100, v100, s56, v51
    s_waitcnt lgkmcnt(8)
    v_mfma_f32_16x16x32_bf16 v[156:159], a[48:51], v[76:79], v[156:159]
    ds_read_b64_tr_b16 v[94:95], v15 offset:20992
    v_fma_f32 v101, v101, s56, v51
    v_fma_f32 v108, v108, s56, v51
    v_fma_f32 v109, v109, s56, v51
    v_mfma_f32_16x16x32_bf16 v[188:191], a[52:55], v[76:79], v[188:191]
    v_mul_f32 v100, v100, v96
    v_mul_f32 v101, v101, v97
    v_mul_f32 v108, v108, v104
    v_mfma_f32_16x16x32_bf16 v[220:223], v[76:79], v[76:79], v[220:223]
    buffer_load_dwordx4 a[44:47], v52, s[4:7], s60 offen offset:3072 sc1
    s_add_u32 s60, s60, 4096
    v_mul_f32 v109, v109, v105
    v_exp_f32 v100, v100
    s_waitcnt lgkmcnt(6)
    v_mfma_f32_16x16x32_bf16 v[144:147], a[60:63], v[80:83], v[144:147]
    v_exp_f32 v101, v101
    v_exp_f32 v108, v108
    v_mfma_f32_16x16x32_bf16 v[176:179], a[64:67], v[80:83], v[176:179]
    v_exp_f32 v109, v109
    v_mul_f32 v96, v96, v98
    v_mfma_f32_16x16x32_bf16 v[208:211], v[80:83], v[80:83], v[208:211]
    ds_read_b64_tr_b16 v[64:65], v12 offset:24576
    buffer_load_dwordx4 a[48:51], v52, s[4:7], s60 offen offset:0 sc1
    v_mul_f32 v97, v97, v99
    v_mul_f32 v104, v104, v106
    v_mul_f32 v105, v105, v107
    s_waitcnt lgkmcnt(5)
    v_mfma_f32_16x16x32_bf16 v[148:151], a[60:63], v[84:87], v[148:151]
    ds_read_b64_tr_b16 v[66:67], v12 offset:25088
    v_add_f32 v100, 1.0, v100
    v_add_f32 v101, 1.0, v101
    v_add_f32 v108, 1.0, v108
    v_mfma_f32_16x16x32_bf16 v[180:183], a[64:67], v[84:87], v[180:183]
    ds_read_b64_tr_b16 v[68:69], v13 offset:24576
    v_add_f32 v109, 1.0, v109
    v_rcp_f32 v100, v100
    v_mfma_f32_16x16x32_bf16 v[212:215], v[84:87], v[84:87], v[212:215]
    ds_read_b64_tr_b16 v[70:71], v13 offset:25088
    buffer_load_dwordx4 a[52:55], v52, s[4:7], s60 offen offset:1024 sc1
    v_rcp_f32 v101, v101
    v_rcp_f32 v108, v108
    s_waitcnt lgkmcnt(6)
    v_mfma_f32_16x16x32_bf16 v[152:155], a[60:63], v[88:91], v[152:155]
    ds_read_b64_tr_b16 v[72:73], v14 offset:24576
    v_rcp_f32 v109, v109
    v_mul_f32 v96, v96, v100
    v_mfma_f32_16x16x32_bf16 v[184:187], a[64:67], v[88:91], v[184:187]
    ds_read_b64_tr_b16 v[74:75], v14 offset:25088
    v_mul_f32 v97, v97, v101
    v_mul_f32 v104, v104, v108
    v_mul_f32 v105, v105, v109
    v_mfma_f32_16x16x32_bf16 v[216:219], v[88:91], v[88:91], v[216:219]
    ds_read_b64_tr_b16 v[76:77], v15 offset:24576
    buffer_load_dwordx4 a[56:59], v52, s[4:7], s60 offen offset:2048 sc1
    v_cvt_pk_bf16_f32 v240, v96, v97
    v_cvt_pk_bf16_f32 v241, v104, v105
    ds_write2st64_b32 v234, v240, v241 offset0:15 offset1:23
    s_waitcnt lgkmcnt(8)
    v_mfma_f32_16x16x32_bf16 v[156:159], a[60:63], v[92:95], v[156:159]
    ds_read_b64_tr_b16 v[78:79], v15 offset:25088
    v_fma_f32 v96, v16, v45, v28
    v_fma_f32 v97, v17, v45, v29
    v_fma_f32 v98, v18, v45, v30
    v_mfma_f32_16x16x32_bf16 v[188:191], a[64:67], v[92:95], v[188:191]
    v_fma_f32 v99, v19, v45, v31
    v_fma_f32 v104, v20, v45, v32
    v_fma_f32 v105, v21, v45, v33
    v_mfma_f32_16x16x32_bf16 v[220:223], v[92:95], v[92:95], v[220:223]
    v_fma_f32 v106, v22, v45, v34
    v_fma_f32 v107, v23, v45, v35
    v_fmac_f32 v96, v136, v44
    s_waitcnt lgkmcnt(7)
    v_mfma_f32_16x16x32_bf16 v[144:147], a[72:75], v[64:67], v[144:147]
    v_fmac_f32 v97, v137, v44
    v_fmac_f32 v98, v138, v44
    v_fmac_f32 v99, v139, v44
    v_mfma_f32_16x16x32_bf16 v[176:179], a[76:79], v[64:67], v[176:179]
    v_fmac_f32 v104, v168, v44
    v_fmac_f32 v105, v169, v44
    v_fmac_f32 v106, v170, v44
    v_mfma_f32_16x16x32_bf16 v[208:211], v[64:67], v[64:67], v[208:211]
    ds_read_b64_tr_b16 v[80:81], v12 offset:28672
    buffer_load_dwordx4 a[60:63], v52, s[4:7], s60 offen offset:3072 sc1
    s_add_u32 s60, s60, 4096
    v_fmac_f32 v107, v171, v44
    v_mul_f32 v100, v96, v96
    v_mul_f32 v101, v97, v97
    s_waitcnt lgkmcnt(6)
    v_mfma_f32_16x16x32_bf16 v[148:151], a[72:75], v[68:71], v[148:151]
    ds_read_b64_tr_b16 v[82:83], v12 offset:29184
    v_mul_f32 v108, v104, v104
    v_mul_f32 v109, v105, v105
    v_fma_f32 v100, v100, s56, v51
    v_mfma_f32_16x16x32_bf16 v[180:183], a[76:79], v[68:71], v[180:183]
    ds_read_b64_tr_b16 v[84:85], v13 offset:28672
    v_fma_f32 v101, v101, s56, v51
    v_fma_f32 v108, v108, s56, v51
    v_fma_f32 v109, v109, s56, v51
    v_mfma_f32_16x16x32_bf16 v[212:215], v[68:71], v[68:71], v[212:215]
    ds_read_b64_tr_b16 v[86:87], v13 offset:29184
    buffer_load_dwordx3 a[64:66], v53, s[4:7], s60 offen offset:0 sc1
    v_accvgpr_write_b32 a67, 0
    v_mul_f32 v100, v100, v96
    v_mul_f32 v101, v101, v97
    v_mul_f32 v108, v108, v104
    s_waitcnt lgkmcnt(7)
    v_mfma_f32_16x16x32_bf16 v[152:155], a[72:75], v[72:75], v[152:155]
    ds_read_b64_tr_b16 v[88:89], v14 offset:28672
    v_mul_f32 v109, v109, v105
    v_exp_f32 v100, v100
    v_mfma_f32_16x16x32_bf16 v[184:187], a[76:79], v[72:75], v[184:187]
    ds_read_b64_tr_b16 v[90:91], v14 offset:29184
    v_exp_f32 v101, v101
    v_exp_f32 v108, v108
    v_mfma_f32_16x16x32_bf16 v[216:219], v[72:75], v[72:75], v[216:219]
    ds_read_b64_tr_b16 v[92:93], v15 offset:28672
    buffer_load_dwordx3 a[68:70], v53, s[4:7], s60 offen offset:768 sc1
    v_accvgpr_write_b32 a71, 0
    v_exp_f32 v109, v109
    v_mul_f32 v96, v96, v98
    s_waitcnt lgkmcnt(7)
    v_mfma_f32_16x16x32_bf16 v[156:159], a[72:75], v[76:79], v[156:159]
    ds_read_b64_tr_b16 v[94:95], v15 offset:29184
    v_mul_f32 v97, v97, v99
    v_mul_f32 v104, v104, v106
    v_mul_f32 v105, v105, v107
    v_mfma_f32_16x16x32_bf16 v[188:191], a[76:79], v[76:79], v[188:191]
    v_add_f32 v100, 1.0, v100
    v_add_f32 v101, 1.0, v101
    v_add_f32 v108, 1.0, v108
    v_mfma_f32_16x16x32_bf16 v[220:223], v[76:79], v[76:79], v[220:223]
    v_add_f32 v109, 1.0, v109
    v_rcp_f32 v100, v100
    s_waitcnt vmcnt(38)
    s_waitcnt lgkmcnt(0)
    s_barrier
    v_mfma_f32_16x16x32_bf16 v[144:147], a[84:87], v[80:83], v[144:147]
    v_rcp_f32 v101, v101
    v_rcp_f32 v108, v108
    v_mfma_f32_16x16x32_bf16 v[176:179], a[88:91], v[80:83], v[176:179]
    v_rcp_f32 v109, v109
    v_mul_f32 v96, v96, v100
    v_mfma_f32_16x16x32_bf16 v[208:211], v[80:83], v[80:83], v[208:211]
    ds_read_b64_tr_b16 v[64:65], v12 offset:32768
    buffer_load_dwordx3 a[72:74], v53, s[4:7], s60 offen offset:1536 sc1
    v_accvgpr_write_b32 a75, 0
    v_mul_f32 v97, v97, v101
    v_mul_f32 v104, v104, v108
    v_mul_f32 v105, v105, v109
    v_mfma_f32_16x16x32_bf16 v[148:151], a[84:87], v[84:87], v[148:151]
    ds_read_b64_tr_b16 v[66:67], v12 offset:33280
    v_cvt_pk_bf16_f32 v244, v96, v97
    v_cvt_pk_bf16_f32 v245, v104, v105
    ds_write2st64_b32 v234, v244, v245 offset0:16 offset1:24
    v_mfma_f32_16x16x32_bf16 v[180:183], a[88:91], v[84:87], v[180:183]
    ds_read_b64_tr_b16 v[68:69], v13 offset:32768
    v_fma_f32 v96, v16, v47, v28
    v_fma_f32 v97, v17, v47, v29
    v_fma_f32 v98, v18, v47, v30
    v_mfma_f32_16x16x32_bf16 v[212:215], v[84:87], v[84:87], v[212:215]
    ds_read_b64_tr_b16 v[70:71], v13 offset:33280
    buffer_load_dwordx3 a[76:78], v53, s[4:7], s60 offen offset:2304 sc1
    v_accvgpr_write_b32 a79, 0
    s_add_u32 s60, s60, 3072
    v_fma_f32 v99, v19, v47, v31
    v_fma_f32 v104, v20, v47, v32
    v_fma_f32 v105, v21, v47, v33
    v_mfma_f32_16x16x32_bf16 v[152:155], a[84:87], v[88:91], v[152:155]
    ds_read_b64_tr_b16 v[72:73], v14 offset:32768
    v_fma_f32 v106, v22, v47, v34
    v_fma_f32 v107, v23, v47, v35
    v_fmac_f32 v96, v140, v46
    buffer_store_dwordx4 v[236:239], v229, s[4:7], s54 offen sc1
    s_add_u32 s54, s54, 49152
    v_mfma_f32_16x16x32_bf16 v[184:187], a[88:91], v[88:91], v[184:187]
    ds_read_b64_tr_b16 v[74:75], v14 offset:33280
    v_fmac_f32 v97, v141, v46
    v_fmac_f32 v98, v142, v46
    v_fmac_f32 v99, v143, v46
    v_mfma_f32_16x16x32_bf16 v[216:219], v[88:91], v[88:91], v[216:219]
    ds_read_b64_tr_b16 v[76:77], v15 offset:32768
    buffer_load_dwordx4 a[80:83], v52, s[4:7], s60 offen offset:0 sc1
    v_fmac_f32 v104, v172, v46
    v_fmac_f32 v105, v173, v46
    v_fmac_f32 v106, v174, v46
    v_mfma_f32_16x16x32_bf16 v[156:159], a[84:87], v[92:95], v[156:159]
    ds_read_b64_tr_b16 v[78:79], v15 offset:33280
    v_fmac_f32 v107, v175, v46
    v_mul_f32 v100, v96, v96
    v_mul_f32 v101, v97, v97
    v_mfma_f32_16x16x32_bf16 v[188:191], a[88:91], v[92:95], v[188:191]
    v_mul_f32 v108, v104, v104
    v_mul_f32 v109, v105, v105
    v_fma_f32 v100, v100, s56, v51
    v_mfma_f32_16x16x32_bf16 v[220:223], v[92:95], v[92:95], v[220:223]
    v_fma_f32 v101, v101, s56, v51
    v_fma_f32 v108, v108, s56, v51
    v_fma_f32 v109, v109, s56, v51
    s_waitcnt lgkmcnt(7)
    v_mfma_f32_16x16x32_bf16 v[144:147], a[96:99], v[64:67], v[144:147]
    v_mul_f32 v100, v100, v96
    v_mul_f32 v101, v101, v97
    v_mul_f32 v108, v108, v104
    v_mfma_f32_16x16x32_bf16 v[176:179], a[100:103], v[64:67], v[176:179]
    v_mul_f32 v109, v109, v105
    v_exp_f32 v100, v100
    v_mfma_f32_16x16x32_bf16 v[208:211], v[64:67], v[64:67], v[208:211]
    ds_read_b64_tr_b16 v[80:81], v12 offset:36864
    buffer_load_dwordx4 a[84:87], v52, s[4:7], s60 offen offset:1024 sc1
    v_exp_f32 v101, v101
    v_exp_f32 v108, v108
    s_waitcnt lgkmcnt(5)
    v_mfma_f32_16x16x32_bf16 v[148:151], a[96:99], v[68:71], v[148:151]
    ds_read_b64_tr_b16 v[82:83], v12 offset:37376
    v_exp_f32 v109, v109
    v_mul_f32 v96, v96, v98
    v_mfma_f32_16x16x32_bf16 v[180:183], a[100:103], v[68:71], v[180:183]
    ds_read_b64_tr_b16 v[84:85], v13 offset:36864
    v_mul_f32 v97, v97, v99
    v_mul_f32 v104, v104, v106
    v_mul_f32 v105, v105, v107
    v_mfma_f32_16x16x32_bf16 v[212:215], v[68:71], v[68:71], v[212:215]
    ds_read_b64_tr_b16 v[86:87], v13 offset:37376
    buffer_load_dwordx4 a[88:91], v52, s[4:7], s60 offen offset:2048 sc1
    v_add_f32 v100, 1.0, v100
    v_add_f32 v101, 1.0, v101
    v_add_f32 v108, 1.0, v108
    s_waitcnt lgkmcnt(6)
    v_mfma_f32_16x16x32_bf16 v[152:155], a[96:99], v[72:75], v[152:155]
    ds_read_b64_tr_b16 v[88:89], v14 offset:36864
    v_add_f32 v109, 1.0, v109
    v_rcp_f32 v100, v100
    buffer_store_dwordx4 v[240:243], v229, s[4:7], s54 offen sc1
    s_add_u32 s54, s54, 49152
    v_mfma_f32_16x16x32_bf16 v[184:187], a[100:103], v[72:75], v[184:187]
    ds_read_b64_tr_b16 v[90:91], v14 offset:37376
    v_rcp_f32 v101, v101
    v_rcp_f32 v108, v108
    v_mfma_f32_16x16x32_bf16 v[216:219], v[72:75], v[72:75], v[216:219]
    ds_read_b64_tr_b16 v[92:93], v15 offset:36864
    buffer_load_dwordx4 a[92:95], v52, s[4:7], s60 offen offset:3072 sc1
    s_add_u32 s60, s60, 4096
    v_rcp_f32 v109, v109
    v_mul_f32 v96, v96, v100
    s_waitcnt lgkmcnt(7)
    v_mfma_f32_16x16x32_bf16 v[156:159], a[96:99], v[76:79], v[156:159]
    ds_read_b64_tr_b16 v[94:95], v15 offset:37376
    v_mul_f32 v97, v97, v101
    v_mul_f32 v104, v104, v108
    v_mul_f32 v105, v105, v109
    v_mfma_f32_16x16x32_bf16 v[188:191], a[100:103], v[76:79], v[188:191]
    v_cvt_pk_bf16_f32 v248, v96, v97
    v_cvt_pk_bf16_f32 v249, v104, v105
    ds_write2st64_b32 v234, v248, v249 offset0:17 offset1:25
    v_mfma_f32_16x16x32_bf16 v[220:223], v[76:79], v[76:79], v[220:223]
    s_waitcnt lgkmcnt(7)
    v_mfma_f32_16x16x32_bf16 v[144:147], a[108:111], v[80:83], v[144:147]
    v_mfma_f32_16x16x32_bf16 v[176:179], a[112:115], v[80:83], v[176:179]
    v_mfma_f32_16x16x32_bf16 v[208:211], v[80:83], v[80:83], v[208:211]
    ds_read_b64_tr_b16 v[64:65], v12 offset:40960
    buffer_load_dwordx4 a[96:99], v52, s[4:7], s60 offen offset:0 sc1
    s_waitcnt lgkmcnt(6)
    v_mfma_f32_16x16x32_bf16 v[148:151], a[108:111], v[84:87], v[148:151]
    ds_read_b64_tr_b16 v[66:67], v12 offset:41472
    v_mfma_f32_16x16x32_bf16 v[180:183], a[112:115], v[84:87], v[180:183]
    ds_read_b64_tr_b16 v[68:69], v13 offset:40960
    v_mfma_f32_16x16x32_bf16 v[212:215], v[84:87], v[84:87], v[212:215]
    ds_read_b64_tr_b16 v[70:71], v13 offset:41472
    buffer_load_dwordx4 a[100:103], v52, s[4:7], s60 offen offset:1024 sc1
    s_waitcnt lgkmcnt(7)
    v_mfma_f32_16x16x32_bf16 v[152:155], a[108:111], v[88:91], v[152:155]
    ds_read_b64_tr_b16 v[72:73], v14 offset:40960
    v_mfma_f32_16x16x32_bf16 v[184:187], a[112:115], v[88:91], v[184:187]
    ds_read_b64_tr_b16 v[74:75], v14 offset:41472
    v_mfma_f32_16x16x32_bf16 v[216:219], v[88:91], v[88:91], v[216:219]
    ds_read_b64_tr_b16 v[76:77], v15 offset:40960
    buffer_load_dwordx4 a[104:107], v52, s[4:7], s60 offen offset:2048 sc1
    s_waitcnt lgkmcnt(8)
    v_mfma_f32_16x16x32_bf16 v[156:159], a[108:111], v[92:95], v[156:159]
    ds_read_b64_tr_b16 v[78:79], v15 offset:41472
    v_mfma_f32_16x16x32_bf16 v[188:191], a[112:115], v[92:95], v[188:191]
    v_mfma_f32_16x16x32_bf16 v[220:223], v[92:95], v[92:95], v[220:223]
    s_waitcnt lgkmcnt(6)
    v_mfma_f32_16x16x32_bf16 v[144:147], a[120:123], v[64:67], v[144:147]
    v_mfma_f32_16x16x32_bf16 v[176:179], a[124:127], v[64:67], v[176:179]
    v_mfma_f32_16x16x32_bf16 v[208:211], v[64:67], v[64:67], v[208:211]
    ds_read_b64_tr_b16 v[80:81], v12 offset:45056
    buffer_load_dwordx4 a[108:111], v52, s[4:7], s60 offen offset:3072 sc1
    s_add_u32 s60, s60, 4096
    s_waitcnt lgkmcnt(5)
    v_mfma_f32_16x16x32_bf16 v[148:151], a[120:123], v[68:71], v[148:151]
    ds_read_b64_tr_b16 v[82:83], v12 offset:45568
    v_mfma_f32_16x16x32_bf16 v[180:183], a[124:127], v[68:71], v[180:183]
    ds_read_b64_tr_b16 v[84:85], v13 offset:45056
    v_mfma_f32_16x16x32_bf16 v[212:215], v[68:71], v[68:71], v[212:215]
    ds_read_b64_tr_b16 v[86:87], v13 offset:45568
    buffer_load_dwordx3 a[112:114], v53, s[4:7], s60 offen offset:0 sc1
    v_accvgpr_write_b32 a115, 0
    s_waitcnt lgkmcnt(6)
    v_mfma_f32_16x16x32_bf16 v[152:155], a[120:123], v[72:75], v[152:155]
    ds_read_b64_tr_b16 v[88:89], v14 offset:45056
    v_mfma_f32_16x16x32_bf16 v[184:187], a[124:127], v[72:75], v[184:187]
    ds_read_b64_tr_b16 v[90:91], v14 offset:45568
    v_mfma_f32_16x16x32_bf16 v[216:219], v[72:75], v[72:75], v[216:219]
    ds_read_b64_tr_b16 v[92:93], v15 offset:45056
    buffer_load_dwordx3 a[116:118], v53, s[4:7], s60 offen offset:768 sc1
    v_accvgpr_write_b32 a119, 0
    s_waitcnt lgkmcnt(7)
    v_mfma_f32_16x16x32_bf16 v[156:159], a[120:123], v[76:79], v[156:159]
    ds_read_b64_tr_b16 v[94:95], v15 offset:45568
    v_mfma_f32_16x16x32_bf16 v[188:191], a[124:127], v[76:79], v[188:191]
    v_mfma_f32_16x16x32_bf16 v[220:223], v[76:79], v[76:79], v[220:223]
    s_waitcnt vmcnt(48)
    s_waitcnt vmcnt(7)
    s_waitcnt lgkmcnt(0)
    s_barrier
    s_mov_b64 exec, s[76:77]
    buffer_store_dword v56, v50, s[4:7], s66 offen offset:0 sc1
    s_mov_b64 exec, -1
    v_mfma_f32_16x16x32_bf16 v[144:147], a[132:135], v[80:83], v[144:147]
    v_mfma_f32_16x16x32_bf16 v[176:179], a[136:139], v[80:83], v[176:179]
    v_mfma_f32_16x16x32_bf16 v[208:211], v[80:83], v[80:83], v[208:211]
    ds_read_b64_tr_b16 v[64:65], v12 offset:49152
    buffer_load_dwordx3 a[120:122], v53, s[4:7], s60 offen offset:1536 sc1
    v_accvgpr_write_b32 a123, 0
    v_mfma_f32_16x16x32_bf16 v[148:151], a[132:135], v[84:87], v[148:151]
    ds_read_b64_tr_b16 v[66:67], v12 offset:49664
    v_mfma_f32_16x16x32_bf16 v[180:183], a[136:139], v[84:87], v[180:183]
    ds_read_b64_tr_b16 v[68:69], v13 offset:49152
    v_mfma_f32_16x16x32_bf16 v[212:215], v[84:87], v[84:87], v[212:215]
    ds_read_b64_tr_b16 v[70:71], v13 offset:49664
    buffer_load_dwordx3 a[124:126], v53, s[4:7], s60 offen offset:2304 sc1
    v_accvgpr_write_b32 a127, 0
    s_add_u32 s60, s60, 3072
    v_mfma_f32_16x16x32_bf16 v[152:155], a[132:135], v[88:91], v[152:155]
    ds_read_b64_tr_b16 v[72:73], v14 offset:49152
    buffer_store_dwordx4 v[244:247], v229, s[4:7], s54 offen sc1
    s_add_u32 s54, s54, 49152
    v_mfma_f32_16x16x32_bf16 v[184:187], a[136:139], v[88:91], v[184:187]
    ds_read_b64_tr_b16 v[74:75], v14 offset:49664
    v_mfma_f32_16x16x32_bf16 v[216:219], v[88:91], v[88:91], v[216:219]
    ds_read_b64_tr_b16 v[76:77], v15 offset:49152
    v_mfma_f32_16x16x32_bf16 v[156:159], a[132:135], v[92:95], v[156:159]
    ds_read_b64_tr_b16 v[78:79], v15 offset:49664
    v_mfma_f32_16x16x32_bf16 v[188:191], a[136:139], v[92:95], v[188:191]
    v_mfma_f32_16x16x32_bf16 v[220:223], v[92:95], v[92:95], v[220:223]
    s_waitcnt lgkmcnt(6)
    v_mfma_f32_16x16x32_bf16 v[144:147], a[144:147], v[64:67], v[144:147]
    v_mfma_f32_16x16x32_bf16 v[176:179], a[148:151], v[64:67], v[176:179]
    v_mfma_f32_16x16x32_bf16 v[208:211], v[64:67], v[64:67], v[208:211]
    ds_read_b64_tr_b16 v[80:81], v12 offset:53248
    s_waitcnt lgkmcnt(5)
    v_mfma_f32_16x16x32_bf16 v[148:151], a[144:147], v[68:71], v[148:151]
    ds_read_b64_tr_b16 v[82:83], v12 offset:53760
    v_mfma_f32_16x16x32_bf16 v[180:183], a[148:151], v[68:71], v[180:183]
    ds_read_b64_tr_b16 v[84:85], v13 offset:53248
    v_mfma_f32_16x16x32_bf16 v[212:215], v[68:71], v[68:71], v[212:215]
    ds_read_b64_tr_b16 v[86:87], v13 offset:53760
    s_waitcnt lgkmcnt(6)
    v_mfma_f32_16x16x32_bf16 v[152:155], a[144:147], v[72:75], v[152:155]
    ds_read_b64_tr_b16 v[88:89], v14 offset:53248
    buffer_store_dwordx4 v[248:251], v229, s[4:7], s54 offen sc1
    s_add_u32 s54, s54, 49152
    v_mfma_f32_16x16x32_bf16 v[184:187], a[148:151], v[72:75], v[184:187]
    ds_read_b64_tr_b16 v[90:91], v14 offset:53760
    v_mfma_f32_16x16x32_bf16 v[216:219], v[72:75], v[72:75], v[216:219]
    ds_read_b64_tr_b16 v[92:93], v15 offset:53248
    s_waitcnt lgkmcnt(7)
    v_mfma_f32_16x16x32_bf16 v[156:159], a[144:147], v[76:79], v[156:159]
    ds_read_b64_tr_b16 v[94:95], v15 offset:53760
    v_mfma_f32_16x16x32_bf16 v[188:191], a[148:151], v[76:79], v[188:191]
    v_mfma_f32_16x16x32_bf16 v[220:223], v[76:79], v[76:79], v[220:223]
    s_waitcnt lgkmcnt(6)
    v_mfma_f32_16x16x32_bf16 v[144:147], a[156:159], v[80:83], v[144:147]
    v_mfma_f32_16x16x32_bf16 v[176:179], a[160:163], v[80:83], v[176:179]
    v_mfma_f32_16x16x32_bf16 v[208:211], v[80:83], v[80:83], v[208:211]
    ds_read_b64_tr_b16 v[64:65], v12 offset:57344
    s_waitcnt lgkmcnt(5)
    v_mfma_f32_16x16x32_bf16 v[148:151], a[156:159], v[84:87], v[148:151]
    ds_read_b64_tr_b16 v[66:67], v12 offset:57856
    v_mfma_f32_16x16x32_bf16 v[180:183], a[160:163], v[84:87], v[180:183]
    ds_read_b64_tr_b16 v[68:69], v13 offset:57344
    v_mfma_f32_16x16x32_bf16 v[212:215], v[84:87], v[84:87], v[212:215]
    ds_read_b64_tr_b16 v[70:71], v13 offset:57856
    s_waitcnt lgkmcnt(6)
    v_mfma_f32_16x16x32_bf16 v[152:155], a[156:159], v[88:91], v[152:155]
    ds_read_b64_tr_b16 v[72:73], v14 offset:57344
    v_mfma_f32_16x16x32_bf16 v[184:187], a[160:163], v[88:91], v[184:187]
    ds_read_b64_tr_b16 v[74:75], v14 offset:57856
    v_mfma_f32_16x16x32_bf16 v[216:219], v[88:91], v[88:91], v[216:219]
    ds_read_b64_tr_b16 v[76:77], v15 offset:57344
    s_waitcnt lgkmcnt(7)
    v_mfma_f32_16x16x32_bf16 v[156:159], a[156:159], v[92:95], v[156:159]
    ds_read_b64_tr_b16 v[78:79], v15 offset:57856
    v_mfma_f32_16x16x32_bf16 v[188:191], a[160:163], v[92:95], v[188:191]
    v_mfma_f32_16x16x32_bf16 v[220:223], v[92:95], v[92:95], v[220:223]
    s_waitcnt lgkmcnt(6)
    v_mfma_f32_16x16x32_bf16 v[144:147], a[168:171], v[64:67], v[144:147]
    v_mfma_f32_16x16x32_bf16 v[176:179], a[172:175], v[64:67], v[176:179]
    v_mfma_f32_16x16x32_bf16 v[208:211], v[64:67], v[64:67], v[208:211]
    ds_read_b64_tr_b16 v[80:81], v12 offset:61440
    s_waitcnt lgkmcnt(5)
    v_mfma_f32_16x16x32_bf16 v[148:151], a[168:171], v[68:71], v[148:151]
    ds_read_b64_tr_b16 v[82:83], v12 offset:61952
    v_mfma_f32_16x16x32_bf16 v[180:183], a[172:175], v[68:71], v[180:183]
    ds_read_b64_tr_b16 v[84:85], v13 offset:61440
    v_mfma_f32_16x16x32_bf16 v[212:215], v[68:71], v[68:71], v[212:215]
    ds_read_b64_tr_b16 v[86:87], v13 offset:61952
    s_waitcnt lgkmcnt(6)
    v_mfma_f32_16x16x32_bf16 v[152:155], a[168:171], v[72:75], v[152:155]
    ds_read_b64_tr_b16 v[88:89], v14 offset:61440
    v_mfma_f32_16x16x32_bf16 v[184:187], a[172:175], v[72:75], v[184:187]
    ds_read_b64_tr_b16 v[90:91], v14 offset:61952
    v_mfma_f32_16x16x32_bf16 v[216:219], v[72:75], v[72:75], v[216:219]
    ds_read_b64_tr_b16 v[92:93], v15 offset:61440
    s_waitcnt lgkmcnt(7)
    v_mfma_f32_16x16x32_bf16 v[156:159], a[168:171], v[76:79], v[156:159]
    ds_read_b64_tr_b16 v[94:95], v15 offset:61952
    v_mfma_f32_16x16x32_bf16 v[188:191], a[172:175], v[76:79], v[188:191]
    v_mfma_f32_16x16x32_bf16 v[220:223], v[76:79], v[76:79], v[220:223]
    buffer_load_dword v62, v63, s[4:7], s74 offen offset:0 sc1
    s_waitcnt lgkmcnt(6)
    v_mfma_f32_16x16x32_bf16 v[208:211], v[80:83], v[80:83], v[208:211]
    s_waitcnt lgkmcnt(4)
    v_mfma_f32_16x16x32_bf16 v[212:215], v[84:87], v[84:87], v[212:215]
    s_waitcnt lgkmcnt(2)
    v_mfma_f32_16x16x32_bf16 v[216:219], v[88:91], v[88:91], v[216:219]
    s_waitcnt lgkmcnt(0)
    v_mfma_f32_16x16x32_bf16 v[220:223], v[92:95], v[92:95], v[220:223]
    v_mfma_f32_16x16x32_bf16 v[144:147], a[180:183], v[80:83], v[144:147]
    v_mfma_f32_16x16x32_bf16 v[148:151], a[180:183], v[84:87], v[148:151]
    ds_write_b128 v233, v[208:211] offset:4096
    v_mfma_f32_16x16x32_bf16 v[152:155], a[180:183], v[88:91], v[152:155]
    ds_write_b128 v233, v[212:215] offset:5120
    v_mfma_f32_16x16x32_bf16 v[156:159], a[180:183], v[92:95], v[156:159]
    ds_write_b128 v233, v[216:219] offset:6144
    v_mfma_f32_16x16x32_bf16 v[176:179], a[184:187], v[80:83], v[176:179]
    ds_write_b128 v233, v[220:223] offset:7168
    v_mfma_f32_16x16x32_bf16 v[180:183], a[184:187], v[84:87], v[180:183]
    ds_write_b32 v234, v145 offset:1024
    v_mfma_f32_16x16x32_bf16 v[184:187], a[184:187], v[88:91], v[184:187]
    ds_write_b32 v234, v149 offset:1280
    v_mfma_f32_16x16x32_bf16 v[188:191], a[184:187], v[92:95], v[188:191]
    ds_write_b32 v234, v153 offset:1536
    s_nop 4
    ds_write_b32 v234, v157 offset:1792
    s_waitcnt lgkmcnt(0)
    s_waitcnt vmcnt(1)
    s_barrier
    s_mov_b64 exec, s[76:77]
    buffer_store_dword v56, v50, s[4:7], s66 offen offset:128 sc1
    s_mov_b64 exec, -1
    ds_read2st64_b32 v[120:121], v227 offset0:4 offset1:5
    ds_read2st64_b32 v[124:125], v226 offset0:16 offset1:20
    ds_read2st64_b32 v[122:123], v227 offset0:6 offset1:7
    ds_read2st64_b32 v[126:127], v226 offset0:24 offset1:28
    s_waitcnt lgkmcnt(2)
    v_pk_mul_f32 v[120:121], v[120:121], v[230:231] op_sel_hi:[1,0]
    v_pk_fma_f32 v[124:125], v[124:125], v[230:231], v[230:231] op_sel:[0,0,1] op_sel_hi:[1,0,1]
    v_pk_fma_f32 v[124:125], v[120:121], v[120:121], v[124:125] neg_lo:[1,0,0] neg_hi:[1,0,0]
    v_rsq_f32 v40, v124
    v_rsq_f32 v42, v125
    v_mul_f32 v41, -v120, v40
    v_mul_f32 v43, -v121, v42

    s_waitcnt lgkmcnt(0)
    v_pk_mul_f32 v[122:123], v[122:123], v[230:231] op_sel_hi:[1,0]
    v_pk_fma_f32 v[126:127], v[126:127], v[230:231], v[230:231] op_sel:[0,0,1] op_sel_hi:[1,0,1]
    v_pk_fma_f32 v[126:127], v[122:123], v[122:123], v[126:127] neg_lo:[1,0,0] neg_hi:[1,0,0]
    v_rsq_f32 v44, v126
    v_rsq_f32 v46, v127
    v_mul_f32 v45, -v122, v44
    v_mul_f32 v47, -v123, v46

    v_pk_fma_f32 v[96:97], v[16:17], v[40:41], v[28:29] op_sel:[0,1,0] op_sel_hi:[1,1,1]
    v_pk_fma_f32 v[98:99], v[18:19], v[40:41], v[30:31] op_sel:[0,1,0] op_sel_hi:[1,1,1]
    v_pk_fma_f32 v[104:105], v[20:21], v[40:41], v[32:33] op_sel:[0,1,0] op_sel_hi:[1,1,1]
    v_pk_fma_f32 v[106:107], v[22:23], v[40:41], v[34:35] op_sel:[0,1,0] op_sel_hi:[1,1,1]
    v_pk_fma_f32 v[96:97], v[144:145], v[40:41], v[96:97] op_sel_hi:[1,0,1]
    v_pk_fma_f32 v[98:99], v[146:147], v[40:41], v[98:99] op_sel_hi:[1,0,1]
    v_pk_fma_f32 v[104:105], v[176:177], v[40:41], v[104:105] op_sel_hi:[1,0,1]
    v_pk_fma_f32 v[106:107], v[178:179], v[40:41], v[106:107] op_sel_hi:[1,0,1]
    v_pk_mul_f32 v[100:101], v[96:97], v[96:97]
    v_pk_mul_f32 v[108:109], v[104:105], v[104:105]
    v_pk_fma_f32 v[100:101], v[100:101], s[56:57], s[56:57] op_sel:[0,0,1] op_sel_hi:[1,0,1]
    v_pk_fma_f32 v[108:109], v[108:109], s[56:57], s[56:57] op_sel:[0,0,1] op_sel_hi:[1,0,1]
    v_pk_mul_f32 v[100:101], v[100:101], v[96:97]
    v_pk_mul_f32 v[108:109], v[108:109], v[104:105]
    v_exp_f32 v100, v100
    v_exp_f32 v101, v101
    v_exp_f32 v108, v108
    v_exp_f32 v109, v109
    v_pk_mul_f32 v[96:97], v[96:97], v[98:99]
    v_pk_mul_f32 v[104:105], v[104:105], v[106:107]
    v_pk_add_f32 v[100:101], v[100:101], 1.0 op_sel_hi:[1,0]
    v_pk_add_f32 v[108:109], v[108:109], 1.0 op_sel_hi:[1,0]
    v_rcp_f32 v100, v100
    v_rcp_f32 v101, v101
    v_rcp_f32 v108, v108
    v_rcp_f32 v109, v109
    v_pk_mul_f32 v[96:97], v[96:97], v[100:101]
    v_pk_mul_f32 v[104:105], v[104:105], v[108:109]
    v_cvt_pk_bf16_f32 v236, v96, v97
    v_cvt_pk_bf16_f32 v237, v104, v105
    ds_write2st64_b32 v234, v236, v237 offset0:18 offset1:26
    s_waitcnt vmcnt(1)
    s_mov_b32 s75, 0
    s_branch K3_ph0w1_c
K3_ph0w1:
    buffer_load_dword v62, v63, s[4:7], s74 offen offset:0 sc1
    s_add_u32 s75, s75, 1
    s_waitcnt vmcnt(0)
K3_ph0w1_c:
    v_cmpx_ne_u32 vcc, s30, v62
    s_cmp_gt_u32 s75, 0x40000
    s_cbranch_scc1 K3_ph0w1_x
    s_cbranch_execnz K3_ph0w1
K3_ph0w1_x:
    s_mov_b64 exec, -1

    v_pk_fma_f32 v[96:97], v[16:17], v[42:43], v[28:29] op_sel:[0,1,0] op_sel_hi:[1,1,1]
    v_pk_fma_f32 v[98:99], v[18:19], v[42:43], v[30:31] op_sel:[0,1,0] op_sel_hi:[1,1,1]
    v_pk_fma_f32 v[104:105], v[20:21], v[42:43], v[32:33] op_sel:[0,1,0] op_sel_hi:[1,1,1]
    v_pk_fma_f32 v[106:107], v[22:23], v[42:43], v[34:35] op_sel:[0,1,0] op_sel_hi:[1,1,1]
    buffer_load_dwordx4 v[64:67], v52, s[4:7], s64 offen offset:0 sc1
    buffer_load_dwordx4 v[68:71], v52, s[4:7], s64 offen offset:1024 sc1
    v_pk_fma_f32 v[96:97], v[148:149], v[42:43], v[96:97] op_sel_hi:[1,0,1]
    v_pk_fma_f32 v[98:99], v[150:151], v[42:43], v[98:99] op_sel_hi:[1,0,1]
    v_pk_fma_f32 v[104:105], v[180:181], v[42:43], v[104:105] op_sel_hi:[1,0,1]
    v_pk_fma_f32 v[106:107], v[182:183], v[42:43], v[106:107] op_sel_hi:[1,0,1]
    buffer_load_dwordx4 v[72:75], v52, s[4:7], s64 offen offset:2048 sc1
    buffer_load_dwordx4 v[76:79], v52, s[4:7], s64 offen offset:3072 sc1
    s_add_u32 s64, s64, 4096
    v_pk_mul_f32 v[100:101], v[96:97], v[96:97]
    v_pk_mul_f32 v[108:109], v[104:105], v[104:105]
    v_pk_fma_f32 v[100:101], v[100:101], s[56:57], s[56:57] op_sel:[0,0,1] op_sel_hi:[1,0,1]
    v_pk_fma_f32 v[108:109], v[108:109], s[56:57], s[56:57] op_sel:[0,0,1] op_sel_hi:[1,0,1]
    buffer_load_dwordx4 v[80:83], v52, s[4:7], s64 offen offset:0 sc1
    v_pk_mul_f32 v[100:101], v[100:101], v[96:97]
    v_pk_mul_f32 v[108:109], v[108:109], v[104:105]
    v_exp_f32 v100, v100
    v_exp_f32 v101, v101
    v_exp_f32 v108, v108
    v_exp_f32 v109, v109
    buffer_load_dwordx4 v[84:87], v52, s[4:7], s64 offen offset:1024 sc1
    v_pk_mul_f32 v[96:97], v[96:97], v[98:99]
    v_pk_mul_f32 v[104:105], v[104:105], v[106:107]
    v_pk_add_f32 v[100:101], v[100:101], 1.0 op_sel_hi:[1,0]
    v_pk_add_f32 v[108:109], v[108:109], 1.0 op_sel_hi:[1,0]
    buffer_store_dwordx4 v[236:239], v229, s[4:7], s54 offen sc1
    s_add_u32 s54, s54, 49152
    v_rcp_f32 v100, v100
    v_rcp_f32 v101, v101
    v_rcp_f32 v108, v108
    v_rcp_f32 v109, v109
    buffer_load_dwordx4 v[88:91], v52, s[4:7], s64 offen offset:2048 sc1
    buffer_load_dwordx4 v[92:95], v52, s[4:7], s64 offen offset:3072 sc1
    s_add_u32 s64, s64, 4096
    v_pk_mul_f32 v[96:97], v[96:97], v[100:101]
    v_pk_mul_f32 v[104:105], v[104:105], v[108:109]
    v_cvt_pk_bf16_f32 v240, v96, v97
    v_cvt_pk_bf16_f32 v241, v104, v105
    ds_write2st64_b32 v234, v240, v241 offset0:19 offset1:27
    s_waitcnt lgkmcnt(0)
    s_barrier
    v_pk_fma_f32 v[96:97], v[16:17], v[44:45], v[28:29] op_sel:[0,1,0] op_sel_hi:[1,1,1]
    v_pk_fma_f32 v[98:99], v[18:19], v[44:45], v[30:31] op_sel:[0,1,0] op_sel_hi:[1,1,1]
    v_pk_fma_f32 v[104:105], v[20:21], v[44:45], v[32:33] op_sel:[0,1,0] op_sel_hi:[1,1,1]
    v_pk_fma_f32 v[106:107], v[22:23], v[44:45], v[34:35] op_sel:[0,1,0] op_sel_hi:[1,1,1]
    buffer_load_dwordx4 v[128:131], v52, s[4:7], s64 offen offset:0 sc1
    buffer_load_dwordx4 v[132:135], v52, s[4:7], s64 offen offset:1024 sc1
    v_pk_fma_f32 v[96:97], v[152:153], v[44:45], v[96:97] op_sel_hi:[1,0,1]
    v_pk_fma_f32 v[98:99], v[154:155], v[44:45], v[98:99] op_sel_hi:[1,0,1]
    v_pk_fma_f32 v[104:105], v[184:185], v[44:45], v[104:105] op_sel_hi:[1,0,1]
    v_pk_fma_f32 v[106:107], v[186:187], v[44:45], v[106:107] op_sel_hi:[1,0,1]
    buffer_load_dwordx4 v[136:139], v52, s[4:7], s64 offen offset:2048 sc1
    buffer_load_dwordx4 v[140:143], v52, s[4:7], s64 offen offset:3072 sc1
    s_add_u32 s64, s64, 90112
    v_pk_mul_f32 v[100:101], v[96:97], v[96:97]
    v_pk_mul_f32 v[108:109], v[104:105], v[104:105]
    v_pk_fma_f32 v[100:101], v[100:101], s[56:57], s[56:57] op_sel:[0,0,1] op_sel_hi:[1,0,1]
    v_pk_fma_f32 v[108:109], v[108:109], s[56:57], s[56:57] op_sel:[0,0,1] op_sel_hi:[1,0,1]
    v_pk_mul_f32 v[100:101], v[100:101], v[96:97]
    v_pk_mul_f32 v[108:109], v[108:109], v[104:105]
    v_exp_f32 v100, v100
    v_exp_f32 v101, v101
    v_exp_f32 v108, v108
    v_exp_f32 v109, v109
    v_pk_mul_f32 v[96:97], v[96:97], v[98:99]
    v_pk_mul_f32 v[104:105], v[104:105], v[106:107]
    v_pk_add_f32 v[100:101], v[100:101], 1.0 op_sel_hi:[1,0]
    v_pk_add_f32 v[108:109], v[108:109], 1.0 op_sel_hi:[1,0]
    buffer_store_dwordx4 v[240:243], v229, s[4:7], s54 offen sc1
    s_add_u32 s54, s54, 49152
    v_rcp_f32 v100, v100
    v_rcp_f32 v101, v101
    v_rcp_f32 v108, v108
    v_rcp_f32 v109, v109
    v_pk_mul_f32 v[96:97], v[96:97], v[100:101]
    v_pk_mul_f32 v[104:105], v[104:105], v[108:109]
    v_cvt_pk_bf16_f32 v244, v96, v97
    v_cvt_pk_bf16_f32 v245, v104, v105
    ds_write2st64_b32 v234, v244, v245 offset0:20 offset1:28
    buffer_load_dword v62, v63, s[4:7], s74 offen offset:128 sc1
    v_pk_fma_f32 v[96:97], v[16:17], v[46:47], v[28:29] op_sel:[0,1,0] op_sel_hi:[1,1,1]
    v_pk_fma_f32 v[98:99], v[18:19], v[46:47], v[30:31] op_sel:[0,1,0] op_sel_hi:[1,1,1]
    v_pk_fma_f32 v[104:105], v[20:21], v[46:47], v[32:33] op_sel:[0,1,0] op_sel_hi:[1,1,1]
    v_pk_fma_f32 v[106:107], v[22:23], v[46:47], v[34:35] op_sel:[0,1,0] op_sel_hi:[1,1,1]
    v_pk_fma_f32 v[96:97], v[156:157], v[46:47], v[96:97] op_sel_hi:[1,0,1]
    v_pk_fma_f32 v[98:99], v[158:159], v[46:47], v[98:99] op_sel_hi:[1,0,1]
    v_pk_fma_f32 v[104:105], v[188:189], v[46:47], v[104:105] op_sel_hi:[1,0,1]
    v_pk_fma_f32 v[106:107], v[190:191], v[46:47], v[106:107] op_sel_hi:[1,0,1]
    v_pk_mul_f32 v[100:101], v[96:97], v[96:97]
    v_pk_mul_f32 v[108:109], v[104:105], v[104:105]
    v_pk_fma_f32 v[100:101], v[100:101], s[56:57], s[56:57] op_sel:[0,0,1] op_sel_hi:[1,0,1]
    v_pk_fma_f32 v[108:109], v[108:109], s[56:57], s[56:57] op_sel:[0,0,1] op_sel_hi:[1,0,1]
    v_pk_mul_f32 v[100:101], v[100:101], v[96:97]
    v_pk_mul_f32 v[108:109], v[108:109], v[104:105]
    v_exp_f32 v100, v100
    v_exp_f32 v101, v101
    v_exp_f32 v108, v108
    v_exp_f32 v109, v109
    v_pk_mul_f32 v[96:97], v[96:97], v[98:99]
    v_pk_mul_f32 v[104:105], v[104:105], v[106:107]
    v_pk_add_f32 v[100:101], v[100:101], 1.0 op_sel_hi:[1,0]
    v_pk_add_f32 v[108:109], v[108:109], 1.0 op_sel_hi:[1,0]
    buffer_store_dwordx4 v[244:247], v229, s[4:7], s54 offen sc1
    s_add_u32 s54, s54, 49152
    v_rcp_f32 v100, v100
    v_rcp_f32 v101, v101
    v_rcp_f32 v108, v108
    v_rcp_f32 v109, v109
    v_pk_mul_f32 v[96:97], v[96:97], v[100:101]
    v_pk_mul_f32 v[104:105], v[104:105], v[108:109]
    v_cvt_pk_bf16_f32 v248, v96, v97
    v_cvt_pk_bf16_f32 v249, v104, v105
    ds_write2st64_b32 v234, v248, v249 offset0:21 offset1:29
    s_waitcnt lgkmcnt(0)
    s_barrier
    buffer_store_dwordx4 v[248:251], v229, s[4:7], s54 offen sc1
    s_add_u32 s54, s54, 49152
K3_p2:
    s_mov_b32 s12, s42
    s_mov_b32 s13, s43
    s_waitcnt vmcnt(16)
    v_mfma_f32_16x16x32_bf16 a[128:131], v[64:67], a[192:195], 0
    v_mfma_f32_16x16x32_bf16 a[132:135], v[64:67], a[196:199], 0
    v_mfma_f32_16x16x32_bf16 a[136:139], v[64:67], a[200:203], 0
    v_mfma_f32_16x16x32_bf16 a[140:143], v[64:67], a[204:207], 0
    s_waitcnt vmcnt(15)
    v_mfma_f32_16x16x32_bf16 a[128:131], v[68:71], a[208:211], a[128:131]
    v_mfma_f32_16x16x32_bf16 a[132:135], v[68:71], a[212:215], a[132:135]
    v_mfma_f32_16x16x32_bf16 a[136:139], v[68:71], a[216:219], a[136:139]
    v_mfma_f32_16x16x32_bf16 a[140:143], v[68:71], a[220:223], a[140:143]
    s_waitcnt vmcnt(2)
    s_mov_b32 s75, 0
    s_branch K3_ph1_c
K3_ph1:
    buffer_load_dword v62, v63, s[4:7], s74 offen offset:128 sc1
    s_add_u32 s75, s75, 1
    s_waitcnt vmcnt(0)
K3_ph1_c:
    v_cmpx_ne_u32 vcc, s30, v62
    s_cmp_gt_u32 s75, 0x40000
    s_cbranch_scc1 K3_ph1_x
    s_cbranch_execnz K3_ph1
K3_ph1_x:
    s_mov_b64 exec, -1

    buffer_load_dwordx4 v[160:163], v52, s[4:7], s64 offen offset:0 sc1
    buffer_load_dwordx4 v[164:167], v52, s[4:7], s64 offen offset:1024 sc1
    buffer_load_dwordx4 v[168:171], v52, s[4:7], s64 offen offset:2048 sc1
    buffer_load_dwordx4 v[172:175], v52, s[4:7], s64 offen offset:3072 sc1
    s_add_u32 s64, s64, 4096
    buffer_load_dwordx4 v[192:195], v52, s[4:7], s64 offen offset:0 sc1
    buffer_load_dwordx4 v[196:199], v52, s[4:7], s64 offen offset:1024 sc1
    buffer_load_dwordx4 v[200:203], v52, s[4:7], s64 offen offset:2048 sc1
    buffer_load_dwordx4 v[204:207], v52, s[4:7], s64 offen offset:3072 sc1
    s_add_u32 s64, s64, 4096
    buffer_load_dwordx4 v[96:99], v52, s[4:7], s64 offen offset:0 sc1
    buffer_load_dwordx4 v[100:103], v52, s[4:7], s64 offen offset:1024 sc1
    buffer_load_dwordx4 v[104:107], v52, s[4:7], s64 offen offset:2048 sc1
    v_mfma_f32_16x16x32_bf16 a[128:131], v[72:75], a[224:227], a[128:131]
    v_mfma_f32_16x16x32_bf16 a[132:135], v[72:75], a[228:231], a[132:135]
    v_mfma_f32_16x16x32_bf16 a[136:139], v[72:75], a[232:235], a[136:139]
    v_mfma_f32_16x16x32_bf16 a[140:143], v[72:75], a[236:239], a[140:143]
    v_mfma_f32_16x16x32_bf16 a[128:131], v[76:79], a[240:243], a[128:131]
    v_mfma_f32_16x16x32_bf16 a[132:135], v[76:79], a[244:247], a[132:135]
    v_mfma_f32_16x16x32_bf16 a[136:139], v[76:79], a[248:251], a[136:139]
    v_mfma_f32_16x16x32_bf16 a[140:143], v[76:79], a[252:255], a[140:143]
    v_mfma_f32_16x16x32_bf16 a[128:131], v[80:83], a[0:3], a[128:131]
    v_mfma_f32_16x16x32_bf16 a[132:135], v[80:83], a[4:7], a[132:135]
    v_mfma_f32_16x16x32_bf16 a[136:139], v[80:83], a[8:11], a[136:139]
    v_mfma_f32_16x16x32_bf16 a[140:143], v[80:83], a[12:15], a[140:143]
    v_mfma_f32_16x16x32_bf16 a[128:131], v[84:87], a[16:19], a[128:131]
    v_mfma_f32_16x16x32_bf16 a[132:135], v[84:87], a[20:23], a[132:135]
    v_mfma_f32_16x16x32_bf16 a[136:139], v[84:87], a[24:27], a[136:139]
    v_mfma_f32_16x16x32_bf16 a[140:143], v[84:87], a[28:31], a[140:143]
    v_mfma_f32_16x16x32_bf16 a[128:131], v[88:91], a[32:35], a[128:131]
    v_mfma_f32_16x16x32_bf16 a[132:135], v[88:91], a[36:39], a[132:135]
    v_mfma_f32_16x16x32_bf16 a[136:139], v[88:91], a[40:43], a[136:139]
    v_mfma_f32_16x16x32_bf16 a[140:143], v[88:91], a[44:47], a[140:143]
    v_mfma_f32_16x16x32_bf16 a[128:131], v[92:95], a[48:51], a[128:131]
    v_mfma_f32_16x16x32_bf16 a[132:135], v[92:95], a[52:55], a[132:135]
    v_mfma_f32_16x16x32_bf16 a[136:139], v[92:95], a[56:59], a[136:139]
    v_mfma_f32_16x16x32_bf16 a[140:143], v[92:95], a[60:63], a[140:143]
    v_mfma_f32_16x16x32_bf16 a[128:131], v[128:131], a[64:67], a[128:131]
    v_mfma_f32_16x16x32_bf16 a[132:135], v[128:131], a[68:71], a[132:135]
    v_mfma_f32_16x16x32_bf16 a[136:139], v[128:131], a[72:75], a[136:139]
    v_mfma_f32_16x16x32_bf16 a[140:143], v[128:131], a[76:79], a[140:143]
    v_mfma_f32_16x16x32_bf16 a[128:131], v[132:135], a[80:83], a[128:131]
    v_mfma_f32_16x16x32_bf16 a[132:135], v[132:135], a[84:87], a[132:135]
    v_mfma_f32_16x16x32_bf16 a[136:139], v[132:135], a[88:91], a[136:139]
    v_mfma_f32_16x16x32_bf16 a[140:143], v[132:135], a[92:95], a[140:143]
    s_waitcnt vmcnt(11)
    s_barrier
    s_mov_b64 exec, s[76:77]
    buffer_store_dword v56, v50, s[4:7], s66 offen offset:384 sc1
    s_mov_b64 exec, -1
    buffer_load_dwordx4 v[108:111], v52, s[4:7], s64 offen offset:3072 sc1
    s_add_u32 s64, s64, 90112
    buffer_load_dwordx2 v[16:17], v59, s[4:7], s70 offen sc1
    s_add_u32 s70, s70, 4352
    v_mfma_f32_16x16x32_bf16 a[128:131], v[136:139], a[96:99], a[128:131]
    v_mfma_f32_16x16x32_bf16 a[132:135], v[136:139], a[100:103], a[132:135]
    v_mfma_f32_16x16x32_bf16 a[136:139], v[136:139], a[104:107], a[136:139]
    v_mfma_f32_16x16x32_bf16 a[140:143], v[136:139], a[108:111], a[140:143]
    v_mfma_f32_16x16x32_bf16 a[128:131], v[140:143], a[112:115], a[128:131]
    v_mfma_f32_16x16x32_bf16 a[132:135], v[140:143], a[116:119], a[132:135]
    v_mfma_f32_16x16x32_bf16 a[136:139], v[140:143], a[120:123], a[136:139]
    v_mfma_f32_16x16x32_bf16 a[140:143], v[140:143], a[124:127], a[140:143]
    s_waitcnt vmcnt(13)
    v_mfma_f32_16x16x32_bf16 a[144:147], v[160:163], a[192:195], 0
    buffer_load_dwordx2 v[18:19], v59, s[4:7], s70 offen sc1
    s_add_u32 s70, s70, 4352
    v_mfma_f32_16x16x32_bf16 a[148:151], v[160:163], a[196:199], 0
    v_mfma_f32_16x16x32_bf16 a[152:155], v[160:163], a[200:203], 0
    v_mfma_f32_16x16x32_bf16 a[156:159], v[160:163], a[204:207], 0
    s_waitcnt vmcnt(13)
    v_mfma_f32_16x16x32_bf16 a[144:147], v[164:167], a[208:211], a[144:147]
    buffer_load_dwordx2 v[20:21], v59, s[4:7], s70 offen sc1
    s_add_u32 s70, s70, 4352
    v_mfma_f32_16x16x32_bf16 a[148:151], v[164:167], a[212:215], a[148:151]
    v_mfma_f32_16x16x32_bf16 a[152:155], v[164:167], a[216:219], a[152:155]
    v_mfma_f32_16x16x32_bf16 a[156:159], v[164:167], a[220:223], a[156:159]
    s_waitcnt vmcnt(13)
    v_mfma_f32_16x16x32_bf16 a[144:147], v[168:171], a[224:227], a[144:147]
    buffer_load_dwordx2 v[22:23], v59, s[4:7], s70 offen sc1
    s_add_u32 s70, s70, 4352
    v_mfma_f32_16x16x32_bf16 a[148:151], v[168:171], a[228:231], a[148:151]
    v_mfma_f32_16x16x32_bf16 a[152:155], v[168:171], a[232:235], a[152:155]
    ds_write_b128 v54, a[128:131] offset:0
    v_mfma_f32_16x16x32_bf16 a[156:159], v[168:171], a[236:239], a[156:159]
    s_waitcnt vmcnt(13)
    v_mfma_f32_16x16x32_bf16 a[144:147], v[172:175], a[240:243], a[144:147]
    buffer_load_dwordx4 v[24:27], v60, s[4:7], s71 offen sc1
    v_mfma_f32_16x16x32_bf16 a[148:151], v[172:175], a[244:247], a[148:151]
    v_mfma_f32_16x16x32_bf16 a[152:155], v[172:175], a[248:251], a[152:155]
    ds_write_b128 v54, a[132:135] offset:1024
    v_mfma_f32_16x16x32_bf16 a[156:159], v[172:175], a[252:255], a[156:159]
    buffer_load_dword v62, v63, s[4:7], s74 offen offset:384 sc1
    s_waitcnt vmcnt(14)
    v_mfma_f32_16x16x32_bf16 a[144:147], v[192:195], a[0:3], a[144:147]
    v_mfma_f32_16x16x32_bf16 a[148:151], v[192:195], a[4:7], a[148:151]
    v_mfma_f32_16x16x32_bf16 a[152:155], v[192:195], a[8:11], a[152:155]
    ds_write_b128 v54, a[136:139] offset:2048
    v_mfma_f32_16x16x32_bf16 a[156:159], v[192:195], a[12:15], a[156:159]
    s_waitcnt vmcnt(13)
    v_mfma_f32_16x16x32_bf16 a[144:147], v[196:199], a[16:19], a[144:147]
    v_mfma_f32_16x16x32_bf16 a[148:151], v[196:199], a[20:23], a[148:151]
    v_mfma_f32_16x16x32_bf16 a[152:155], v[196:199], a[24:27], a[152:155]
    ds_write_b128 v54, a[140:143] offset:3072
    v_mfma_f32_16x16x32_bf16 a[156:159], v[196:199], a[28:31], a[156:159]
    s_waitcnt vmcnt(12)
    v_mfma_f32_16x16x32_bf16 a[144:147], v[200:203], a[32:35], a[144:147]
    v_mfma_f32_16x16x32_bf16 a[148:151], v[200:203], a[36:39], a[148:151]
    v_mfma_f32_16x16x32_bf16 a[152:155], v[200:203], a[40:43], a[152:155]
    v_mfma_f32_16x16x32_bf16 a[156:159], v[200:203], a[44:47], a[156:159]
    s_waitcnt vmcnt(11)
    v_mfma_f32_16x16x32_bf16 a[144:147], v[204:207], a[48:51], a[144:147]
    v_mfma_f32_16x16x32_bf16 a[148:151], v[204:207], a[52:55], a[148:151]
    v_mfma_f32_16x16x32_bf16 a[152:155], v[204:207], a[56:59], a[152:155]
    v_mfma_f32_16x16x32_bf16 a[156:159], v[204:207], a[60:63], a[156:159]
    s_waitcnt vmcnt(10)
    v_mfma_f32_16x16x32_bf16 a[144:147], v[96:99], a[64:67], a[144:147]
    v_mfma_f32_16x16x32_bf16 a[148:151], v[96:99], a[68:71], a[148:151]
    v_mfma_f32_16x16x32_bf16 a[152:155], v[96:99], a[72:75], a[152:155]
    v_mfma_f32_16x16x32_bf16 a[156:159], v[96:99], a[76:79], a[156:159]
    s_waitcnt vmcnt(9)
    v_mfma_f32_16x16x32_bf16 a[144:147], v[100:103], a[80:83], a[144:147]
    v_mfma_f32_16x16x32_bf16 a[148:151], v[100:103], a[84:87], a[148:151]
    v_mfma_f32_16x16x32_bf16 a[152:155], v[100:103], a[88:91], a[152:155]
    v_mfma_f32_16x16x32_bf16 a[156:159], v[100:103], a[92:95], a[156:159]
    s_waitcnt vmcnt(0)
    s_mov_b32 s75, 0
    s_branch K3_ph3_c
K3_ph3:
    buffer_load_dword v62, v63, s[4:7], s74 offen offset:384 sc1
    s_add_u32 s75, s75, 1
    s_waitcnt vmcnt(0)
K3_ph3_c:
    v_cmpx_ne_u32 vcc, s30, v62
    s_cmp_gt_u32 s75, 0x40000
    s_cbranch_scc1 K3_ph3_x
    s_cbranch_execnz K3_ph3
K3_ph3_x:
    s_mov_b64 exec, -1

    buffer_load_dwordx4 v[112:115], v52, s[4:7], s64 offen offset:0 sc1
    buffer_load_dwordx4 v[116:119], v52, s[4:7], s64 offen offset:1024 sc1
    buffer_load_dwordx4 v[120:123], v52, s[4:7], s64 offen offset:2048 sc1
    buffer_load_dwordx4 v[124:127], v52, s[4:7], s64 offen offset:3072 sc1
    s_add_u32 s64, s64, 4096
    buffer_load_dwordx4 v[144:147], v52, s[4:7], s64 offen offset:0 sc1
    buffer_load_dwordx4 v[148:151], v52, s[4:7], s64 offen offset:1024 sc1
    buffer_load_dwordx4 v[152:155], v52, s[4:7], s64 offen offset:2048 sc1
    buffer_load_dwordx4 v[156:159], v52, s[4:7], s64 offen offset:3072 sc1
    s_add_u32 s64, s64, 4096
    buffer_load_dwordx4 v[176:179], v52, s[4:7], s64 offen offset:0 sc1
    buffer_load_dwordx4 v[180:183], v52, s[4:7], s64 offen offset:1024 sc1
    buffer_load_dwordx4 v[184:187], v52, s[4:7], s64 offen offset:2048 sc1
    buffer_load_dwordx4 v[188:191], v52, s[4:7], s64 offen offset:3072 sc1
    s_add_u32 s64, s64, 90112
    buffer_load_dwordx4 v[208:211], v52, s[4:7], s64 offen offset:0 sc1
    buffer_load_dwordx4 v[212:215], v52, s[4:7], s64 offen offset:1024 sc1
    v_mfma_f32_16x16x32_bf16 a[144:147], v[104:107], a[96:99], a[144:147]
    v_mfma_f32_16x16x32_bf16 a[148:151], v[104:107], a[100:103], a[148:151]
    v_mfma_f32_16x16x32_bf16 a[152:155], v[104:107], a[104:107], a[152:155]
    v_mfma_f32_16x16x32_bf16 a[156:159], v[104:107], a[108:111], a[156:159]
    v_mfma_f32_16x16x32_bf16 a[144:147], v[108:111], a[112:115], a[144:147]
    v_mfma_f32_16x16x32_bf16 a[148:151], v[108:111], a[116:119], a[148:151]
    v_mfma_f32_16x16x32_bf16 a[152:155], v[108:111], a[120:123], a[152:155]
    v_mfma_f32_16x16x32_bf16 a[156:159], v[108:111], a[124:127], a[156:159]
    s_waitcnt vmcnt(13)
    v_mfma_f32_16x16x32_bf16 a[160:163], v[112:115], a[192:195], 0
    buffer_load_dwordx4 v[216:219], v52, s[4:7], s64 offen offset:2048 sc1
    v_mfma_f32_16x16x32_bf16 a[164:167], v[112:115], a[196:199], 0
    v_mfma_f32_16x16x32_bf16 a[168:171], v[112:115], a[200:203], 0
    v_mfma_f32_16x16x32_bf16 a[172:175], v[112:115], a[204:207], 0
    s_waitcnt vmcnt(13)
    v_mfma_f32_16x16x32_bf16 a[160:163], v[116:119], a[208:211], a[160:163]
    buffer_load_dwordx4 v[220:223], v52, s[4:7], s64 offen offset:3072 sc1
    s_add_u32 s64, s64, 4096
    v_mfma_f32_16x16x32_bf16 a[164:167], v[116:119], a[212:215], a[164:167]
    v_mfma_f32_16x16x32_bf16 a[168:171], v[116:119], a[216:219], a[168:171]
    v_mfma_f32_16x16x32_bf16 a[172:175], v[116:119], a[220:223], a[172:175]
    s_waitcnt vmcnt(13)
    v_mfma_f32_16x16x32_bf16 a[160:163], v[120:123], a[224:227], a[160:163]
    buffer_load_dwordx4 v[224:227], v52, s[4:7], s64 offen offset:0 sc1
    v_mfma_f32_16x16x32_bf16 a[164:167], v[120:123], a[228:231], a[164:167]
    v_mfma_f32_16x16x32_bf16 a[168:171], v[120:123], a[232:235], a[168:171]
    ds_write_b128 v54, a[144:147] offset:16384
    v_mfma_f32_16x16x32_bf16 a[172:175], v[120:123], a[236:239], a[172:175]
    s_waitcnt vmcnt(13)
    v_mfma_f32_16x16x32_bf16 a[160:163], v[124:127], a[240:243], a[160:163]
    buffer_load_dwordx4 v[228:231], v52, s[4:7], s64 offen offset:1024 sc1
    v_mfma_f32_16x16x32_bf16 a[164:167], v[124:127], a[244:247], a[164:167]
    v_mfma_f32_16x16x32_bf16 a[168:171], v[124:127], a[248:251], a[168:171]
    ds_write_b128 v54, a[148:151] offset:17408
    v_mfma_f32_16x16x32_bf16 a[172:175], v[124:127], a[252:255], a[172:175]
    s_waitcnt vmcnt(13)
    v_mfma_f32_16x16x32_bf16 a[160:163], v[144:147], a[0:3], a[160:163]
    buffer_load_dwordx4 v[232:235], v52, s[4:7], s64 offen offset:2048 sc1
    v_mfma_f32_16x16x32_bf16 a[164:167], v[144:147], a[4:7], a[164:167]
    v_mfma_f32_16x16x32_bf16 a[168:171], v[144:147], a[8:11], a[168:171]
    ds_write_b128 v54, a[152:155] offset:18432
    v_mfma_f32_16x16x32_bf16 a[172:175], v[144:147], a[12:15], a[172:175]
    s_waitcnt vmcnt(13)
    v_mfma_f32_16x16x32_bf16 a[160:163], v[148:151], a[16:19], a[160:163]
    buffer_load_dwordx4 v[236:239], v52, s[4:7], s64 offen offset:3072 sc1
    s_add_u32 s64, s64, 4096
    v_mfma_f32_16x16x32_bf16 a[164:167], v[148:151], a[20:23], a[164:167]
    v_mfma_f32_16x16x32_bf16 a[168:171], v[148:151], a[24:27], a[168:171]
    ds_write_b128 v54, a[156:159] offset:19456
    v_mfma_f32_16x16x32_bf16 a[172:175], v[148:151], a[28:31], a[172:175]
    s_waitcnt vmcnt(13)
    v_mfma_f32_16x16x32_bf16 a[160:163], v[152:155], a[32:35], a[160:163]
    buffer_load_dwordx4 v[240:243], v52, s[4:7], s64 offen offset:0 sc1
    v_mfma_f32_16x16x32_bf16 a[164:167], v[152:155], a[36:39], a[164:167]
    v_mfma_f32_16x16x32_bf16 a[168:171], v[152:155], a[40:43], a[168:171]
    v_mfma_f32_16x16x32_bf16 a[172:175], v[152:155], a[44:47], a[172:175]
    s_waitcnt vmcnt(13)
    v_mfma_f32_16x16x32_bf16 a[160:163], v[156:159], a[48:51], a[160:163]
    buffer_load_dwordx4 v[244:247], v52, s[4:7], s64 offen offset:1024 sc1
    v_mfma_f32_16x16x32_bf16 a[164:167], v[156:159], a[52:55], a[164:167]
    v_mfma_f32_16x16x32_bf16 a[168:171], v[156:159], a[56:59], a[168:171]
    v_mfma_f32_16x16x32_bf16 a[172:175], v[156:159], a[60:63], a[172:175]
    s_waitcnt vmcnt(13)
    v_mfma_f32_16x16x32_bf16 a[160:163], v[176:179], a[64:67], a[160:163]
    buffer_load_dwordx4 v[248:251], v52, s[4:7], s64 offen offset:2048 sc1
    v_mfma_f32_16x16x32_bf16 a[164:167], v[176:179], a[68:71], a[164:167]
    v_mfma_f32_16x16x32_bf16 a[168:171], v[176:179], a[72:75], a[168:171]
    v_mfma_f32_16x16x32_bf16 a[172:175], v[176:179], a[76:79], a[172:175]
    s_waitcnt vmcnt(13)
    v_mfma_f32_16x16x32_bf16 a[160:163], v[180:183], a[80:83], a[160:163]
    buffer_load_dwordx4 v[252:255], v52, s[4:7], s64 offen offset:3072 sc1
    s_add_u32 s64, s64, 90112
    v_mfma_f32_16x16x32_bf16 a[164:167], v[180:183], a[84:87], a[164:167]
    v_mfma_f32_16x16x32_bf16 a[168:171], v[180:183], a[88:91], a[168:171]
    v_mfma_f32_16x16x32_bf16 a[172:175], v[180:183], a[92:95], a[172:175]
    s_waitcnt vmcnt(13)
    v_mfma_f32_16x16x32_bf16 a[160:163], v[184:187], a[96:99], a[160:163]
    v_mfma_f32_16x16x32_bf16 a[164:167], v[184:187], a[100:103], a[164:167]
    v_mfma_f32_16x16x32_bf16 a[168:171], v[184:187], a[104:107], a[168:171]
    v_mfma_f32_16x16x32_bf16 a[172:175], v[184:187], a[108:111], a[172:175]
    s_waitcnt vmcnt(12)
    v_mfma_f32_16x16x32_bf16 a[160:163], v[188:191], a[112:115], a[160:163]
    v_mfma_f32_16x16x32_bf16 a[164:167], v[188:191], a[116:119], a[164:167]
    v_mfma_f32_16x16x32_bf16 a[168:171], v[188:191], a[120:123], a[168:171]
    v_mfma_f32_16x16x32_bf16 a[172:175], v[188:191], a[124:127], a[172:175]
    s_waitcnt vmcnt(11)
    v_mfma_f32_16x16x32_bf16 a[176:179], v[208:211], a[192:195], 0
    v_mfma_f32_16x16x32_bf16 a[180:183], v[208:211], a[196:199], 0
    v_mfma_f32_16x16x32_bf16 a[184:187], v[208:211], a[200:203], 0
    v_mfma_f32_16x16x32_bf16 a[188:191], v[208:211], a[204:207], 0
    s_waitcnt vmcnt(10)
    v_mfma_f32_16x16x32_bf16 a[176:179], v[212:215], a[208:211], a[176:179]
    v_mfma_f32_16x16x32_bf16 a[180:183], v[212:215], a[212:215], a[180:183]
    v_mfma_f32_16x16x32_bf16 a[184:187], v[212:215], a[216:219], a[184:187]
    v_mfma_f32_16x16x32_bf16 a[188:191], v[212:215], a[220:223], a[188:191]
    s_waitcnt vmcnt(9)
    v_mfma_f32_16x16x32_bf16 a[176:179], v[216:219], a[224:227], a[176:179]
    v_mfma_f32_16x16x32_bf16 a[180:183], v[216:219], a[228:231], a[180:183]
    v_mfma_f32_16x16x32_bf16 a[184:187], v[216:219], a[232:235], a[184:187]
    ds_write_b128 v54, a[160:163] offset:32768
    v_mfma_f32_16x16x32_bf16 a[188:191], v[216:219], a[236:239], a[188:191]
    s_waitcnt vmcnt(8)
    v_mfma_f32_16x16x32_bf16 a[176:179], v[220:223], a[240:243], a[176:179]
    v_mfma_f32_16x16x32_bf16 a[180:183], v[220:223], a[244:247], a[180:183]
    v_mfma_f32_16x16x32_bf16 a[184:187], v[220:223], a[248:251], a[184:187]
    ds_write_b128 v54, a[164:167] offset:33792
    v_mfma_f32_16x16x32_bf16 a[188:191], v[220:223], a[252:255], a[188:191]
    s_waitcnt vmcnt(7)
    v_mfma_f32_16x16x32_bf16 a[176:179], v[224:227], a[0:3], a[176:179]
    v_mfma_f32_16x16x32_bf16 a[180:183], v[224:227], a[4:7], a[180:183]
    v_mfma_f32_16x16x32_bf16 a[184:187], v[224:227], a[8:11], a[184:187]
    ds_write_b128 v54, a[168:171] offset:34816
    v_mfma_f32_16x16x32_bf16 a[188:191], v[224:227], a[12:15], a[188:191]
    s_waitcnt vmcnt(6)
    v_mfma_f32_16x16x32_bf16 a[176:179], v[228:231], a[16:19], a[176:179]
    v_mfma_f32_16x16x32_bf16 a[180:183], v[228:231], a[20:23], a[180:183]
    v_mfma_f32_16x16x32_bf16 a[184:187], v[228:231], a[24:27], a[184:187]
    ds_write_b128 v54, a[172:175] offset:35840
    v_mfma_f32_16x16x32_bf16 a[188:191], v[228:231], a[28:31], a[188:191]
    s_waitcnt vmcnt(5)
    v_mfma_f32_16x16x32_bf16 a[176:179], v[232:235], a[32:35], a[176:179]
    v_mfma_f32_16x16x32_bf16 a[180:183], v[232:235], a[36:39], a[180:183]
    v_mfma_f32_16x16x32_bf16 a[184:187], v[232:235], a[40:43], a[184:187]
    v_mfma_f32_16x16x32_bf16 a[188:191], v[232:235], a[44:47], a[188:191]
    s_waitcnt vmcnt(4)
    v_mfma_f32_16x16x32_bf16 a[176:179], v[236:239], a[48:51], a[176:179]
    v_mfma_f32_16x16x32_bf16 a[180:183], v[236:239], a[52:55], a[180:183]
    v_mfma_f32_16x16x32_bf16 a[184:187], v[236:239], a[56:59], a[184:187]
    v_mfma_f32_16x16x32_bf16 a[188:191], v[236:239], a[60:63], a[188:191]
    s_waitcnt vmcnt(3)
    v_mfma_f32_16x16x32_bf16 a[176:179], v[240:243], a[64:67], a[176:179]
    v_mfma_f32_16x16x32_bf16 a[180:183], v[240:243], a[68:71], a[180:183]
    v_mfma_f32_16x16x32_bf16 a[184:187], v[240:243], a[72:75], a[184:187]
    v_mfma_f32_16x16x32_bf16 a[188:191], v[240:243], a[76:79], a[188:191]
    s_waitcnt vmcnt(2)
    v_mfma_f32_16x16x32_bf16 a[176:179], v[244:247], a[80:83], a[176:179]
    v_mfma_f32_16x16x32_bf16 a[180:183], v[244:247], a[84:87], a[180:183]
    v_mfma_f32_16x16x32_bf16 a[184:187], v[244:247], a[88:91], a[184:187]
    v_mfma_f32_16x16x32_bf16 a[188:191], v[244:247], a[92:95], a[188:191]
    s_waitcnt vmcnt(1)
    v_mfma_f32_16x16x32_bf16 a[176:179], v[248:251], a[96:99], a[176:179]
    v_mfma_f32_16x16x32_bf16 a[180:183], v[248:251], a[100:103], a[180:183]
    v_mfma_f32_16x16x32_bf16 a[184:187], v[248:251], a[104:107], a[184:187]
    v_mfma_f32_16x16x32_bf16 a[188:191], v[248:251], a[108:111], a[188:191]
    s_waitcnt vmcnt(0)
    v_mfma_f32_16x16x32_bf16 a[176:179], v[252:255], a[112:115], a[176:179]
    v_mfma_f32_16x16x32_bf16 a[180:183], v[252:255], a[116:119], a[180:183]
    v_mfma_f32_16x16x32_bf16 a[184:187], v[252:255], a[120:123], a[184:187]
    v_mfma_f32_16x16x32_bf16 a[188:191], v[252:255], a[124:127], a[188:191]
    v_lshlrev_b32 v32, 16, v16
    v_and_b32 v33, 0xffff0000, v16
    v_lshlrev_b32 v34, 16, v17
    v_and_b32 v35, 0xffff0000, v17
    v_lshlrev_b32 v36, 16, v18
    v_and_b32 v37, 0xffff0000, v18
    v_lshlrev_b32 v38, 16, v19
    v_and_b32 v39, 0xffff0000, v19
    ds_write_b128 v54, a[176:179] offset:49152
    ds_write_b128 v54, a[180:183] offset:50176
    ds_write_b128 v54, a[184:187] offset:51200
    ds_write_b128 v54, a[188:191] offset:52224
    v_lshlrev_b32 v40, 16, v20
    v_and_b32 v41, 0xffff0000, v20
    v_lshlrev_b32 v42, 16, v21
    v_and_b32 v43, 0xffff0000, v21
    v_lshlrev_b32 v44, 16, v22
    v_and_b32 v45, 0xffff0000, v22
    v_lshlrev_b32 v46, 16, v23
    v_and_b32 v47, 0xffff0000, v23
    s_waitcnt lgkmcnt(0)
    s_barrier
    ds_read_b128 v[64:67], v55 offset:0
    ds_read_b128 v[68:71], v55 offset:4096
    ds_read_b128 v[72:75], v55 offset:8192
    ds_read_b128 v[76:79], v55 offset:12288
    ds_read_b128 v[80:83], v55 offset:1024
    ds_read_b128 v[84:87], v55 offset:5120
    ds_read_b128 v[88:91], v55 offset:9216
    ds_read_b128 v[92:95], v55 offset:13312
    ds_read_b128 v[96:99], v55 offset:2048
    ds_read_b128 v[100:103], v55 offset:6144
    ds_read_b128 v[104:107], v55 offset:10240
    ds_read_b128 v[108:111], v55 offset:14336
    ds_read_b128 v[112:115], v55 offset:3072
    ds_read_b128 v[116:119], v55 offset:7168
    ds_read_b128 v[120:123], v55 offset:11264
    ds_read_b128 v[124:127], v55 offset:15360
    s_waitcnt lgkmcnt(12)
    v_pk_add_f32 v[64:65], v[64:65], v[68:69]
    v_pk_add_f32 v[72:73], v[72:73], v[76:77]
    v_pk_add_f32 v[66:67], v[66:67], v[70:71]
    v_pk_add_f32 v[74:75], v[74:75], v[78:79]
    v_pk_add_f32 v[64:65], v[64:65], v[72:73]
    v_pk_add_f32 v[66:67], v[66:67], v[74:75]
    v_pk_fma_f32 v[32:33], v[64:65], v[24:25], v[32:33] op_sel:[0,0,0] op_sel_hi:[1,0,1]
    v_pk_fma_f32 v[34:35], v[66:67], v[24:25], v[34:35] op_sel:[0,0,0] op_sel_hi:[1,0,1]
    s_waitcnt lgkmcnt(8)
    v_pk_add_f32 v[80:81], v[80:81], v[84:85]
    v_pk_add_f32 v[88:89], v[88:89], v[92:93]
    v_pk_add_f32 v[82:83], v[82:83], v[86:87]
    v_pk_add_f32 v[90:91], v[90:91], v[94:95]
    v_pk_add_f32 v[80:81], v[80:81], v[88:89]
    v_pk_add_f32 v[82:83], v[82:83], v[90:91]
    v_pk_fma_f32 v[36:37], v[80:81], v[24:25], v[36:37] op_sel:[0,1,0] op_sel_hi:[1,1,1]
    v_pk_fma_f32 v[38:39], v[82:83], v[24:25], v[38:39] op_sel:[0,1,0] op_sel_hi:[1,1,1]
    s_waitcnt lgkmcnt(4)
    v_pk_add_f32 v[96:97], v[96:97], v[100:101]
    v_pk_add_f32 v[104:105], v[104:105], v[108:109]
    v_pk_add_f32 v[98:99], v[98:99], v[102:103]
    v_pk_add_f32 v[106:107], v[106:107], v[110:111]
    v_pk_add_f32 v[96:97], v[96:97], v[104:105]
    v_pk_add_f32 v[98:99], v[98:99], v[106:107]
    v_pk_fma_f32 v[40:41], v[96:97], v[26:27], v[40:41] op_sel:[0,0,0] op_sel_hi:[1,0,1]
    v_pk_fma_f32 v[42:43], v[98:99], v[26:27], v[42:43] op_sel:[0,0,0] op_sel_hi:[1,0,1]
    s_waitcnt lgkmcnt(0)
    v_pk_add_f32 v[112:113], v[112:113], v[116:117]
    v_pk_add_f32 v[120:121], v[120:121], v[124:125]
    v_pk_add_f32 v[114:115], v[114:115], v[118:119]
    v_pk_add_f32 v[122:123], v[122:123], v[126:127]
    v_pk_add_f32 v[112:113], v[112:113], v[120:121]
    v_pk_add_f32 v[114:115], v[114:115], v[122:123]
    v_pk_fma_f32 v[44:45], v[112:113], v[26:27], v[44:45] op_sel:[0,1,0] op_sel_hi:[1,1,1]
    v_pk_fma_f32 v[46:47], v[114:115], v[26:27], v[46:47] op_sel:[0,1,0] op_sel_hi:[1,1,1]
    v_cvt_pk_bf16_f32 v16, v32, v36
    v_cvt_pk_bf16_f32 v17, v40, v44
    buffer_store_dwordx2 v[16:17], v61, s[12:15], s72 offen offset:0

    v_cvt_pk_bf16_f32 v18, v33, v37
    v_cvt_pk_bf16_f32 v19, v41, v45
    buffer_store_dwordx2 v[18:19], v61, s[12:15], s72 offen offset:1024

    v_cvt_pk_bf16_f32 v20, v34, v38
    v_cvt_pk_bf16_f32 v21, v42, v46
    buffer_store_dwordx2 v[20:21], v61, s[12:15], s72 offen offset:2048

    v_cvt_pk_bf16_f32 v22, v35, v39
    v_cvt_pk_bf16_f32 v23, v43, v47
    buffer_store_dwordx2 v[22:23], v61, s[12:15], s72 offen offset:3072

K3_end:
    s_endpgm
CODE_END:
.section .rodata,"a"
.p2align 6
.amdhsa_kernel k1_kernel
  .amdhsa_next_free_vgpr 512
  .amdhsa_next_free_sgpr 102
  .amdhsa_accum_offset 256
  .amdhsa_group_segment_fixed_size 0
  .amdhsa_kernarg_size 128
  .amdhsa_user_sgpr_count 2
  .amdhsa_user_sgpr_kernarg_segment_ptr 1
  .amdhsa_system_sgpr_workgroup_id_x 1
  .amdhsa_float_denorm_mode_32 3
.end_amdhsa_kernel
```
